```python
import torch

def _softmax(x, axis=-1):
    return torch.softmax(x, dim=axis)

def _gelu(x):
    return torch.nn.functional.gelu(x, approximate='tanh')

def _silu(x):
    return torch.nn.functional.silu(x)

def _sigmoid(x):
    return torch.sigmoid(x)

def _layernorm(x, axis=-1, eps=1e-05):
    m = x.mean(dim=axis, keepdim=True)
    v = x.var(dim=axis, keepdim=True, unbiased=False)
    return (x - m) / torch.sqrt(v + eps)

def _scatter_add(tgt, idx, src, axis=0):
    return tgt.clone().index_add_(axis, idx, src)

def _segment_sum(src, seg, n):
    out = torch.zeros((n,) + src.shape[1:], dtype=src.dtype)
    return out.index_add_(0, seg, src)

def _pad(x, pw):
    flat = tuple((v for pair in reversed(pw) for v in pair))
    return torch.nn.functional.pad(x, flat)
kernel_name = 'adaLN_cond__ssm_conv_s4__dense_activation_relu__prompt'

def setup_inputs():

    _w = lambda a: (lambda t: t.to(torch.bfloat16) if t.is_floating_point() else t)(torch.as_tensor(a))

    def _A_setup():
        B, L, D, N = (1, 2048, 640, 128)
        A_re = -(lambda _x: torch.exp(torch.as_tensor(_x)))((lambda *s: torch.randn(*s, dtype=torch.bfloat16) * 3.2)(D, N))
        A_im = torch.pi * (lambda *s: torch.randn(*s, dtype=torch.bfloat16) * 0.1)(D, N)
        B_re = (lambda *s: torch.randn(*s, dtype=torch.bfloat16) * 0.2)(D, N)
        B_im = (lambda *s: torch.randn(*s, dtype=torch.bfloat16) * 0.2)(D, N)
        C_re = (lambda *s: torch.randn(*s, dtype=torch.bfloat16) * 0.2)(D, N)
        C_im = (lambda *s: torch.randn(*s, dtype=torch.bfloat16) * 0.2)(D, N)
        log_dt = (lambda *s: torch.randn(*s, dtype=torch.bfloat16) * 0.1)(D) * 0.5 - 4.0
        Dskip = (lambda *s: torch.randn(*s, dtype=torch.bfloat16) * 0.2)(D)
        return {'u': _w((lambda *s: torch.randn(*s, dtype=torch.bfloat16) * 0.05)(B, L, D)), 'A_re': _w(A_re), 'A_im': _w(A_im), 'B_re': _w(B_re), 'B_im': _w(B_im), 'C_re': _w(C_re), 'C_im': _w(C_im), 'log_dt': _w(log_dt), 'Dskip': _w(Dskip)}
    _A_in = _A_setup()

    def _B_setup():
        B, S, D, Dff = (1, 2048, 640, 1728)
        return {'x': _w((lambda *s: torch.randn(*s, dtype=torch.bfloat16) * 0.05)(B, S, D)), 'w1': _w((lambda *s: torch.randn(*s, dtype=torch.bfloat16) * 0.05)(D, Dff)), 'w2': _w((lambda *s: torch.randn(*s, dtype=torch.bfloat16) * 0.05)(Dff, D))}
    _B_in = _B_setup()
    return {'A_u': _A_in['u'], 'A_A_re': _A_in['A_re'], 'A_A_im': _A_in['A_im'], 'A_B_re': _A_in['B_re'], 'A_B_im': _A_in['B_im'], 'A_C_re': _A_in['C_re'], 'A_C_im': _A_in['C_im'], 'A_log_dt': _A_in['log_dt'], 'A_Dskip': _A_in['Dskip'], 'B_x': _B_in['x'], 'B_w1': _B_in['w1'], 'B_w2': _B_in['w2'], 'c': _w((lambda *s: torch.randn(*s, dtype=torch.bfloat16) * 0.1)(1, 640) * 8.0), 'w_mod': _w((lambda *s: torch.randn(*s, dtype=torch.bfloat16) * 0.1)(640, 6 * 640) * 640 ** (-0.5) * 8.0)}

def reference(A_u, A_A_re, A_A_im, A_B_re, A_B_im, A_C_re, A_C_im, A_log_dt, A_Dskip, B_x, B_w1, B_w2, c, w_mod):

    def _A_ref(u, A_re, A_im, B_re, B_im, C_re, C_im, log_dt, Dskip):
        Bsz, L, D = u.shape
        dt = torch.exp(log_dt)[:, None]
        A = A_re + 1j * A_im
        Bc = B_re + 1j * B_im
        Cc = C_re + 1j * C_im
        logdA = dt * A
        dB = dt * Bc
        l = (lambda x, dt: x.to(dt))(torch.arange(L), A_re.dtype)
        P = torch.exp(logdA[:, :, None] * l[None, None, :])
        K = torch.einsum('dn,dnl,dn->dl', Cc, P, dB).real
        L2 = 2 * L
        Kp = _pad(K, ((0, 0), (0, L)))
        up = (lambda x, *d: x.permute(*d))(u, 0, 2, 1)
        up = _pad(up, ((0, 0), (0, 0), (0, L)))
        Kf = (lambda x, axes=(-2, -1): torch.fft.rfft2(x.float(), dim=axes))(Kp[:, None, :], axes=(-2, -1))
        Uf = (lambda x, axes=(-2, -1): torch.fft.rfft2(x.float(), dim=axes))(up[:, :, None, :], axes=(-2, -1))
        Yf = Uf * Kf[None, :, :, :]
        y = (lambda x, s, axes=(-2, -1): torch.fft.irfft2(x, s=s, dim=axes).to(torch.bfloat16))(Yf, (1, L2), axes=(-2, -1))[:, :, 0, :L]
        y = (lambda x, *d: x.permute(*d))(y, 0, 2, 1) + u * Dskip[None, None, :]
        return y

    def _B_ref(x, w1, w2):
        h = torch.einsum('bsd,df->bsf', x, w1)
        zero = torch.zeros_like(h)
        h = torch.maximum(h, zero)
        return torch.einsum('bsf,fd->bsd', h, w2)
    x = A_u
    mod = (_silu(c) @ w_mod).reshape(c.shape[0], 6, 1, -1)
    sa, ca, ga, sb, cb, gb = (mod[:, 0].clone(), mod[:, 1].clone(), mod[:, 2].clone(), mod[:, 3].clone(), mod[:, 4].clone(), mod[:, 5].clone())
    h = _layernorm(x, axis=-1) * (1 + ca) + sa
    x = x + ga * _A_ref(h, A_A_re, A_A_im, A_B_re, A_B_im, A_C_re, A_C_im, A_log_dt, A_Dskip)
    h = _layernorm(x, axis=-1) * (1 + cb) + sb
    x = x + gb * _B_ref(h, B_w1, B_w2)
    return x
```

```asm
; @launch kernel=fused_kernel grid=(256,1,1) block=(256,1,1) lds=163840
.amdgcn_target "amdgcn-amd-amdhsa--gfx950"
.text
.globl fused_kernel
.type fused_kernel,@function
.p2align 8
fused_kernel:
    s_cmp_ge_u32 s2, 256
    s_cbranch_scc1 L_end
    s_load_dwordx16 s[16:31], s[0:1], 0
    s_load_dwordx2 s[36:37], s[0:1], 128
    s_load_dwordx8 s[72:79], s[0:1], 80
    s_load_dwordx2 s[38:39], s[0:1], 64
    s_load_dwordx4 s[32:35], s[0:1], 112
    v_lshlrev_b32 v227, 4, v0
    s_getpc_b64 s[48:49]
L_pc0:
    s_mov_b32 s50, L_code_end-L_pc0
    s_mov_b32 s51, 0x00020000
    s_lshr_b32 s4, s2, 3
    s_lshl_b32 s4, s4, 12
    buffer_load_dwordx4 v[252:255], v227, s[48:51], s4 offen
    v_lshrrev_b32 v1, 6, v0
    s_nop 0
    v_readfirstlane_b32 s3, v1
    v_and_b32 v2, 63, v0
    v_lshlrev_b32 v1, 4, v2
    s_and_b32 s6, s2, 7
    s_lshl_b32 s6, s6, 5
    s_lshr_b32 s7, s2, 3
    s_add_u32 s6, s6, s7
    s_and_b32 s89, s6, 1
    s_lshr_b32 s8, s6, 1
    s_add_u32 s8, s8, 512
    s_lshl_b32 s9, s6, 1
    s_add_u32 s10, s9, 1
    s_lshl_b32 s11, s8, 4
    s_add_u32 s11, s11, 2097152
    s_lshl_b32 s12, s9, 4
    s_add_u32 s12, s12, 2097152
    s_lshl_b32 s14, s10, 4
    s_add_u32 s14, s14, 2097152
    s_mov_b32 s68, 0xc080400
    s_mov_b32 s69, 0x2090501
    s_mov_b32 s70, 0x30e0a06
    s_mov_b32 s71, 0xb07
    s_cmp_eq_u32 s3, 1
    s_cselect_b32 s68, 0x1c181410, s68
    s_cselect_b32 s69, 0x1215110d, s69
    s_cselect_b32 s70, 0xf1e1a16, s70
    s_cselect_b32 s71, 0x1713, s71
    s_cmp_eq_u32 s3, 2
    s_cselect_b32 s68, 0x19282420, s68
    s_cselect_b32 s69, 0x2225211d, s69
    s_cselect_b32 s70, 0x1f1b2a26, s70
    s_cselect_b32 s71, 0x2723, s71
    s_cmp_eq_u32 s3, 3
    s_cselect_b32 s68, 0x2934302c, s68
    s_cselect_b32 s69, 0x35312d, s69
    s_cselect_b32 s70, 0x2b322e00, s70
    s_cselect_b32 s71, 0x332f, s71
    v_and_b32 v3, 127, v0
    v_lshlrev_b32 v130, 1, v3
    v_cmp_gt_u32 vcc, 128, v0
    v_mov_b32 v4, s9
    v_mov_b32 v5, s8
    v_cndmask_b32 v4, v4, v5, vcc
    v_lshl_add_u32 v128, v4, 8, v130
    v_lshlrev_b32 v129, 1, v4
    v_mov_b32 v131, 0
    s_and_b32 s85, s2, 127
    s_mul_i32 s67, s85, 5
    s_cmp_lt_u32 s2, 128
    s_cselect_b32 s66, 2211840, 0
    s_movk_i32 s4, 6554
    s_cselect_b32 s86, 2428, s4
    s_mov_b32 s4, 39680
    s_cselect_b32 s87, 107136, s4
    s_movk_i32 s4, 1280
    s_cselect_b32 s4, 3456, s4
    s_cselect_b32 s88, 1, 0
    v_lshrrev_b32 v3, 3, v0
    v_mul_u32_u24 v188, s4, v3
    v_and_b32 v3, 7, v0
    v_lshl_add_u32 v188, v3, 4, v188
    s_lshl_b32 s4, s67, 12
    s_add_u32 s66, s66, s4
    s_add_u32 s66, s66, 24117248
    s_lshl_b32 s60, s3, 10
    v_mov_b32 v190, -1
    v_mov_b32 v191, -1
    v_mov_b32 v192, -1
    v_mov_b32 v193, -1
    s_waitcnt lgkmcnt(0)
    s_add_u32 s40, s36, 0
    s_addc_u32 s41, s37, 0
    s_mov_b32 s42, 33554432
    s_mov_b32 s43, 0x00020000
    s_bfe_u32 s0, s2, 0x30004
    s_lshl_b32 s0, s0, 3
    s_and_b32 s1, s2, 7
    s_or_b32 s0, s0, s1
    s_bfe_u32 s1, s2, 0x20004
    s_xor_b32 s0, s0, s1
    s_cmp_lt_u32 s2, 128
    s_cselect_b32 s0, 255, s0
    s_add_u32 s1, s2, 8
    s_and_b32 s1, s1, 63
    s_sub_u32 s4, s0, 30
    s_cmp_lt_u32 s4, 30
    s_cselect_b32 s1, s1, 64
    s_bitcmp1_b32 s2, 3
    s_cselect_b32 s1, 64, s1
    s_lshr_b32 s5, s8, 1
    s_lshl_b32 s5, s5, 2
    s_load_dword s63, s[38:39], s5
    s_lshr_b32 s5, s9, 1
    s_lshl_b32 s5, s5, 2
    s_load_dword s64, s[38:39], s5
    s_lshr_b32 s5, s10, 1
    s_lshl_b32 s5, s5, 2
    s_load_dword s65, s[38:39], s5
    s_cmp_lg_u32 s2, 0
    s_cbranch_scc1 L_nl1
    s_mov_b32 s13, 1048576
    buffer_store_dwordx4 v[190:193], v227, s[40:43], s13 offen sc1
    s_mov_b32 s13, 1052672
    buffer_store_dwordx4 v[190:193], v227, s[40:43], s13 offen sc1
    s_mov_b32 s13, 1056768
    buffer_store_dwordx4 v[190:193], v227, s[40:43], s13 offen sc1
    s_mov_b32 s13, 1060864
    buffer_store_dwordx4 v[190:193], v227, s[40:43], s13 offen sc1
    s_mov_b32 s13, 1064960
    buffer_store_dwordx4 v[190:193], v227, s[40:43], s13 offen sc1
    s_mov_b32 s13, 1069056
    buffer_store_dwordx4 v[190:193], v227, s[40:43], s13 offen sc1
    s_mov_b32 s13, 1073152
    buffer_store_dwordx4 v[190:193], v227, s[40:43], s13 offen sc1
    s_mov_b32 s13, 1077248
    buffer_store_dwordx4 v[190:193], v227, s[40:43], s13 offen sc1
    s_mov_b32 s13, 1081344
    buffer_store_dwordx4 v[190:193], v227, s[40:43], s13 offen sc1
    s_mov_b32 s13, 1085440
    buffer_store_dwordx4 v[190:193], v227, s[40:43], s13 offen sc1
L_nl1:
    s_cmp_ge_u32 s2, 128
    s_cbranch_scc1 L_nx
    s_mul_i32 s5, s2, 20480
    v_lshrrev_b32 v3, 4, v0
    v_and_b32 v4, 15, v0
    v_mul_u32_u24 v5, 1280, v3
    v_lshl_add_u32 v5, v4, 4, v5
    s_add_u32 s48, s16, 0
    s_addc_u32 s49, s17, 0
    s_mov_b32 s50, 2621440
    s_mov_b32 s51, 0x00020000
    buffer_load_dwordx4 v[232:235], v5, s[48:51], s5 offen offset:0
    buffer_load_dwordx4 v[236:239], v5, s[48:51], s5 offen offset:256
    buffer_load_dwordx4 v[240:243], v5, s[48:51], s5 offen offset:512
    buffer_load_dwordx4 v[244:247], v5, s[48:51], s5 offen offset:768
    buffer_load_dwordx4 v[248:251], v5, s[48:51], s5 offen offset:1024
L_nx:
    s_lshl_b32 s13, s10, 8
    s_lshl_b32 s15, s10, 1
    s_add_u32 s48, s18, 0
    s_addc_u32 s49, s19, 0
    s_mov_b32 s50, 163840
    s_mov_b32 s51, 0x00020000
    buffer_load_ushort v108, v128, s[48:51], 0 offen
    buffer_load_ushort v115, v130, s[48:51], s13 offen
    s_add_u32 s52, s20, 0
    s_addc_u32 s53, s21, 0
    s_mov_b32 s54, 163840
    s_mov_b32 s55, 0x00020000
    buffer_load_ushort v109, v128, s[52:55], 0 offen
    buffer_load_ushort v116, v130, s[52:55], s13 offen
    s_add_u32 s56, s22, 0
    s_addc_u32 s57, s23, 0
    s_mov_b32 s58, 163840
    s_mov_b32 s59, 0x00020000
    buffer_load_ushort v110, v128, s[56:59], 0 offen
    buffer_load_ushort v117, v130, s[56:59], s13 offen
    s_add_u32 s48, s24, 0
    s_addc_u32 s49, s25, 0
    s_mov_b32 s50, 163840
    s_mov_b32 s51, 0x00020000
    buffer_load_ushort v111, v128, s[48:51], 0 offen
    buffer_load_ushort v118, v130, s[48:51], s13 offen
    s_add_u32 s52, s26, 0
    s_addc_u32 s53, s27, 0
    s_mov_b32 s54, 163840
    s_mov_b32 s55, 0x00020000
    buffer_load_ushort v112, v128, s[52:55], 0 offen
    buffer_load_ushort v119, v130, s[52:55], s13 offen
    s_add_u32 s56, s28, 0
    s_addc_u32 s57, s29, 0
    s_mov_b32 s58, 163840
    s_mov_b32 s59, 0x00020000
    buffer_load_ushort v113, v128, s[56:59], 0 offen
    buffer_load_ushort v120, v130, s[56:59], s13 offen
    s_add_u32 s48, s30, 0
    s_addc_u32 s49, s31, 0
    s_mov_b32 s50, 1280
    s_mov_b32 s51, 0x00020000
    buffer_load_ushort v114, v129, s[48:51], 0 offen
    buffer_load_ushort v121, v131, s[48:51], s15 offen
    v_lshlrev_b32 v6, 1, v0
    s_add_u32 s48, s76, 0
    s_addc_u32 s49, s77, 0
    s_mov_b32 s50, 1280
    s_mov_b32 s51, 0x00020000
    buffer_load_ushort v124, v6, s[48:51], 0 offen offset:0
    buffer_load_ushort v125, v6, s[48:51], 0 offen offset:512
    buffer_load_ushort v126, v6, s[48:51], 0 offen offset:1024
    s_cmp_lg_u32 s88, 0
    s_cselect_b32 s44, s72, s74
    s_cselect_b32 s45, s73, s75
    s_cmp_lt_u32 s85, 108
    s_cselect_b32 s46, 2211840, 0
    s_mov_b32 s47, 0x00020000
    s_add_u32 s15, s67, 0
    s_mul_i32 s13, s15, s86
    s_lshr_b32 s13, s13, 16
    s_mul_i32 s13, s13, s87
    s_lshl_b32 s15, s15, 7
    s_add_u32 s80, s13, s15
    s_add_u32 s15, s67, 1
    s_mul_i32 s13, s15, s86
    s_lshr_b32 s13, s13, 16
    s_mul_i32 s13, s13, s87
    s_lshl_b32 s15, s15, 7
    s_add_u32 s81, s13, s15
    s_add_u32 s15, s67, 2
    s_mul_i32 s13, s15, s86
    s_lshr_b32 s13, s13, 16
    s_mul_i32 s13, s13, s87
    s_lshl_b32 s15, s15, 7
    s_add_u32 s82, s13, s15
    s_add_u32 s15, s67, 3
    s_mul_i32 s13, s15, s86
    s_lshr_b32 s13, s13, 16
    s_mul_i32 s13, s13, s87
    s_lshl_b32 s15, s15, 7
    s_add_u32 s83, s13, s15
    s_add_u32 s15, s67, 4
    s_mul_i32 s13, s15, s86
    s_lshr_b32 s13, s13, 16
    s_mul_i32 s13, s13, s87
    s_lshl_b32 s15, s15, 7
    s_add_u32 s84, s13, s15
    s_cmp_ge_u32 s0, 60
    s_cbranch_scc1 L_nx2
    s_barrier
    v_and_b32 v160, 7, v0
    v_lshrrev_b32 v161, 3, v0
    s_mov_b32 s6, 76800
    v_mul_lo_u32 v161, v161, s6
    v_lshl_add_u32 v161, v160, 4, v161
    s_lshl_b32 s62, s0, 9
    s_lshl_b32 s5, s0, 7
    s_bfe_u32 s4, s2, 0x10003
    s_mul_i32 s6, s4, 2457600
    s_add_u32 s5, s5, s6
    s_mul_i32 s6, s4, 15360
    s_add_u32 s62, s62, s6
    s_cmp_lt_u32 s0, 30
    s_mov_b32 s6, 1098752
    s_cselect_b32 s6, 1056768, s6
    s_add_u32 s62, s62, s6
    s_mul_i32 s61, s4, 1280
    s_add_u32 s52, s78, 0
    s_addc_u32 s53, s79, 0
    s_mov_b32 s54, 4915200
    s_mov_b32 s55, 0x00020000
    buffer_load_dwordx4 v[232:235], v161, s[52:55], s5 offen
    s_add_u32 s5, s5, 7680
    buffer_load_dwordx4 v[236:239], v161, s[52:55], s5 offen
    s_add_u32 s5, s5, 7680
    buffer_load_dwordx4 v[240:243], v161, s[52:55], s5 offen
    s_add_u32 s5, s5, 7680
    buffer_load_dwordx4 v[244:247], v161, s[52:55], s5 offen
    s_add_u32 s5, s5, 7680
    buffer_load_dwordx4 v[248:251], v161, s[52:55], s5 offen
    s_add_u32 s5, s5, 7680
    buffer_load_dwordx4 v[252:255], v161, s[52:55], s5 offen
    s_add_u32 s5, s5, 7680
    buffer_load_dwordx4 v[172:175], v161, s[52:55], s5 offen
    s_add_u32 s5, s5, 7680
    buffer_load_dwordx4 v[176:179], v161, s[52:55], s5 offen
    s_add_u32 s5, s5, 7680
    buffer_load_dwordx4 v[180:183], v161, s[52:55], s5 offen
    s_add_u32 s5, s5, 7680
    buffer_load_dwordx4 v[184:187], v161, s[52:55], s5 offen
L_nx2:
    v_and_b32 v96, 15, v2
    v_lshrrev_b32 v97, 4, v2
    s_add_u32 s13, s88, 2
    v_lshlrev_b32 v98, s13, v97
    v_bfe_u32 v99, v2, 2, 2
    v_add_u32 v98, v98, v99
    v_lshlrev_b32 v98, 7, v98
    v_and_b32 v99, 3, v2
    v_lshl_add_u32 v98, v99, 3, v98
    s_lshl_b32 s13, s3, 5
    v_add_u32 v195, s13, v98
    s_cmp_lg_u32 s88, 0
    s_movk_i32 s13, 2048
    s_cselect_b32 s13, 512, s13
    v_add_u32 v196, s13, v195
    s_cmp_lt_u32 s85, 108
    s_cselect_b32 s13, 0, 0x70000000
    v_add_u32 v226, s13, v227
    s_lshl_b32 s13, s3, 10
    s_add_u32 s13, s13, 61440
    v_lshlrev_b32 v98, 5, v97
    v_add_u32 v197, s13, v98
    s_mul_i32 s13, s3, 2304
    s_add_u32 s13, s13, 90496
    v_add_u32 v198, s13, v1
    s_lshl_b32 s13, s3, 9
    s_add_u32 s13, s13, 155648
    v_lshlrev_b32 v98, 2, v2
    v_add_u32 v199, s13, v98
    s_lshl_b32 s13, s3, 11
    s_add_u32 s13, s13, 155648
    v_add_u32 v201, s13, v98
    v_lshlrev_b32 v200, 3, v0
    v_add_u32 v200, 90496, v200
    v_bfe_u32 v98, v0, 5, 2
    v_and_b32 v99, 1, v0
    v_lshlrev_b32 v99, 1, v99
    v_mov_b32 v101, 1
    v_lshlrev_b32 v101, v98, v101
    v_min_u32 v101, 4, v101
    v_mul_u32_u24 v101, v101, v99
    v_lshl_add_u32 v101, v98, 8, v101
    v_lshl_add_u32 v102, v98, 1, v99
    v_subrev_u32 v102, 2, v102
    v_min_u32 v100, v98, v99
    v_cmp_lt_u32 vcc, 1, v100
    s_nop 1
    v_cndmask_b32 v100, v101, v102, vcc
    v_bfe_u32 v98, v0, 1, 4
    v_lshl_add_u32 v100, v98, 3, v100
    v_and_b32 v98, 128, v0
    v_add_u32 v100, v100, v98
    v_cvt_f32_u32 v101, v100
    v_lshrrev_b32 v101, 16, v101
    v_lshlrev_b32 v101, 2, v101
    v_add_u32 v101, 0xffffdf00, v101
    v_cmp_gt_u32 vcc, 128, v100
    v_lshlrev_b32 v202, 2, v100
    v_add_u32 v202, 59648, v202
    v_cndmask_b32 v202, v101, v202, vcc
    v_lshrrev_b32 v101, 7, v202
    v_lshl_add_u32 v202, v101, 2, v202
    s_lshl_b32 s13, s3, 12
    s_add_u32 s13, s13, 63624
    v_mul_u32_u24 v98, 132, v97
    v_lshl_add_u32 v98, v96, 2, v98
    v_add_u32 v98, s13, v98
    v_lshlrev_b32 v99, 12, v2
    v_add_u32 v99, 64152, v99
    v_mov_b32 v100, 64328
    v_cmp_gt_u32 vcc, 3, v2
    s_nop 1
    v_cndmask_b32 v99, v100, v99, vcc
    v_cmp_gt_u32 vcc, 192, v0
    s_nop 1
    v_cndmask_b32 v203, v99, v98, vcc
    v_and_b32 v98, 127, v0
    v_lshrrev_b32 v99, 7, v0
    v_lshlrev_b32 v100, 4, v98
    v_mul_u32_u24 v101, 2304, v99
    v_add_u32 v101, v101, v100
    v_add_u32 v212, 90496, v101
    v_lshl_add_u32 v100, v99, 3, v100
    v_add_u32 v100, 7, v100
    s_mov_b32 s13, 0xffffdf00
    v_mov_b32 v104, 59648
    v_cvt_f32_u32 v101, v100
    v_subrev_f32 v204, 0.0, v101
    v_subrev_f32 v205, 1.0, v101
    v_cvt_pk_bf16_f32 v102, v204, v205
    v_and_b32 v204, 0xffff, v102
    v_lshrrev_b32 v205, 16, v102
    v_lshl_add_u32 v204, v204, 2, s13
    v_lshl_add_u32 v205, v205, 2, s13
    v_subrev_u32 v102, 0, v100
    v_subrev_u32 v103, 1, v100
    v_cmp_gt_u32 vcc, 128, v102
    v_lshl_add_u32 v102, v102, 2, v104
    s_nop 0
    v_cndmask_b32 v204, v204, v102, vcc
    v_cmp_gt_u32 vcc, 128, v103
    v_lshl_add_u32 v103, v103, 2, v104
    s_nop 0
    v_cndmask_b32 v205, v205, v103, vcc
    v_lshrrev_b32 v102, 7, v204
    v_lshl_add_u32 v204, v102, 2, v204
    v_lshrrev_b32 v103, 7, v205
    v_lshl_add_u32 v205, v103, 2, v205
    v_subrev_f32 v206, 2.0, v101
    v_subrev_f32 v207, 3.0, v101
    v_cvt_pk_bf16_f32 v102, v206, v207
    v_and_b32 v206, 0xffff, v102
    v_lshrrev_b32 v207, 16, v102
    v_lshl_add_u32 v206, v206, 2, s13
    v_lshl_add_u32 v207, v207, 2, s13
    v_subrev_u32 v102, 2, v100
    v_subrev_u32 v103, 3, v100
    v_cmp_gt_u32 vcc, 128, v102
    v_lshl_add_u32 v102, v102, 2, v104
    s_nop 0
    v_cndmask_b32 v206, v206, v102, vcc
    v_cmp_gt_u32 vcc, 128, v103
    v_lshl_add_u32 v103, v103, 2, v104
    s_nop 0
    v_cndmask_b32 v207, v207, v103, vcc
    v_lshrrev_b32 v102, 7, v206
    v_lshl_add_u32 v206, v102, 2, v206
    v_lshrrev_b32 v103, 7, v207
    v_lshl_add_u32 v207, v103, 2, v207
    v_subrev_f32 v208, 4.0, v101
    v_subrev_f32 v209, 5.0, v101
    v_cvt_pk_bf16_f32 v102, v208, v209
    v_and_b32 v208, 0xffff, v102
    v_lshrrev_b32 v209, 16, v102
    v_lshl_add_u32 v208, v208, 2, s13
    v_lshl_add_u32 v209, v209, 2, s13
    v_subrev_u32 v102, 4, v100
    v_subrev_u32 v103, 5, v100
    v_cmp_gt_u32 vcc, 128, v102
    v_lshl_add_u32 v102, v102, 2, v104
    s_nop 0
    v_cndmask_b32 v208, v208, v102, vcc
    v_cmp_gt_u32 vcc, 128, v103
    v_lshl_add_u32 v103, v103, 2, v104
    s_nop 0
    v_cndmask_b32 v209, v209, v103, vcc
    v_lshrrev_b32 v102, 7, v208
    v_lshl_add_u32 v208, v102, 2, v208
    v_lshrrev_b32 v103, 7, v209
    v_lshl_add_u32 v209, v103, 2, v209
    v_subrev_f32 v210, 6.0, v101
    v_subrev_f32 v211, 7.0, v101
    v_cvt_pk_bf16_f32 v102, v210, v211
    v_and_b32 v210, 0xffff, v102
    v_lshrrev_b32 v211, 16, v102
    v_lshl_add_u32 v210, v210, 2, s13
    v_lshl_add_u32 v211, v211, 2, s13
    v_subrev_u32 v102, 6, v100
    v_subrev_u32 v103, 7, v100
    v_cmp_gt_u32 vcc, 128, v102
    v_lshl_add_u32 v102, v102, 2, v104
    s_nop 0
    v_cndmask_b32 v210, v210, v102, vcc
    v_cmp_gt_u32 vcc, 128, v103
    v_lshl_add_u32 v103, v103, 2, v104
    s_nop 0
    v_cndmask_b32 v211, v211, v103, vcc
    v_lshrrev_b32 v102, 7, v210
    v_lshl_add_u32 v210, v102, 2, v210
    v_lshrrev_b32 v103, 7, v211
    v_lshl_add_u32 v211, v103, 2, v211
    v_mul_u32_u24 v213, 10368, v0
    v_subrev_u32 v100, 1, v0
    v_max_i32 v100, 0, v100
    v_mul_u32_u24 v214, 10368, v100
    v_lshrrev_b32 v98, 3, v2
    v_bfe_u32 v99, v2, 1, 2
    v_mov_b32 v100, s8
    v_mov_b32 v101, s9
    v_cmp_eq_u32 vcc, 1, v98
    s_nop 1
    v_cndmask_b32 v100, v100, v101, vcc
    v_mov_b32 v101, s10
    v_cmp_eq_u32 vcc, 2, v98
    s_nop 1
    v_cndmask_b32 v100, v100, v101, vcc
    v_mul_u32_u24 v99, 5120, v99
    v_lshl_add_u32 v215, v100, 3, v99
    v_and_b32 v99, 1, v2
    v_mul_u32_u24 v99, 15360, v99
    v_add_u32 v215, v215, v99
    v_add_u32 v216, 73760, v227
    s_mul_i32 s13, s3, 25728
    s_add_u32 s13, s13, 90240
    v_mul_u32_u24 v98, 2304, v97
    v_lshl_add_u32 v98, v96, 4, v98
    v_add_u32 v98, s13, v98
    v_cmp_gt_u32 vcc, 24, v2
    s_nop 1
    v_cndmask_b32 v102, 0, v2, vcc
    v_lshrrev_b32 v99, 3, v102
    v_mul_u32_u24 v99, 25728, v99
    v_bfe_u32 v100, v102, 1, 2
    v_mul_u32_u24 v100, 4128, v100
    v_and_b32 v101, 1, v102
    v_lshl_add_u32 v100, v101, 4, v100
    v_add_u32 v99, v99, v100
    v_add_u32 v99, 73728, v99
    v_cmp_gt_u32 vcc, 192, v0
    s_nop 1
    v_cndmask_b32 v217, v99, v98, vcc
    v_sub_u32 v98, 3, v96
    v_and_b32 v98, 3, v98
    v_mul_u32_u24 v99, 4130, v98
    v_lshl_add_u32 v99, v96, 1, v99
    v_lshlrev_b32 v100, 4, v97
    v_sub_u32 v99, v99, v100
    s_lshl_b32 s13, s3, 7
    s_add_u32 s13, s13, 73778
    v_add_u32 v218, s13, v99
    v_add_u32 v219, 2048, v218
    v_and_b32 v98, 1, v97
    v_mul_u32_u24 v98, 2304, v98
    v_lshrrev_b32 v99, 1, v97
    v_add_u32 v99, v99, v96
    v_lshl_add_u32 v98, v99, 4, v98
    s_lshl_b32 s13, s3, 6
    s_sub_u32 s13, 90448, s13
    v_add_u32 v220, s13, v98
    v_lshrrev_b32 v99, 1, v97
    v_lshl_add_u32 v98, v99, 7, v1
    s_mul_i32 s13, s3, 9216
    v_add_u32 v221, s13, v98
    s_mul_i32 s13, s3, 1152
    v_and_b32 v98, 3, v2
    v_lshlrev_b32 v98, 8, v98
    v_bfe_u32 v99, v2, 1, 1
    v_lshl_add_u32 v98, v99, 7, v98
    v_lshrrev_b32 v99, 2, v2
    v_lshl_add_u32 v98, v99, 4, v98
    v_add_u32 v223, s13, v98
    v_lshrrev_b32 v98, 5, v0
    v_mul_u32_u24 v98, 1152, v98
    v_and_b32 v99, 1, v0
    v_mul_u32_u24 v99, 640, v99
    v_bfe_u32 v100, v0, 1, 4
    v_lshl_add_u32 v99, v100, 4, v99
    v_add_u32 v222, v98, v99
    s_cmp_eq_u32 s89, 0
    s_mov_b32 s15, 0x02030405
    s_cselect_b32 s13, 0x00010607, s15
    s_lshl_b32 s15, s3, 3
    s_lshr_b32 s13, s13, s15
    s_and_b32 s13, s13, 7
    s_lshl_b32 s13, s13, 9
    v_lshlrev_b32 v98, 3, v2
    v_add_u32 v224, s13, v98
    v_add_u32 v225, 73760, v224
    v_lshrrev_b32 v98, 5, v224
    v_mul_u32_u24 v98, 4064, v98
    v_add_u32 v224, v224, v98
    v_lshlrev_b32 v104, 3, v96
    v_cvt_f32_u32 v104, v104
    v_lshrrev_b32 v98, 2, v96
    v_and_b32 v99, 3, v96
    v_mov_b32 v100, 1
    v_lshlrev_b32 v100, v98, v100
    v_min_u32 v100, 4, v100
    v_mul_u32_u24 v100, v100, v99
    v_lshl_add_u32 v100, v98, 8, v100
    v_lshl_add_u32 v101, v98, 1, v99
    v_subrev_u32 v101, 2, v101
    v_min_u32 v106, v98, v99
    v_cmp_lt_u32 vcc, 1, v106
    s_nop 1
    v_cndmask_b32 v106, v100, v101, vcc
    v_cvt_f32_u32 v106, v106
    s_add_u32 s48, s34, 0
    s_addc_u32 s49, s35, 0
    s_mov_b32 s50, 256
    s_mov_b32 s51, 0x00020000
    s_cmp_lg_u32 s2, 0
    s_cbranch_scc1 L_nl2
    v_mov_b32 v12, 1
    s_lshl_b32 s13, s3, 2
    s_waitcnt vmcnt(22)
    s_mov_b64 exec, 1
    buffer_store_dword v12, v131, s[48:51], s13 offen sc1
    s_mov_b64 exec, -1
    s_branch L_ln1
    s_waitcnt vmcnt(1)
    s_branch L_nl3
L_nl2:
    s_cmp_lt_u32 s2, 128
    s_cbranch_scc1 L_ln1
    s_cmp_lt_u32 s0, 60
    s_cbranch_scc1 L_nl4
    s_waitcnt vmcnt(0)
L_nl4:
    s_waitcnt vmcnt(10)
L_nl3:
    s_cmp_lt_u32 s2, 128
    s_cbranch_scc1 L_nx3
    s_add_u32 m0, s60, 0
    s_nop 0
    buffer_load_dwordx4 v188, s[44:47], s80 offen lds
    s_add_u32 m0, s60, 4096
    s_nop 0
    buffer_load_dwordx4 v188, s[44:47], s81 offen lds
    s_add_u32 m0, s60, 8192
    s_nop 0
    buffer_load_dwordx4 v188, s[44:47], s82 offen lds
    s_add_u32 m0, s60, 12288
    s_nop 0
    buffer_load_dwordx4 v188, s[44:47], s83 offen lds
    s_add_u32 m0, s60, 16384
    s_nop 0
    buffer_load_dwordx4 v188, s[44:47], s84 offen lds
    s_branch L_nx3
L_ln1:
    s_mul_i32 s5, s2, 20736
    v_lshrrev_b32 v140, 4, v0
    v_and_b32 v145, 15, v0
    s_add_u32 s6, s5, 2097152
    s_mul_i32 s4, s3, 2560
    s_add_u32 s6, s6, s4
    s_mov_b32 s7, 0x3f803f80
    v_mov_b32 v143, 0x3f80
    v_mov_b32 v144, 0x3f800000
    v_mul_u32_u24 v140, 1344, v140
    v_lshl_add_u32 v140, v145, 4, v140
    s_waitcnt vmcnt(17)
    v_dot2_f32_bf16 v148, v232, s7, 0
    v_dot2_f32_bf16 v150, v232, v232, 0
    v_dot2_f32_bf16 v149, v233, s7, 0
    v_dot2_f32_bf16 v151, v233, v233, 0
    v_dot2_f32_bf16 v148, v234, s7, v148
    v_dot2_f32_bf16 v150, v234, v234, v150
    v_dot2_f32_bf16 v149, v235, s7, v149
    v_dot2_f32_bf16 v151, v235, v235, v151
    v_dot2_f32_bf16 v148, v236, s7, v148
    v_dot2_f32_bf16 v150, v236, v236, v150
    v_dot2_f32_bf16 v149, v237, s7, v149
    v_dot2_f32_bf16 v151, v237, v237, v151
    v_dot2_f32_bf16 v148, v238, s7, v148
    v_dot2_f32_bf16 v150, v238, v238, v150
    v_dot2_f32_bf16 v149, v239, s7, v149
    v_dot2_f32_bf16 v151, v239, v239, v151
    v_dot2_f32_bf16 v148, v240, s7, v148
    v_dot2_f32_bf16 v150, v240, v240, v150
    v_dot2_f32_bf16 v149, v241, s7, v149
    v_dot2_f32_bf16 v151, v241, v241, v151
    v_dot2_f32_bf16 v148, v242, s7, v148
    v_dot2_f32_bf16 v150, v242, v242, v150
    v_dot2_f32_bf16 v149, v243, s7, v149
    v_dot2_f32_bf16 v151, v243, v243, v151
    v_dot2_f32_bf16 v148, v244, s7, v148
    v_dot2_f32_bf16 v150, v244, v244, v150
    v_dot2_f32_bf16 v149, v245, s7, v149
    v_dot2_f32_bf16 v151, v245, v245, v151
    v_dot2_f32_bf16 v148, v246, s7, v148
    v_dot2_f32_bf16 v150, v246, v246, v150
    v_dot2_f32_bf16 v149, v247, s7, v149
    v_dot2_f32_bf16 v151, v247, v247, v151
    v_dot2_f32_bf16 v148, v248, s7, v148
    v_dot2_f32_bf16 v150, v248, v248, v150
    v_dot2_f32_bf16 v149, v249, s7, v149
    v_dot2_f32_bf16 v151, v249, v249, v151
    v_dot2_f32_bf16 v148, v250, s7, v148
    v_dot2_f32_bf16 v150, v250, v250, v150
    v_dot2_f32_bf16 v149, v251, s7, v149
    v_dot2_f32_bf16 v151, v251, v251, v151
    v_lshrrev_b32 v145, 5, v2
    v_bfe_u32 v141, v2, 2, 2
    v_lshl_add_u32 v141, v145, 3, v141
    v_add_f32 v148, v148, v149
    v_add_f32 v150, v150, v151
    v_mul_u32_u24 v141, 1344, v141
    v_add_f32_dpp v148, v148, v148 row_ror:8 row_mask:0xf bank_mask:0xf
    v_add_f32_dpp v150, v150, v150 row_ror:8 row_mask:0xf bank_mask:0xf
    v_bfe_u32 v146, v2, 4, 1
    v_add_f32_dpp v148, v148, v148 row_ror:4 row_mask:0xf bank_mask:0xf
    v_add_f32_dpp v150, v150, v150 row_ror:4 row_mask:0xf bank_mask:0xf
    v_lshl_add_u32 v141, v146, 5, v141
    v_add_f32_dpp v148, v148, v148 row_ror:2 row_mask:0xf bank_mask:0xf
    v_add_f32_dpp v150, v150, v150 row_ror:2 row_mask:0xf bank_mask:0xf
    v_and_b32 v146, 3, v2
    v_add_f32_dpp v148, v148, v148 row_ror:1 row_mask:0xf bank_mask:0xf
    v_add_f32_dpp v150, v150, v150 row_ror:1 row_mask:0xf bank_mask:0xf
    v_mul_f32 v148, 0x3acccccd, v148
    v_mul_f32 v150, 0x3acccccd, v150
    v_fma_f32 v150, -v148, v148, v150
    v_cvt_pk_bf16_f32 v148, v148, v148
    v_max_f32 v150, 0, v150
    v_and_b32 v148, 0xffff0000, v148
    v_cvt_pk_bf16_f32 v150, v150, v150
    v_xor_b32 v148, 0x80000000, v148
    v_and_b32 v150, 0xffff0000, v150
    v_dot2_f32_bf16 v156, v232, v143, v148
    v_add_f32 v150, 0x3727c5ac, v150
    v_dot2_f32_bf16 v157, v232, v144, v148
    v_cvt_pk_bf16_f32 v150, v150, v150
    v_dot2_f32_bf16 v158, v233, v143, v148
    v_and_b32 v150, 0xffff0000, v150
    v_dot2_f32_bf16 v159, v233, v144, v148
    v_sqrt_f32 v152, v150
    v_dot2_f32_bf16 v160, v234, v143, v148
    v_rcp_f32 v154, v152
    v_dot2_f32_bf16 v161, v234, v144, v148
    v_fma_f32 v153, -v152, v152, v150
    v_dot2_f32_bf16 v162, v235, v143, v148
    v_mul_f32 v154, 0.5, v154
    v_dot2_f32_bf16 v163, v235, v144, v148
    v_fmac_f32 v152, v153, v154
    v_dot2_f32_bf16 v164, v236, v143, v148
    v_cvt_pk_bf16_f32 v152, v152, v152
    v_dot2_f32_bf16 v165, v236, v144, v148
    v_and_b32 v152, 0xffff0000, v152
    v_dot2_f32_bf16 v166, v237, v143, v148
    v_rcp_f32 v154, v152
    v_dot2_f32_bf16 v167, v237, v144, v148
    v_fma_f32 v153, -v152, v154, 1.0
    v_dot2_f32_bf16 v168, v238, v143, v148
    v_fmac_f32 v154, v153, v154
    v_dot2_f32_bf16 v169, v238, v144, v148
    v_lshl_add_u32 v141, v146, 3, v141
    v_dot2_f32_bf16 v170, v239, v143, v148
    s_mul_i32 s4, s3, 320
    v_dot2_f32_bf16 v171, v239, v144, v148
    v_add_u32 v141, s4, v141
    v_cvt_pk_bf16_f32 v232, v156, v157
    v_and_b32 v142, 31, v2
    v_cvt_pk_bf16_f32 v233, v158, v159
    v_mul_u32_u24 v145, 10368, v145
    v_cvt_pk_bf16_f32 v234, v160, v161
    v_lshl_add_u32 v142, v142, 4, v145
    v_cvt_pk_bf16_f32 v235, v162, v163
    v_dot2_f32_bf16 v156, v240, v143, v148
    v_dot2_f32_bf16 v157, v240, v144, v148
    v_dot2_f32_bf16 v158, v241, v143, v148
    v_dot2_f32_bf16 v159, v241, v144, v148
    v_dot2_f32_bf16 v160, v242, v143, v148
    v_dot2_f32_bf16 v161, v242, v144, v148
    v_dot2_f32_bf16 v162, v243, v143, v148
    v_dot2_f32_bf16 v163, v243, v144, v148
    v_cvt_pk_bf16_f32 v236, v164, v165
    v_cvt_pk_bf16_f32 v237, v166, v167
    v_cvt_pk_bf16_f32 v238, v168, v169
    v_cvt_pk_bf16_f32 v239, v170, v171
    v_dot2_f32_bf16 v164, v244, v143, v148
    v_dot2_f32_bf16 v165, v244, v144, v148
    v_dot2_f32_bf16 v166, v245, v143, v148
    v_dot2_f32_bf16 v167, v245, v144, v148
    v_dot2_f32_bf16 v168, v246, v143, v148
    v_dot2_f32_bf16 v169, v246, v144, v148
    v_dot2_f32_bf16 v170, v247, v143, v148
    v_dot2_f32_bf16 v171, v247, v144, v148
    v_cvt_pk_bf16_f32 v240, v156, v157
    v_cvt_pk_bf16_f32 v241, v158, v159
    v_cvt_pk_bf16_f32 v242, v160, v161
    v_cvt_pk_bf16_f32 v243, v162, v163
    v_dot2_f32_bf16 v156, v248, v143, v148
    v_dot2_f32_bf16 v157, v248, v144, v148
    v_dot2_f32_bf16 v158, v249, v143, v148
    v_dot2_f32_bf16 v159, v249, v144, v148
    v_dot2_f32_bf16 v160, v250, v143, v148
    v_dot2_f32_bf16 v161, v250, v144, v148
    v_dot2_f32_bf16 v162, v251, v143, v148
    v_dot2_f32_bf16 v163, v251, v144, v148
    v_cvt_pk_bf16_f32 v244, v164, v165
    v_cvt_pk_bf16_f32 v245, v166, v167
    v_cvt_pk_bf16_f32 v246, v168, v169
    v_cvt_pk_bf16_f32 v247, v170, v171
    v_cvt_pk_bf16_f32 v248, v156, v157
    v_cvt_pk_bf16_f32 v249, v158, v159
    v_cvt_pk_bf16_f32 v250, v160, v161
    v_cvt_pk_bf16_f32 v251, v162, v163
    v_lshlrev_b32 v156, 16, v232
    v_and_b32 v157, 0xffff0000, v232
    v_lshlrev_b32 v158, 16, v233
    v_and_b32 v159, 0xffff0000, v233
    v_lshlrev_b32 v160, 16, v234
    v_and_b32 v161, 0xffff0000, v234
    v_lshlrev_b32 v162, 16, v235
    v_and_b32 v163, 0xffff0000, v235
    v_pk_mul_f32 v[156:157], v[156:157], v[154:155] op_sel:[0,0] op_sel_hi:[1,0]
    v_pk_mul_f32 v[158:159], v[158:159], v[154:155] op_sel:[0,0] op_sel_hi:[1,0]
    v_pk_mul_f32 v[160:161], v[160:161], v[154:155] op_sel:[0,0] op_sel_hi:[1,0]
    v_pk_mul_f32 v[162:163], v[162:163], v[154:155] op_sel:[0,0] op_sel_hi:[1,0]
    v_cvt_pk_bf16_f32 v232, v156, v157
    v_cvt_pk_bf16_f32 v233, v158, v159
    v_cvt_pk_bf16_f32 v234, v160, v161
    v_cvt_pk_bf16_f32 v235, v162, v163
    ds_write_b128 v140, v[232:235] offset:36864
    v_lshlrev_b32 v164, 16, v236
    v_and_b32 v165, 0xffff0000, v236
    v_lshlrev_b32 v166, 16, v237
    v_and_b32 v167, 0xffff0000, v237
    v_lshlrev_b32 v168, 16, v238
    v_and_b32 v169, 0xffff0000, v238
    v_lshlrev_b32 v170, 16, v239
    v_and_b32 v171, 0xffff0000, v239
    v_pk_mul_f32 v[164:165], v[164:165], v[154:155] op_sel:[0,0] op_sel_hi:[1,0]
    v_pk_mul_f32 v[166:167], v[166:167], v[154:155] op_sel:[0,0] op_sel_hi:[1,0]
    v_pk_mul_f32 v[168:169], v[168:169], v[154:155] op_sel:[0,0] op_sel_hi:[1,0]
    v_pk_mul_f32 v[170:171], v[170:171], v[154:155] op_sel:[0,0] op_sel_hi:[1,0]
    v_cvt_pk_bf16_f32 v236, v164, v165
    v_cvt_pk_bf16_f32 v237, v166, v167
    v_cvt_pk_bf16_f32 v238, v168, v169
    v_cvt_pk_bf16_f32 v239, v170, v171
    ds_write_b128 v140, v[236:239] offset:37120
    v_lshlrev_b32 v156, 16, v240
    v_and_b32 v157, 0xffff0000, v240
    v_lshlrev_b32 v158, 16, v241
    v_and_b32 v159, 0xffff0000, v241
    v_lshlrev_b32 v160, 16, v242
    v_and_b32 v161, 0xffff0000, v242
    v_lshlrev_b32 v162, 16, v243
    v_and_b32 v163, 0xffff0000, v243
    v_pk_mul_f32 v[156:157], v[156:157], v[154:155] op_sel:[0,0] op_sel_hi:[1,0]
    v_pk_mul_f32 v[158:159], v[158:159], v[154:155] op_sel:[0,0] op_sel_hi:[1,0]
    v_pk_mul_f32 v[160:161], v[160:161], v[154:155] op_sel:[0,0] op_sel_hi:[1,0]
    v_pk_mul_f32 v[162:163], v[162:163], v[154:155] op_sel:[0,0] op_sel_hi:[1,0]
    v_cvt_pk_bf16_f32 v240, v156, v157
    v_cvt_pk_bf16_f32 v241, v158, v159
    v_cvt_pk_bf16_f32 v242, v160, v161
    v_cvt_pk_bf16_f32 v243, v162, v163
    ds_write_b128 v140, v[240:243] offset:37376
    v_lshlrev_b32 v164, 16, v244
    v_and_b32 v165, 0xffff0000, v244
    v_lshlrev_b32 v166, 16, v245
    v_and_b32 v167, 0xffff0000, v245
    v_lshlrev_b32 v168, 16, v246
    v_and_b32 v169, 0xffff0000, v246
    v_lshlrev_b32 v170, 16, v247
    v_and_b32 v171, 0xffff0000, v247
    v_pk_mul_f32 v[164:165], v[164:165], v[154:155] op_sel:[0,0] op_sel_hi:[1,0]
    v_pk_mul_f32 v[166:167], v[166:167], v[154:155] op_sel:[0,0] op_sel_hi:[1,0]
    v_pk_mul_f32 v[168:169], v[168:169], v[154:155] op_sel:[0,0] op_sel_hi:[1,0]
    v_pk_mul_f32 v[170:171], v[170:171], v[154:155] op_sel:[0,0] op_sel_hi:[1,0]
    v_cvt_pk_bf16_f32 v244, v164, v165
    v_cvt_pk_bf16_f32 v245, v166, v167
    v_cvt_pk_bf16_f32 v246, v168, v169
    v_cvt_pk_bf16_f32 v247, v170, v171
    ds_write_b128 v140, v[244:247] offset:37632
    v_lshlrev_b32 v156, 16, v248
    v_and_b32 v157, 0xffff0000, v248
    v_lshlrev_b32 v158, 16, v249
    v_and_b32 v159, 0xffff0000, v249
    v_lshlrev_b32 v160, 16, v250
    v_and_b32 v161, 0xffff0000, v250
    v_lshlrev_b32 v162, 16, v251
    v_and_b32 v163, 0xffff0000, v251
    v_pk_mul_f32 v[156:157], v[156:157], v[154:155] op_sel:[0,0] op_sel_hi:[1,0]
    v_pk_mul_f32 v[158:159], v[158:159], v[154:155] op_sel:[0,0] op_sel_hi:[1,0]
    v_pk_mul_f32 v[160:161], v[160:161], v[154:155] op_sel:[0,0] op_sel_hi:[1,0]
    v_pk_mul_f32 v[162:163], v[162:163], v[154:155] op_sel:[0,0] op_sel_hi:[1,0]
    v_cvt_pk_bf16_f32 v248, v156, v157
    v_cvt_pk_bf16_f32 v249, v158, v159
    v_cvt_pk_bf16_f32 v250, v160, v161
    v_cvt_pk_bf16_f32 v251, v162, v163
    ds_write_b128 v140, v[248:251] offset:37888
    s_waitcnt lgkmcnt(0)
    s_barrier
    ds_read_b64_tr_b16 v[232:233], v141 offset:36864
    ds_read_b64_tr_b16 v[234:235], v141 offset:42240
    ds_read_b64_tr_b16 v[236:237], v141 offset:36928
    ds_read_b64_tr_b16 v[238:239], v141 offset:42304
    ds_read_b64_tr_b16 v[240:241], v141 offset:36992
    ds_read_b64_tr_b16 v[242:243], v141 offset:42368
    ds_read_b64_tr_b16 v[244:245], v141 offset:37056
    ds_read_b64_tr_b16 v[246:247], v141 offset:42432
    ds_read_b64_tr_b16 v[248:249], v141 offset:37120
    ds_read_b64_tr_b16 v[250:251], v141 offset:42496
    v_mov_b32 v252, v142
    s_waitcnt lgkmcnt(8)
    buffer_store_dwordx4 v[232:235], v252, s[40:43], s6 offen offset:0 sc1
    s_waitcnt lgkmcnt(6)
    buffer_store_dwordx4 v[236:239], v252, s[40:43], s6 offen offset:512 sc1
    s_waitcnt lgkmcnt(4)
    buffer_store_dwordx4 v[240:243], v252, s[40:43], s6 offen offset:1024 sc1
    s_waitcnt lgkmcnt(2)
    buffer_store_dwordx4 v[244:247], v252, s[40:43], s6 offen offset:1536 sc1
    s_waitcnt lgkmcnt(0)
    buffer_store_dwordx4 v[248:251], v252, s[40:43], s6 offen offset:2048 sc1
    v_lshlrev_b32 v5, 2, v2
    s_waitcnt vmcnt(5)
    s_cmp_eq_u32 s3, 0
    s_cselect_b64 exec, 15, 0
    buffer_load_dword v189, v5, s[48:51], 0 offen sc1
    s_mov_b64 exec, -1
L_nx3:
    s_mov_b32 s4, 0x3fb8aa3b
    s_mov_b32 s5, 0x32a57060
    v_lshlrev_b32 v3, 5, v0
    v_add_u32 v3, 61440, v3
    v_lshlrev_b32 v4, 4, v130
    v_add_u32 v4, 69632, v4
    v_lshlrev_b32 v114, 16, v114
    v_mul_f32 v12, s4, v114
    v_fma_f32 v13, v114, s4, -v12
    v_mov_b32 v14, s5
    v_fmac_f32 v13, v114, v14
    v_exp_f32 v12, v12
    v_mul_f32 v13, 0x3f317218, v13
    v_fmac_f32 v12, v12, v13
    v_lshlrev_b32 v121, 16, v121
    v_cvt_pk_bf16_f32 v12, v12, v12
    v_mul_f32 v36, s4, v121
    v_and_b32 v12, 0xffff0000, v12
    v_fma_f32 v37, v121, s4, -v36
    v_lshlrev_b32 v108, 16, v108
    v_mov_b32 v38, s5
    v_lshlrev_b32 v109, 16, v109
    v_fmac_f32 v37, v121, v38
    v_lshlrev_b32 v110, 16, v110
    v_exp_f32 v36, v36
    v_lshlrev_b32 v111, 16, v111
    v_mul_f32 v37, 0x3f317218, v37
    v_lshlrev_b32 v112, 16, v112
    v_fmac_f32 v36, v36, v37
    v_lshlrev_b32 v113, 16, v113
    v_cvt_pk_bf16_f32 v36, v36, v36
    v_mul_f32 v108, v12, v108
    v_and_b32 v36, 0xffff0000, v36
    v_mul_f32 v109, v12, v109
    v_lshlrev_b32 v115, 16, v115
    v_mul_f32 v110, v12, v110
    v_lshlrev_b32 v116, 16, v116
    v_mul_f32 v111, v12, v111
    v_lshlrev_b32 v117, 16, v117
    v_mul_f32 v16, s4, v108
    v_lshlrev_b32 v118, 16, v118
    v_mul_f32 v17, 0.15915494, v109
    v_lshlrev_b32 v119, 16, v119
    v_mul_f32 v18, v112, v110
    v_lshlrev_b32 v120, 16, v120
    v_fma_f32 v18, -v113, v111, v18
    v_mul_f32 v115, v36, v115
    v_mul_f32 v19, v112, v111
    v_mul_f32 v116, v36, v116
    v_fmac_f32 v19, v113, v110
    v_mul_f32 v117, v36, v117
    ds_write_b128 v3, v[16:19] offset:0
    v_mul_f32 v118, v36, v118
    v_mul_f32 v26, 0x43000000, v16
    v_mul_f32 v40, s4, v115
    v_mul_f32 v27, 0x43000000, v17
    v_mul_f32 v41, 0.15915494, v116
    v_mul_f32 v28, 0x44800000, v16
    v_mul_f32 v42, v119, v117
    v_mul_f32 v29, 0x44800000, v17
    v_fma_f32 v42, -v120, v118, v42
    v_mul_f32 v30, 0x45000000, v16
    v_mul_f32 v43, v119, v118
    v_mul_f32 v31, 0x45000000, v17
    v_fmac_f32 v43, v120, v117
    v_exp_f32 v26, v26
    ds_write_b128 v4, v[40:43] offset:0
    v_fract_f32 v27, v27
    v_mul_f32 v50, 0x43000000, v40
    v_exp_f32 v28, v28
    v_mul_f32 v51, 0x43000000, v41
    v_fract_f32 v29, v29
    v_mul_f32 v52, 0x44800000, v40
    v_exp_f32 v30, v30
    v_mul_f32 v53, 0x44800000, v41
    v_fract_f32 v31, v31
    v_mul_f32 v54, 0x45000000, v40
    v_cos_f32 v20, v27
    v_mul_f32 v55, 0x45000000, v41
    v_sin_f32 v21, v27
    v_exp_f32 v50, v50
    v_cos_f32 v22, v29
    v_fract_f32 v51, v51
    v_sin_f32 v23, v29
    v_exp_f32 v52, v52
    v_cos_f32 v24, v31
    v_fract_f32 v53, v53
    v_sin_f32 v25, v31
    v_exp_f32 v54, v54
    v_mul_f32 v20, v26, v20
    v_fract_f32 v55, v55
    v_mul_f32 v21, v26, v21
    v_cos_f32 v44, v51
    v_mul_f32 v22, v28, v22
    v_sin_f32 v45, v51
    v_mul_f32 v23, v28, v23
    v_cos_f32 v46, v53
    v_mul_f32 v24, v30, v24
    v_sin_f32 v47, v53
    v_mul_f32 v25, v30, v25
    v_cos_f32 v48, v55
    ds_write_b128 v3, v[20:23] offset:16
    v_sin_f32 v49, v55
    v_mul_f32 v24, v18, v24
    v_mul_f32 v44, v50, v44
    v_fma_f32 v24, -v19, v25, v24
    v_mul_f32 v45, v50, v45
    v_mul_f32 v46, v52, v46
    v_mul_f32 v47, v52, v47
    v_mul_f32 v48, v54, v48
    v_mul_f32 v49, v54, v49
    ds_write_b128 v4, v[44:47] offset:16
    v_mul_f32 v48, v42, v48
    v_fma_f32 v48, -v43, v49, v48
    v_add_f32_dpp v24, v24, v24 row_shr:1 row_mask:0xf bank_mask:0xf bound_ctrl:0
    s_nop 0
    v_add_f32_dpp v48, v48, v48 row_shr:1 row_mask:0xf bank_mask:0xf bound_ctrl:0
    v_add_f32_dpp v24, v24, v24 row_shr:2 row_mask:0xf bank_mask:0xf bound_ctrl:0
    s_nop 0
    v_add_f32_dpp v48, v48, v48 row_shr:2 row_mask:0xf bank_mask:0xf bound_ctrl:0
    v_add_f32_dpp v24, v24, v24 row_shr:4 row_mask:0xf bank_mask:0xf bound_ctrl:0
    s_nop 0
    v_add_f32_dpp v48, v48, v48 row_shr:4 row_mask:0xf bank_mask:0xf bound_ctrl:0
    v_add_f32_dpp v24, v24, v24 row_shr:8 row_mask:0xf bank_mask:0xf bound_ctrl:0
    s_nop 0
    v_add_f32_dpp v48, v48, v48 row_shr:8 row_mask:0xf bank_mask:0xf bound_ctrl:0
    v_add_f32_dpp v24, v24, v24 row_bcast:15 row_mask:0xa bank_mask:0xf
    s_nop 0
    v_add_f32_dpp v48, v48, v48 row_bcast:15 row_mask:0xa bank_mask:0xf
    v_add_f32_dpp v24, v24, v24 row_bcast:31 row_mask:0xc bank_mask:0xf
    s_nop 0
    v_add_f32_dpp v48, v48, v48 row_bcast:31 row_mask:0xc bank_mask:0xf
    s_cmp_lt_u32 s3, 2
    s_cselect_b32 s4, -1, 0
    s_cselect_b32 s5, 0, -1
    s_lshl_b32 s13, s3, 9
    s_add_u32 s13, s13, 161792
    v_mov_b32 v3, s13
    v_and_b32 v140, s4, v24
    v_and_b32 v141, s5, v24
    v_mul_f32 v142, 0.5, v48
    s_mov_b32 exec_lo, 0
    s_mov_b32 exec_hi, 0x80000000
    ds_write_b96 v3, v[140:142]
    ds_write_b96 v3, v[140:142] offset:256
    s_mov_b64 exec, -1
    s_cmp_ge_u32 s2, 128
    s_cbranch_scc1 L_role_mod1
    s_waitcnt lgkmcnt(0)
    s_barrier
    s_branch L_role_done1
L_role_mod1:
    s_mov_b32 s6, 0xbfb8aa3b
    v_lshlrev_b32 v7, 2, v0
    v_add_u32 v7, 24576, v7
    v_lshlrev_b32 v124, 16, v124
    v_lshlrev_b32 v125, 16, v125
    v_lshlrev_b32 v126, 16, v126
    v_mul_f32 v16, s6, v124
    v_mul_f32 v20, s6, v125
    v_mul_f32 v24, s6, v126
    v_exp_f32 v16, v16
    v_exp_f32 v20, v20
    v_exp_f32 v24, v24
    v_add_f32 v16, 1.0, v16
    v_add_f32 v20, 1.0, v20
    v_add_f32 v24, 1.0, v24
    v_rcp_f32 v17, v16
    v_rcp_f32 v21, v20
    v_rcp_f32 v25, v24
    v_fma_f32 v18, -v16, v17, 1.0
    v_fma_f32 v22, -v20, v21, 1.0
    v_fma_f32 v26, -v24, v25, 1.0
    v_fmac_f32 v17, v18, v17
    v_fmac_f32 v21, v22, v21
    v_fmac_f32 v25, v26, v25
    v_mul_f32 v18, v124, v17
    v_mul_f32 v22, v125, v21
    v_mul_f32 v26, v126, v25
    v_fma_f32 v19, -v18, v16, v124
    v_fma_f32 v23, -v22, v20, v125
    v_fma_f32 v27, -v26, v24, v126
    v_fmac_f32 v18, v19, v17
    v_fmac_f32 v22, v23, v21
    v_fmac_f32 v26, v27, v25
    v_cvt_pk_bf16_f32 v18, v18, v18
    v_cvt_pk_bf16_f32 v22, v22, v22
    v_cvt_pk_bf16_f32 v26, v26, v26
    v_and_b32 v18, 0xffff0000, v18
    v_and_b32 v22, 0xffff0000, v22
    v_and_b32 v26, 0xffff0000, v26
    ds_write_b32 v7, v18 offset:0
    ds_write_b32 v7, v22 offset:1024
    ds_write_b32 v7, v26 offset:2048
    v_lshlrev_b32 v5, 2, v2
    s_waitcnt lgkmcnt(0)
    s_barrier
    s_cmp_eq_u32 s3, 0
    s_cselect_b64 exec, 15, 0
    buffer_load_dword v189, v5, s[48:51], 0 offen sc1
    s_mov_b64 exec, -1
L_role_done1:
    ds_read_b128 v[108:111], v197 offset:0
    ds_read_b128 v[112:115], v197 offset:16
    ds_read_b128 v[116:119], v197 offset:128
    ds_read_b128 v[120:123], v197 offset:144
    ds_read_b128 v[124:127], v197 offset:256
    ds_read_b128 v[128:131], v197 offset:272
    ds_read_b128 v[132:135], v197 offset:384
    ds_read_b128 v[136:139], v197 offset:400
    v_mov_b32 v8, v104
    v_mov_b32 v9, v104
    v_mov_b32 v10, v106
    v_mov_b32 v11, v106
    v_mov_b32 v6, 0xbf80
    v_mul_u32_u24 v3, 128, v2
    s_and_b32 s101, s2, 63
    s_mul_i32 s101, s101, 128
    s_lshr_b32 s13, s2, 6
    s_lshl_b32 s13, s13, 2
    s_add_u32 s101, s101, s13
    s_add_u32 s101, s101, 1048576
    v_mov_b32 v7, 0xbf800000
    s_waitcnt lgkmcnt(4)
    v_pk_mul_f32 v[140:141], v[108:109], v[8:9]
    v_pk_mul_f32 v[148:149], v[108:109], v[10:11]
    v_pk_mul_f32 v[156:157], v[116:117], v[8:9]
    v_pk_mul_f32 v[164:165], v[116:117], v[10:11]
    v_fract_f32 v141, v141
    v_fract_f32 v149, v149
    v_fract_f32 v157, v157
    v_fract_f32 v165, v165
    s_nop 0
    v_exp_f32 v140, v140
    v_exp_f32 v148, v148
    v_exp_f32 v156, v156
    v_exp_f32 v164, v164
    v_cos_f32 v142, v141
    v_cos_f32 v150, v149
    s_nop 0
    v_cos_f32 v158, v157
    v_cos_f32 v166, v165
    v_sin_f32 v143, v141
    v_sin_f32 v151, v149
    v_sin_f32 v159, v157
    v_sin_f32 v167, v165
    v_pk_mul_f32 v[142:143], v[142:143], v[140:141] op_sel:[0,0] op_sel_hi:[1,0]
    v_pk_mul_f32 v[158:159], v[158:159], v[156:157] op_sel:[0,0] op_sel_hi:[1,0]
    v_pk_mul_f32 v[150:151], v[150:151], v[148:149] op_sel:[0,0] op_sel_hi:[1,0]
    v_pk_mul_f32 v[166:167], v[166:167], v[164:165] op_sel:[0,0] op_sel_hi:[1,0]
    v_pk_mul_f32 v[140:141], v[142:143], v[110:111] op_sel:[0,0] op_sel_hi:[1,0]
    v_pk_mul_f32 v[156:157], v[158:159], v[118:119] op_sel:[0,0] op_sel_hi:[1,0]
    v_pk_mul_f32 v[148:149], v[150:151], v[114:115] op_sel:[0,0] op_sel_hi:[1,0]
    v_pk_mul_f32 v[164:165], v[166:167], v[122:123] op_sel:[0,0] op_sel_hi:[1,0]
    v_pk_fma_f32 v[144:145], v[142:143], v[110:111], v[140:141] op_sel:[1,1,0] op_sel_hi:[0,1,1] neg_lo:[0,1,0] neg_hi:[0,1,1]
    v_pk_fma_f32 v[160:161], v[158:159], v[118:119], v[156:157] op_sel:[1,1,0] op_sel_hi:[0,1,1] neg_lo:[0,1,0] neg_hi:[0,1,1]
    v_pk_fma_f32 v[152:153], v[150:151], v[114:115], v[148:149] op_sel:[1,1,0] op_sel_hi:[0,1,1] neg_lo:[0,1,0] neg_hi:[0,0,0]
    v_pk_fma_f32 v[168:169], v[166:167], v[122:123], v[164:165] op_sel:[1,1,0] op_sel_hi:[0,1,1] neg_lo:[0,1,0] neg_hi:[0,0,0]
    v_pk_mul_f32 v[140:141], v[144:145], v[112:113] op_sel:[0,0] op_sel_hi:[1,0]
    v_pk_mul_f32 v[156:157], v[160:161], v[120:121] op_sel:[0,0] op_sel_hi:[1,0]
    v_cvt_pk_bf16_f32 v60, v150, v151
    v_cvt_pk_bf16_f32 v61, v166, v167
    v_pk_fma_f32 v[146:147], v[144:145], v[112:113], v[140:141] op_sel:[1,1,0] op_sel_hi:[0,1,1] neg_lo:[0,0,0] neg_hi:[0,1,0]
    v_pk_fma_f32 v[162:163], v[160:161], v[120:121], v[156:157] op_sel:[1,1,0] op_sel_hi:[0,1,1] neg_lo:[0,0,0] neg_hi:[0,1,0]
    v_cvt_pk_bf16_f32 v68, v152, v153
    v_cvt_pk_bf16_f32 v69, v168, v169
    v_cvt_pk_bf16_f32 v44, v144, v145
    v_cvt_pk_bf16_f32 v45, v160, v161
    v_cvt_pk_bf16_f32 v52, v146, v147
    v_cvt_pk_bf16_f32 v53, v162, v163
    v_dot2_f32_bf16 v148, v60, v6, v150
    v_dot2_f32_bf16 v164, v61, v6, v166
    v_dot2_f32_bf16 v154, v68, v6, v152
    v_dot2_f32_bf16 v170, v69, v6, v168
    v_dot2_f32_bf16 v142, v44, v6, v144
    v_dot2_f32_bf16 v158, v45, v6, v160
    v_dot2_f32_bf16 v140, v52, v6, v146
    v_dot2_f32_bf16 v156, v53, v6, v162
    v_dot2_f32_bf16 v149, v60, v7, v151
    v_dot2_f32_bf16 v165, v61, v7, v167
    v_dot2_f32_bf16 v155, v68, v7, v153
    v_dot2_f32_bf16 v171, v69, v7, v169
    v_dot2_f32_bf16 v143, v44, v7, v145
    v_dot2_f32_bf16 v159, v45, v7, v161
    v_dot2_f32_bf16 v141, v52, v7, v147
    v_dot2_f32_bf16 v157, v53, v7, v163
    v_cvt_pk_bf16_f32 v64, v148, v149
    v_cvt_pk_bf16_f32 v65, v164, v165
    v_cvt_pk_bf16_f32 v72, v154, v155
    v_cvt_pk_bf16_f32 v73, v170, v171
    v_cvt_pk_bf16_f32 v48, v142, v143
    v_cvt_pk_bf16_f32 v49, v158, v159
    v_cvt_pk_bf16_f32 v56, v140, v141
    v_cvt_pk_bf16_f32 v57, v156, v157
    s_waitcnt lgkmcnt(0)
    v_pk_mul_f32 v[140:141], v[124:125], v[8:9]
    v_pk_mul_f32 v[148:149], v[124:125], v[10:11]
    v_pk_mul_f32 v[156:157], v[132:133], v[8:9]
    v_pk_mul_f32 v[164:165], v[132:133], v[10:11]
    v_fract_f32 v141, v141
    v_fract_f32 v149, v149
    v_fract_f32 v157, v157
    v_fract_f32 v165, v165
    s_nop 0
    ds_read_b128 v[108:111], v197 offset:512
    ds_read_b128 v[112:115], v197 offset:528
    ds_read_b128 v[116:119], v197 offset:640
    ds_read_b128 v[120:123], v197 offset:656
    s_cmp_ge_u32 s2, 128
    s_cbranch_scc1 L_arr_skip0
    s_waitcnt vmcnt(0)
    s_cmp_eq_u32 s3, 0
    s_cselect_b64 exec, 15, 0
    v_cmp_eq_u32 vcc, 0, v189
    s_cbranch_vccnz L_an_slow0
L_an_done0:
    s_mov_b64 exec, -1
    s_barrier
    s_cmp_lg_u32 s3, 0
    s_cbranch_scc1 L_arr_skip0
    s_mov_b64 exec, 1
    buffer_store_dword v5, v5, s[40:43], s101 offen offset:0 sc1
    s_mov_b64 exec, -1
L_arr_skip0:
    v_exp_f32 v140, v140
    v_exp_f32 v148, v148
    v_exp_f32 v156, v156
    v_exp_f32 v164, v164
    v_cos_f32 v142, v141
    v_cos_f32 v150, v149
    s_nop 0
    v_cos_f32 v158, v157
    v_cos_f32 v166, v165
    v_sin_f32 v143, v141
    v_sin_f32 v151, v149
    v_sin_f32 v159, v157
    v_sin_f32 v167, v165
    v_pk_mul_f32 v[142:143], v[142:143], v[140:141] op_sel:[0,0] op_sel_hi:[1,0]
    v_pk_mul_f32 v[158:159], v[158:159], v[156:157] op_sel:[0,0] op_sel_hi:[1,0]
    v_pk_mul_f32 v[150:151], v[150:151], v[148:149] op_sel:[0,0] op_sel_hi:[1,0]
    v_pk_mul_f32 v[166:167], v[166:167], v[164:165] op_sel:[0,0] op_sel_hi:[1,0]
    v_pk_mul_f32 v[140:141], v[142:143], v[126:127] op_sel:[0,0] op_sel_hi:[1,0]
    v_pk_mul_f32 v[156:157], v[158:159], v[134:135] op_sel:[0,0] op_sel_hi:[1,0]
    v_pk_mul_f32 v[148:149], v[150:151], v[130:131] op_sel:[0,0] op_sel_hi:[1,0]
    v_pk_mul_f32 v[164:165], v[166:167], v[138:139] op_sel:[0,0] op_sel_hi:[1,0]
    v_pk_fma_f32 v[144:145], v[142:143], v[126:127], v[140:141] op_sel:[1,1,0] op_sel_hi:[0,1,1] neg_lo:[0,1,0] neg_hi:[0,1,1]
    v_pk_fma_f32 v[160:161], v[158:159], v[134:135], v[156:157] op_sel:[1,1,0] op_sel_hi:[0,1,1] neg_lo:[0,1,0] neg_hi:[0,1,1]
    v_pk_fma_f32 v[152:153], v[150:151], v[130:131], v[148:149] op_sel:[1,1,0] op_sel_hi:[0,1,1] neg_lo:[0,1,0] neg_hi:[0,0,0]
    v_pk_fma_f32 v[168:169], v[166:167], v[138:139], v[164:165] op_sel:[1,1,0] op_sel_hi:[0,1,1] neg_lo:[0,1,0] neg_hi:[0,0,0]
    v_pk_mul_f32 v[140:141], v[144:145], v[128:129] op_sel:[0,0] op_sel_hi:[1,0]
    v_pk_mul_f32 v[156:157], v[160:161], v[136:137] op_sel:[0,0] op_sel_hi:[1,0]
    v_cvt_pk_bf16_f32 v62, v150, v151
    v_cvt_pk_bf16_f32 v63, v166, v167
    v_pk_fma_f32 v[146:147], v[144:145], v[128:129], v[140:141] op_sel:[1,1,0] op_sel_hi:[0,1,1] neg_lo:[0,0,0] neg_hi:[0,1,0]
    v_pk_fma_f32 v[162:163], v[160:161], v[136:137], v[156:157] op_sel:[1,1,0] op_sel_hi:[0,1,1] neg_lo:[0,0,0] neg_hi:[0,1,0]
    v_cvt_pk_bf16_f32 v70, v152, v153
    v_cvt_pk_bf16_f32 v71, v168, v169
    v_cvt_pk_bf16_f32 v46, v144, v145
    v_cvt_pk_bf16_f32 v47, v160, v161
    v_cvt_pk_bf16_f32 v54, v146, v147
    v_cvt_pk_bf16_f32 v55, v162, v163
    v_dot2_f32_bf16 v148, v62, v6, v150
    v_dot2_f32_bf16 v164, v63, v6, v166
    v_dot2_f32_bf16 v154, v70, v6, v152
    v_dot2_f32_bf16 v170, v71, v6, v168
    v_dot2_f32_bf16 v142, v46, v6, v144
    v_dot2_f32_bf16 v158, v47, v6, v160
    v_dot2_f32_bf16 v140, v54, v6, v146
    v_dot2_f32_bf16 v156, v55, v6, v162
    v_dot2_f32_bf16 v149, v62, v7, v151
    v_dot2_f32_bf16 v165, v63, v7, v167
    v_dot2_f32_bf16 v155, v70, v7, v153
    v_dot2_f32_bf16 v171, v71, v7, v169
    v_dot2_f32_bf16 v143, v46, v7, v145
    v_dot2_f32_bf16 v159, v47, v7, v161
    v_dot2_f32_bf16 v141, v54, v7, v147
    v_dot2_f32_bf16 v157, v55, v7, v163
    v_cvt_pk_bf16_f32 v66, v148, v149
    v_cvt_pk_bf16_f32 v67, v164, v165
    v_cvt_pk_bf16_f32 v74, v154, v155
    v_cvt_pk_bf16_f32 v75, v170, v171
    v_cvt_pk_bf16_f32 v50, v142, v143
    v_cvt_pk_bf16_f32 v51, v158, v159
    v_cvt_pk_bf16_f32 v58, v140, v141
    v_cvt_pk_bf16_f32 v59, v156, v157
    s_cmp_ge_u32 s0, 60
    s_cbranch_scc1 L_mod_done
    s_cmp_eq_u32 s3, 0
    s_cselect_b64 exec, 15, 0
    buffer_load_dword v189, v5, s[48:51], 0 offen sc1
    s_mov_b64 exec, -1
    v_lshrrev_b32 v170, 3, v0
    v_mul_u32_u24 v170, 40, v170
    s_add_u32 s7, s61, 24576
    v_add_u32 v170, s7, v170
    v_and_b32 v171, 7, v0
    v_lshrrev_b32 v158, 4, v0
    ds_read_b64 v[140:141], v170 offset:0
    ds_read_b64 v[142:143], v170 offset:8
    ds_read_b64 v[144:145], v170 offset:16
    ds_read_b64 v[146:147], v170 offset:24
    ds_read_b64 v[148:149], v170 offset:32
    v_lshlrev_b32 v171, 5, v171
    v_lshl_add_u32 v171, v158, 8, v171
    v_lshlrev_b32 v170, 2, v0
    s_waitcnt lgkmcnt(0)
    v_lshrrev_b32 v158, 16, v140
    v_lshrrev_b32 v159, 16, v141
    v_lshrrev_b32 v160, 16, v142
    v_lshrrev_b32 v161, 16, v143
    v_lshrrev_b32 v162, 16, v144
    v_lshrrev_b32 v163, 16, v145
    v_lshrrev_b32 v164, 16, v146
    v_lshrrev_b32 v165, 16, v147
    v_lshrrev_b32 v166, 16, v148
    v_lshrrev_b32 v167, 16, v149
    s_waitcnt vmcnt(5) lgkmcnt(0)
    v_dot2_f32_bf16 v150, v232, v158, 0
    v_dot2_f32_bf16 v151, v232, v140, 0
    v_dot2_f32_bf16 v152, v233, v158, 0
    v_dot2_f32_bf16 v153, v233, v140, 0
    v_dot2_f32_bf16 v154, v234, v158, 0
    v_dot2_f32_bf16 v155, v234, v140, 0
    v_dot2_f32_bf16 v156, v235, v158, 0
    v_dot2_f32_bf16 v157, v235, v140, 0
    v_dot2_f32_bf16 v150, v236, v159, v150
    v_dot2_f32_bf16 v151, v236, v141, v151
    v_dot2_f32_bf16 v152, v237, v159, v152
    v_dot2_f32_bf16 v153, v237, v141, v153
    v_dot2_f32_bf16 v154, v238, v159, v154
    v_dot2_f32_bf16 v155, v238, v141, v155
    v_dot2_f32_bf16 v156, v239, v159, v156
    v_dot2_f32_bf16 v157, v239, v141, v157
    v_dot2_f32_bf16 v150, v240, v160, v150
    v_dot2_f32_bf16 v151, v240, v142, v151
    v_dot2_f32_bf16 v152, v241, v160, v152
    v_dot2_f32_bf16 v153, v241, v142, v153
    v_dot2_f32_bf16 v154, v242, v160, v154
    v_dot2_f32_bf16 v155, v242, v142, v155
    v_dot2_f32_bf16 v156, v243, v160, v156
    v_dot2_f32_bf16 v157, v243, v142, v157
    v_dot2_f32_bf16 v150, v244, v161, v150
    v_dot2_f32_bf16 v151, v244, v143, v151
    v_dot2_f32_bf16 v152, v245, v161, v152
    v_dot2_f32_bf16 v153, v245, v143, v153
    v_dot2_f32_bf16 v154, v246, v161, v154
    v_dot2_f32_bf16 v155, v246, v143, v155
    v_dot2_f32_bf16 v156, v247, v161, v156
    v_dot2_f32_bf16 v157, v247, v143, v157
    v_dot2_f32_bf16 v150, v248, v162, v150
    v_dot2_f32_bf16 v151, v248, v144, v151
    v_dot2_f32_bf16 v152, v249, v162, v152
    v_dot2_f32_bf16 v153, v249, v144, v153
    v_dot2_f32_bf16 v154, v250, v162, v154
    v_dot2_f32_bf16 v155, v250, v144, v155
    v_dot2_f32_bf16 v156, v251, v162, v156
    v_dot2_f32_bf16 v157, v251, v144, v157
    v_dot2_f32_bf16 v150, v252, v163, v150
    v_dot2_f32_bf16 v151, v252, v145, v151
    v_dot2_f32_bf16 v152, v253, v163, v152
    v_dot2_f32_bf16 v153, v253, v145, v153
    v_dot2_f32_bf16 v154, v254, v163, v154
    v_dot2_f32_bf16 v155, v254, v145, v155
    v_dot2_f32_bf16 v156, v255, v163, v156
    v_dot2_f32_bf16 v157, v255, v145, v157
    v_dot2_f32_bf16 v150, v172, v164, v150
    v_dot2_f32_bf16 v151, v172, v146, v151
    v_dot2_f32_bf16 v152, v173, v164, v152
    v_dot2_f32_bf16 v153, v173, v146, v153
    v_dot2_f32_bf16 v154, v174, v164, v154
    v_dot2_f32_bf16 v155, v174, v146, v155
    v_dot2_f32_bf16 v156, v175, v164, v156
    v_dot2_f32_bf16 v157, v175, v146, v157
    v_dot2_f32_bf16 v150, v176, v165, v150
    v_dot2_f32_bf16 v151, v176, v147, v151
    v_dot2_f32_bf16 v152, v177, v165, v152
    v_dot2_f32_bf16 v153, v177, v147, v153
    v_dot2_f32_bf16 v154, v178, v165, v154
    v_dot2_f32_bf16 v155, v178, v147, v155
    v_dot2_f32_bf16 v156, v179, v165, v156
    v_dot2_f32_bf16 v157, v179, v147, v157
    v_dot2_f32_bf16 v150, v180, v166, v150
    v_dot2_f32_bf16 v151, v180, v148, v151
    v_dot2_f32_bf16 v152, v181, v166, v152
    v_dot2_f32_bf16 v153, v181, v148, v153
    v_dot2_f32_bf16 v154, v182, v166, v154
    v_dot2_f32_bf16 v155, v182, v148, v155
    v_dot2_f32_bf16 v156, v183, v166, v156
    v_dot2_f32_bf16 v157, v183, v148, v157
    v_dot2_f32_bf16 v150, v184, v167, v150
    v_dot2_f32_bf16 v151, v184, v149, v151
    v_dot2_f32_bf16 v152, v185, v167, v152
    v_dot2_f32_bf16 v153, v185, v149, v153
    v_dot2_f32_bf16 v154, v186, v167, v154
    v_dot2_f32_bf16 v155, v186, v149, v155
    v_dot2_f32_bf16 v156, v187, v167, v156
    v_dot2_f32_bf16 v157, v187, v149, v157
    v_add_f32_dpp v150, v150, v150 row_ror:8 row_mask:0xf bank_mask:0xf
    v_add_f32_dpp v151, v151, v151 row_ror:8 row_mask:0xf bank_mask:0xf
    v_add_f32_dpp v152, v152, v152 row_ror:8 row_mask:0xf bank_mask:0xf
    v_add_f32_dpp v153, v153, v153 row_ror:8 row_mask:0xf bank_mask:0xf
    v_add_f32_dpp v154, v154, v154 row_ror:8 row_mask:0xf bank_mask:0xf
    v_add_f32_dpp v155, v155, v155 row_ror:8 row_mask:0xf bank_mask:0xf
    v_add_f32_dpp v156, v156, v156 row_ror:8 row_mask:0xf bank_mask:0xf
    v_add_f32_dpp v157, v157, v157 row_ror:8 row_mask:0xf bank_mask:0xf
    s_mov_b32 exec_lo, 0x00ff00ff
    s_mov_b32 exec_hi, 0x00ff00ff
    ds_write_b128 v171, v[150:153] offset:28672
    ds_write_b128 v171, v[154:157] offset:28688
    s_mov_b64 exec, -1
    s_cmp_eq_u32 s3, 0
    s_cbranch_scc1 L_mod_w0
    s_waitcnt vmcnt(0)
L_mod_w0:
    s_waitcnt vmcnt(1) lgkmcnt(0)
    s_barrier
    ds_read_b64_tr_b16 a[236:237], v195 offset:0
    ds_read_b64_tr_b16 a[238:239], v196 offset:0
    ds_read_b64_tr_b16 a[240:241], v195 offset:4096
    ds_read_b64_tr_b16 a[242:243], v196 offset:4096
    ds_read_b64_tr_b16 a[244:245], v195 offset:8192
    ds_read_b64_tr_b16 a[246:247], v196 offset:8192
    ds_read_b64_tr_b16 a[248:249], v195 offset:12288
    ds_read_b64_tr_b16 a[250:251], v196 offset:12288
    ds_read_b64_tr_b16 a[252:253], v195 offset:16384
    ds_read_b64_tr_b16 a[254:255], v196 offset:16384
    s_cmp_lg_u32 s3, 0
    s_cbranch_scc1 L_mod_d1
    ds_read2st64_b32 v[140:141], v170 offset0:112 offset1:113
    ds_read2st64_b32 v[142:143], v170 offset0:114 offset1:115
    ds_read2st64_b32 v[144:145], v170 offset0:116 offset1:117
    ds_read2st64_b32 v[146:147], v170 offset0:118 offset1:119
    ds_read2st64_b32 v[148:149], v170 offset0:120 offset1:121
    ds_read2st64_b32 v[150:151], v170 offset0:122 offset1:123
    ds_read2st64_b32 v[152:153], v170 offset0:124 offset1:125
    ds_read2st64_b32 v[154:155], v170 offset0:126 offset1:127
    v_lshlrev_b32 v170, 3, v0
    s_waitcnt lgkmcnt(6)
    v_cvt_f64_f32 v[232:233], v140
    v_cvt_f64_f32 v[234:235], v141
    v_cvt_f64_f32 v[236:237], v142
    v_cvt_f64_f32 v[238:239], v143
    s_waitcnt lgkmcnt(4)
    v_cvt_f64_f32 v[240:241], v144
    v_cvt_f64_f32 v[242:243], v145
    v_cvt_f64_f32 v[244:245], v146
    v_cvt_f64_f32 v[246:247], v147
    s_waitcnt lgkmcnt(2)
    v_cvt_f64_f32 v[248:249], v148
    v_cvt_f64_f32 v[250:251], v149
    v_cvt_f64_f32 v[252:253], v150
    v_cvt_f64_f32 v[254:255], v151
    s_waitcnt lgkmcnt(0)
    v_cvt_f64_f32 v[172:173], v152
    v_cvt_f64_f32 v[174:175], v153
    v_cvt_f64_f32 v[176:177], v154
    v_cvt_f64_f32 v[178:179], v155
    v_add_f64 v[232:233], v[232:233], v[234:235]
    v_add_f64 v[236:237], v[236:237], v[238:239]
    v_add_f64 v[240:241], v[240:241], v[242:243]
    v_add_f64 v[244:245], v[244:245], v[246:247]
    v_add_f64 v[248:249], v[248:249], v[250:251]
    v_add_f64 v[252:253], v[252:253], v[254:255]
    v_add_f64 v[172:173], v[172:173], v[174:175]
    v_add_f64 v[176:177], v[176:177], v[178:179]
    v_add_f64 v[232:233], v[232:233], v[236:237]
    v_add_f64 v[240:241], v[240:241], v[244:245]
    v_add_f64 v[248:249], v[248:249], v[252:253]
    v_add_f64 v[172:173], v[172:173], v[176:177]
    v_add_f64 v[232:233], v[232:233], v[240:241]
    v_add_f64 v[248:249], v[248:249], v[172:173]
    v_add_f64 v[232:233], v[232:233], v[248:249]
    s_waitcnt vmcnt(0)
    s_cmp_eq_u32 s3, 0
    s_cselect_b64 exec, 15, 0
    v_cmp_eq_u32 vcc, 0, v189
    s_cbranch_vccnz L_an_slow2
L_an_done2:
    s_mov_b64 exec, -1
    s_nop 0
    buffer_store_dwordx2 v[232:233], v170, s[40:43], s62 offen sc1
L_mod_d1:
    s_waitcnt lgkmcnt(0)
    s_add_u32 s13, s66, 0
    buffer_store_dwordx4 a[236:239], v226, s[40:43], s13 offen sc1
    s_add_u32 s13, s66, 4096
    buffer_store_dwordx4 a[240:243], v226, s[40:43], s13 offen sc1
    s_add_u32 s13, s66, 8192
    buffer_store_dwordx4 a[244:247], v226, s[40:43], s13 offen sc1
    s_add_u32 s13, s66, 12288
    buffer_store_dwordx4 a[248:251], v226, s[40:43], s13 offen sc1
    s_add_u32 s13, s66, 16384
    buffer_store_dwordx4 a[252:255], v226, s[40:43], s13 offen sc1
L_mod_done:
    s_waitcnt lgkmcnt(0)
    v_pk_mul_f32 v[140:141], v[108:109], v[8:9]
    v_pk_mul_f32 v[148:149], v[108:109], v[10:11]
    v_pk_mul_f32 v[156:157], v[116:117], v[8:9]
    v_pk_mul_f32 v[164:165], v[116:117], v[10:11]
    v_mfma_f32_16x16x32_bf16 v[12:15], v[60:63], v[44:47], 0
    ds_read_b128 v[124:127], v197 offset:768
    ds_read_b128 v[128:131], v197 offset:784
    ds_read_b128 v[132:135], v197 offset:896
    ds_read_b128 v[136:139], v197 offset:912
    v_fract_f32 v141, v141
    v_fract_f32 v149, v149
    v_fract_f32 v157, v157
    v_fract_f32 v165, v165
    v_mfma_f32_16x16x32_bf16 v[16:19], v[60:63], v[52:55], 0
    s_cmp_lt_u32 s2, 128
    s_cselect_b32 s46, s46, 0
    s_cselect_b32 s13, 0x70000000, 0
    v_or_b32 v249, s13, v226
    s_cselect_b32 s13, 0, 0x70000000
    v_or_b32 v226, s13, v226
    s_cselect_b32 s13, 0, 36864
    s_add_u32 s60, s60, s13
    v_exp_f32 v140, v140
    v_exp_f32 v148, v148
    v_mfma_f32_16x16x32_bf16 v[20:23], v[68:71], v[44:47], 0
    s_add_u32 m0, s60, 0
    s_nop 0
    buffer_load_dwordx4 v188, s[44:47], s80 offen lds
    v_mov_b32 v190, 0
    v_exp_f32 v156, v156
    v_exp_f32 v164, v164
    v_mfma_f32_16x16x32_bf16 v[24:27], v[68:71], v[52:55], 0
    v_mov_b32 v191, 0
    v_mov_b32 v192, 0
    v_mov_b32 v193, 0
    v_cos_f32 v142, v141
    v_cos_f32 v150, v149
    v_mfma_f32_16x16x32_bf16 v[12:15], v[60:63], v[48:51], v[12:15]
    ds_write_b128 v217, v[190:193]
    v_cos_f32 v158, v157
    v_cos_f32 v166, v165
    v_mfma_f32_16x16x32_bf16 v[16:19], v[60:63], v[56:59], v[16:19]
    s_lshr_b32 s26, s2, 5
    s_mul_i32 s100, s26, 5120
    s_add_u32 s100, s100, 24117248
    v_add_u32 v230, s100, v1
    v_add_u32 v231, 0x1000, v230
    v_sin_f32 v143, v141
    v_sin_f32 v151, v149
    v_sin_f32 v159, v157
    v_sin_f32 v167, v165
    v_pk_mul_f32 v[142:143], v[142:143], v[140:141] op_sel:[0,0] op_sel_hi:[1,0]
    v_pk_mul_f32 v[158:159], v[158:159], v[156:157] op_sel:[0,0] op_sel_hi:[1,0]
    v_pk_mul_f32 v[150:151], v[150:151], v[148:149] op_sel:[0,0] op_sel_hi:[1,0]
    v_pk_mul_f32 v[166:167], v[166:167], v[164:165] op_sel:[0,0] op_sel_hi:[1,0]
    v_pk_mul_f32 v[140:141], v[142:143], v[110:111] op_sel:[0,0] op_sel_hi:[1,0]
    v_pk_mul_f32 v[156:157], v[158:159], v[118:119] op_sel:[0,0] op_sel_hi:[1,0]
    v_pk_mul_f32 v[148:149], v[150:151], v[114:115] op_sel:[0,0] op_sel_hi:[1,0]
    v_pk_mul_f32 v[164:165], v[166:167], v[122:123] op_sel:[0,0] op_sel_hi:[1,0]
    v_pk_fma_f32 v[144:145], v[142:143], v[110:111], v[140:141] op_sel:[1,1,0] op_sel_hi:[0,1,1] neg_lo:[0,1,0] neg_hi:[0,1,1]
    v_pk_fma_f32 v[160:161], v[158:159], v[118:119], v[156:157] op_sel:[1,1,0] op_sel_hi:[0,1,1] neg_lo:[0,1,0] neg_hi:[0,1,1]
    v_pk_fma_f32 v[152:153], v[150:151], v[114:115], v[148:149] op_sel:[1,1,0] op_sel_hi:[0,1,1] neg_lo:[0,1,0] neg_hi:[0,0,0]
    v_pk_fma_f32 v[168:169], v[166:167], v[122:123], v[164:165] op_sel:[1,1,0] op_sel_hi:[0,1,1] neg_lo:[0,1,0] neg_hi:[0,0,0]
    v_pk_mul_f32 v[140:141], v[144:145], v[112:113] op_sel:[0,0] op_sel_hi:[1,0]
    v_pk_mul_f32 v[156:157], v[160:161], v[120:121] op_sel:[0,0] op_sel_hi:[1,0]
    v_cvt_pk_bf16_f32 v92, v150, v151
    v_cvt_pk_bf16_f32 v93, v166, v167
    v_pk_fma_f32 v[146:147], v[144:145], v[112:113], v[140:141] op_sel:[1,1,0] op_sel_hi:[0,1,1] neg_lo:[0,0,0] neg_hi:[0,1,0]
    v_pk_fma_f32 v[162:163], v[160:161], v[120:121], v[156:157] op_sel:[1,1,0] op_sel_hi:[0,1,1] neg_lo:[0,0,0] neg_hi:[0,1,0]
    v_cvt_pk_bf16_f32 v100, v152, v153
    v_cvt_pk_bf16_f32 v101, v168, v169
    v_cvt_pk_bf16_f32 v76, v144, v145
    v_cvt_pk_bf16_f32 v77, v160, v161
    v_cvt_pk_bf16_f32 v84, v146, v147
    v_cvt_pk_bf16_f32 v85, v162, v163
    v_dot2_f32_bf16 v148, v92, v6, v150
    v_dot2_f32_bf16 v164, v93, v6, v166
    v_dot2_f32_bf16 v154, v100, v6, v152
    v_dot2_f32_bf16 v170, v101, v6, v168
    v_dot2_f32_bf16 v142, v76, v6, v144
    v_dot2_f32_bf16 v158, v77, v6, v160
    v_dot2_f32_bf16 v140, v84, v6, v146
    v_dot2_f32_bf16 v156, v85, v6, v162
    v_dot2_f32_bf16 v149, v92, v7, v151
    v_dot2_f32_bf16 v165, v93, v7, v167
    v_dot2_f32_bf16 v155, v100, v7, v153
    v_dot2_f32_bf16 v171, v101, v7, v169
    v_dot2_f32_bf16 v143, v76, v7, v145
    v_dot2_f32_bf16 v159, v77, v7, v161
    v_dot2_f32_bf16 v141, v84, v7, v147
    v_dot2_f32_bf16 v157, v85, v7, v163
    v_cvt_pk_bf16_f32 v96, v148, v149
    v_cvt_pk_bf16_f32 v97, v164, v165
    v_cvt_pk_bf16_f32 v104, v154, v155
    v_cvt_pk_bf16_f32 v105, v170, v171
    v_cvt_pk_bf16_f32 v80, v142, v143
    v_cvt_pk_bf16_f32 v81, v158, v159
    v_cvt_pk_bf16_f32 v88, v140, v141
    v_cvt_pk_bf16_f32 v89, v156, v157
    s_waitcnt lgkmcnt(1)
    v_pk_mul_f32 v[140:141], v[124:125], v[8:9]
    v_pk_mul_f32 v[148:149], v[124:125], v[10:11]
    v_pk_mul_f32 v[156:157], v[132:133], v[8:9]
    v_pk_mul_f32 v[164:165], v[132:133], v[10:11]
    v_mfma_f32_16x16x32_bf16 v[20:23], v[68:71], v[48:51], v[20:23]
    ds_read_b128 v[108:111], v197 offset:4096
    ds_read_b128 v[112:115], v197 offset:4112
    ds_read_b128 v[116:119], v197 offset:4224
    ds_read_b128 v[120:123], v197 offset:4240
    v_lshlrev_b32 v250, 3, v2
    v_fract_f32 v141, v141
    v_fract_f32 v149, v149
    v_fract_f32 v157, v157
    v_fract_f32 v165, v165
    v_mfma_f32_16x16x32_bf16 v[24:27], v[68:71], v[56:59], v[24:27]
    s_add_u32 m0, s60, 4096
    s_nop 0
    buffer_load_dwordx4 v188, s[44:47], s81 offen lds
    v_mov_b32 v232, -1
    v_exp_f32 v140, v140
    v_exp_f32 v148, v148
    v_mfma_f32_16x16x32_bf16 v[12:15], v[64:67], v[44:47], v[12:15]
    v_mov_b32 v233, -1
    v_mov_b32 v234, -1
    v_mov_b32 v235, -1
    s_mul_i32 s74, s2, 10240
    s_add_u32 s74, s74, 8388608
    v_exp_f32 v156, v156
    v_exp_f32 v164, v164
    v_mfma_f32_16x16x32_bf16 v[16:19], v[64:67], v[52:55], v[16:19]
    v_cos_f32 v142, v141
    v_cos_f32 v150, v149
    v_mfma_f32_16x16x32_bf16 v[20:23], v[72:75], v[44:47], v[20:23]
    v_cos_f32 v158, v157
    v_cos_f32 v166, v165
    v_mfma_f32_16x16x32_bf16 v[24:27], v[72:75], v[52:55], v[24:27]
    s_add_u32 m0, s60, 8192
    s_nop 0
    buffer_load_dwordx4 v188, s[44:47], s82 offen lds
    v_sin_f32 v143, v141
    v_sin_f32 v151, v149
    v_sin_f32 v159, v157
    v_sin_f32 v167, v165
    v_pk_mul_f32 v[142:143], v[142:143], v[140:141] op_sel:[0,0] op_sel_hi:[1,0]
    v_pk_mul_f32 v[158:159], v[158:159], v[156:157] op_sel:[0,0] op_sel_hi:[1,0]
    v_pk_mul_f32 v[150:151], v[150:151], v[148:149] op_sel:[0,0] op_sel_hi:[1,0]
    v_pk_mul_f32 v[166:167], v[166:167], v[164:165] op_sel:[0,0] op_sel_hi:[1,0]
    v_pk_mul_f32 v[140:141], v[142:143], v[126:127] op_sel:[0,0] op_sel_hi:[1,0]
    v_pk_mul_f32 v[156:157], v[158:159], v[134:135] op_sel:[0,0] op_sel_hi:[1,0]
    v_pk_mul_f32 v[148:149], v[150:151], v[130:131] op_sel:[0,0] op_sel_hi:[1,0]
    v_pk_mul_f32 v[164:165], v[166:167], v[138:139] op_sel:[0,0] op_sel_hi:[1,0]
    v_pk_fma_f32 v[144:145], v[142:143], v[126:127], v[140:141] op_sel:[1,1,0] op_sel_hi:[0,1,1] neg_lo:[0,1,0] neg_hi:[0,1,1]
    v_pk_fma_f32 v[160:161], v[158:159], v[134:135], v[156:157] op_sel:[1,1,0] op_sel_hi:[0,1,1] neg_lo:[0,1,0] neg_hi:[0,1,1]
    v_pk_fma_f32 v[152:153], v[150:151], v[130:131], v[148:149] op_sel:[1,1,0] op_sel_hi:[0,1,1] neg_lo:[0,1,0] neg_hi:[0,0,0]
    v_pk_fma_f32 v[168:169], v[166:167], v[138:139], v[164:165] op_sel:[1,1,0] op_sel_hi:[0,1,1] neg_lo:[0,1,0] neg_hi:[0,0,0]
    v_pk_mul_f32 v[140:141], v[144:145], v[128:129] op_sel:[0,0] op_sel_hi:[1,0]
    v_pk_mul_f32 v[156:157], v[160:161], v[136:137] op_sel:[0,0] op_sel_hi:[1,0]
    v_cvt_pk_bf16_f32 v94, v150, v151
    v_cvt_pk_bf16_f32 v95, v166, v167
    v_pk_fma_f32 v[146:147], v[144:145], v[128:129], v[140:141] op_sel:[1,1,0] op_sel_hi:[0,1,1] neg_lo:[0,0,0] neg_hi:[0,1,0]
    v_pk_fma_f32 v[162:163], v[160:161], v[136:137], v[156:157] op_sel:[1,1,0] op_sel_hi:[0,1,1] neg_lo:[0,0,0] neg_hi:[0,1,0]
    v_cvt_pk_bf16_f32 v102, v152, v153
    v_cvt_pk_bf16_f32 v103, v168, v169
    v_cvt_pk_bf16_f32 v78, v144, v145
    v_cvt_pk_bf16_f32 v79, v160, v161
    v_cvt_pk_bf16_f32 v86, v146, v147
    v_cvt_pk_bf16_f32 v87, v162, v163
    v_dot2_f32_bf16 v148, v94, v6, v150
    v_dot2_f32_bf16 v164, v95, v6, v166
    v_dot2_f32_bf16 v154, v102, v6, v152
    v_dot2_f32_bf16 v170, v103, v6, v168
    v_dot2_f32_bf16 v142, v78, v6, v144
    v_dot2_f32_bf16 v158, v79, v6, v160
    v_dot2_f32_bf16 v140, v86, v6, v146
    v_dot2_f32_bf16 v156, v87, v6, v162
    v_dot2_f32_bf16 v149, v94, v7, v151
    v_dot2_f32_bf16 v165, v95, v7, v167
    v_dot2_f32_bf16 v155, v102, v7, v153
    v_dot2_f32_bf16 v171, v103, v7, v169
    v_dot2_f32_bf16 v143, v78, v7, v145
    v_dot2_f32_bf16 v159, v79, v7, v161
    v_dot2_f32_bf16 v141, v86, v7, v147
    v_dot2_f32_bf16 v157, v87, v7, v163
    v_cvt_pk_bf16_f32 v98, v148, v149
    v_cvt_pk_bf16_f32 v99, v164, v165
    v_cvt_pk_bf16_f32 v106, v154, v155
    v_cvt_pk_bf16_f32 v107, v170, v171
    v_cvt_pk_bf16_f32 v82, v142, v143
    v_cvt_pk_bf16_f32 v83, v158, v159
    v_cvt_pk_bf16_f32 v90, v140, v141
    v_cvt_pk_bf16_f32 v91, v156, v157
    s_waitcnt lgkmcnt(0)
    v_pk_mul_f32 v[140:141], v[108:109], v[8:9]
    v_pk_mul_f32 v[148:149], v[108:109], v[10:11]
    v_pk_mul_f32 v[156:157], v[116:117], v[8:9]
    v_pk_mul_f32 v[164:165], v[116:117], v[10:11]
    v_mfma_f32_16x16x32_bf16 v[12:15], v[92:95], v[76:79], v[12:15]
    ds_read_b128 v[124:127], v197 offset:4352
    ds_read_b128 v[128:131], v197 offset:4368
    ds_read_b128 v[132:135], v197 offset:4480
    ds_read_b128 v[136:139], v197 offset:4496
    v_fract_f32 v141, v141
    v_fract_f32 v149, v149
    v_fract_f32 v157, v157
    v_fract_f32 v165, v165
    v_mfma_f32_16x16x32_bf16 v[16:19], v[92:95], v[84:87], v[16:19]
    s_add_u32 m0, s60, 12288
    s_nop 0
    buffer_load_dwordx4 v188, s[44:47], s83 offen lds
    v_exp_f32 v140, v140
    v_exp_f32 v148, v148
    v_mfma_f32_16x16x32_bf16 v[20:23], v[100:103], v[76:79], v[20:23]
    s_cmp_lt_u32 s2, 128
    s_cbranch_scc1 L_arr_skip1
    s_waitcnt vmcnt(4)
    s_cmp_eq_u32 s3, 0
    s_cselect_b64 exec, 15, 0
    v_cmp_eq_u32 vcc, 0, v189
    s_cbranch_vccnz L_an_slow1
L_an_done1:
    s_mov_b64 exec, -1
    s_barrier
    s_cmp_lg_u32 s3, 0
    s_cbranch_scc1 L_arr_skip1
    s_mov_b64 exec, 1
    buffer_store_dword v5, v5, s[40:43], s101 offen offset:0 sc1
    s_mov_b64 exec, -1
L_arr_skip1:
    v_exp_f32 v156, v156
    v_exp_f32 v164, v164
    v_mfma_f32_16x16x32_bf16 v[24:27], v[100:103], v[84:87], v[24:27]
    s_add_u32 m0, s60, 16384
    s_nop 0
    buffer_load_dwordx4 v188, s[44:47], s84 offen lds
    v_cos_f32 v142, v141
    v_cos_f32 v150, v149
    v_mfma_f32_16x16x32_bf16 v[12:15], v[92:95], v[80:83], v[12:15]
    v_cos_f32 v158, v157
    v_cos_f32 v166, v165
    v_mfma_f32_16x16x32_bf16 v[16:19], v[92:95], v[88:91], v[16:19]
    v_sin_f32 v143, v141
    v_sin_f32 v151, v149
    v_sin_f32 v159, v157
    v_sin_f32 v167, v165
    v_pk_mul_f32 v[142:143], v[142:143], v[140:141] op_sel:[0,0] op_sel_hi:[1,0]
    v_pk_mul_f32 v[158:159], v[158:159], v[156:157] op_sel:[0,0] op_sel_hi:[1,0]
    v_pk_mul_f32 v[150:151], v[150:151], v[148:149] op_sel:[0,0] op_sel_hi:[1,0]
    v_pk_mul_f32 v[166:167], v[166:167], v[164:165] op_sel:[0,0] op_sel_hi:[1,0]
    v_pk_mul_f32 v[140:141], v[142:143], v[110:111] op_sel:[0,0] op_sel_hi:[1,0]
    v_pk_mul_f32 v[156:157], v[158:159], v[118:119] op_sel:[0,0] op_sel_hi:[1,0]
    v_pk_mul_f32 v[148:149], v[150:151], v[114:115] op_sel:[0,0] op_sel_hi:[1,0]
    v_pk_mul_f32 v[164:165], v[166:167], v[122:123] op_sel:[0,0] op_sel_hi:[1,0]
    v_pk_fma_f32 v[144:145], v[142:143], v[110:111], v[140:141] op_sel:[1,1,0] op_sel_hi:[0,1,1] neg_lo:[0,1,0] neg_hi:[0,1,1]
    v_pk_fma_f32 v[160:161], v[158:159], v[118:119], v[156:157] op_sel:[1,1,0] op_sel_hi:[0,1,1] neg_lo:[0,1,0] neg_hi:[0,1,1]
    v_pk_fma_f32 v[152:153], v[150:151], v[114:115], v[148:149] op_sel:[1,1,0] op_sel_hi:[0,1,1] neg_lo:[0,1,0] neg_hi:[0,0,0]
    v_pk_fma_f32 v[168:169], v[166:167], v[122:123], v[164:165] op_sel:[1,1,0] op_sel_hi:[0,1,1] neg_lo:[0,1,0] neg_hi:[0,0,0]
    v_pk_mul_f32 v[140:141], v[144:145], v[112:113] op_sel:[0,0] op_sel_hi:[1,0]
    v_pk_mul_f32 v[156:157], v[160:161], v[120:121] op_sel:[0,0] op_sel_hi:[1,0]
    v_cvt_pk_bf16_f32 v60, v150, v151
    v_cvt_pk_bf16_f32 v61, v166, v167
    v_pk_fma_f32 v[146:147], v[144:145], v[112:113], v[140:141] op_sel:[1,1,0] op_sel_hi:[0,1,1] neg_lo:[0,0,0] neg_hi:[0,1,0]
    v_pk_fma_f32 v[162:163], v[160:161], v[120:121], v[156:157] op_sel:[1,1,0] op_sel_hi:[0,1,1] neg_lo:[0,0,0] neg_hi:[0,1,0]
    v_cvt_pk_bf16_f32 v68, v152, v153
    v_cvt_pk_bf16_f32 v69, v168, v169
    v_cvt_pk_bf16_f32 v44, v144, v145
    v_cvt_pk_bf16_f32 v45, v160, v161
    v_cvt_pk_bf16_f32 v52, v146, v147
    v_cvt_pk_bf16_f32 v53, v162, v163
    v_dot2_f32_bf16 v148, v60, v6, v150
    v_dot2_f32_bf16 v164, v61, v6, v166
    v_dot2_f32_bf16 v154, v68, v6, v152
    v_dot2_f32_bf16 v170, v69, v6, v168
    v_dot2_f32_bf16 v142, v44, v6, v144
    v_dot2_f32_bf16 v158, v45, v6, v160
    v_dot2_f32_bf16 v140, v52, v6, v146
    v_dot2_f32_bf16 v156, v53, v6, v162
    v_dot2_f32_bf16 v149, v60, v7, v151
    v_dot2_f32_bf16 v165, v61, v7, v167
    v_dot2_f32_bf16 v155, v68, v7, v153
    v_dot2_f32_bf16 v171, v69, v7, v169
    v_dot2_f32_bf16 v143, v44, v7, v145
    v_dot2_f32_bf16 v159, v45, v7, v161
    v_dot2_f32_bf16 v141, v52, v7, v147
    v_dot2_f32_bf16 v157, v53, v7, v163
    v_cvt_pk_bf16_f32 v64, v148, v149
    v_cvt_pk_bf16_f32 v65, v164, v165
    v_cvt_pk_bf16_f32 v72, v154, v155
    v_cvt_pk_bf16_f32 v73, v170, v171
    v_cvt_pk_bf16_f32 v48, v142, v143
    v_cvt_pk_bf16_f32 v49, v158, v159
    v_cvt_pk_bf16_f32 v56, v140, v141
    v_cvt_pk_bf16_f32 v57, v156, v157
    s_waitcnt lgkmcnt(0)
    v_pk_mul_f32 v[140:141], v[124:125], v[8:9]
    v_pk_mul_f32 v[148:149], v[124:125], v[10:11]
    v_pk_mul_f32 v[156:157], v[132:133], v[8:9]
    v_pk_mul_f32 v[164:165], v[132:133], v[10:11]
    v_mfma_f32_16x16x32_bf16 v[20:23], v[100:103], v[80:83], v[20:23]
    ds_read_b128 v[108:111], v197 offset:4608
    ds_read_b128 v[112:115], v197 offset:4624
    ds_read_b128 v[116:119], v197 offset:4736
    ds_read_b128 v[120:123], v197 offset:4752
    v_fract_f32 v141, v141
    v_fract_f32 v149, v149
    v_fract_f32 v157, v157
    v_fract_f32 v165, v165
    v_mfma_f32_16x16x32_bf16 v[24:27], v[100:103], v[88:91], v[24:27]
    buffer_store_dwordx4 v[232:235], v227, s[40:43], s74 offen sc1
    v_exp_f32 v140, v140
    v_exp_f32 v148, v148
    v_mfma_f32_16x16x32_bf16 v[12:15], v[96:99], v[76:79], v[12:15]
    v_exp_f32 v156, v156
    v_exp_f32 v164, v164
    v_mfma_f32_16x16x32_bf16 v[16:19], v[96:99], v[84:87], v[16:19]
    v_cos_f32 v142, v141
    v_cos_f32 v150, v149
    v_mfma_f32_16x16x32_bf16 v[20:23], v[104:107], v[76:79], v[20:23]
    v_cos_f32 v158, v157
    v_cos_f32 v166, v165
    v_mfma_f32_16x16x32_bf16 v[24:27], v[104:107], v[84:87], v[24:27]
    v_sin_f32 v143, v141
    v_sin_f32 v151, v149
    v_sin_f32 v159, v157
    v_sin_f32 v167, v165
    v_pk_mul_f32 v[142:143], v[142:143], v[140:141] op_sel:[0,0] op_sel_hi:[1,0]
    v_pk_mul_f32 v[158:159], v[158:159], v[156:157] op_sel:[0,0] op_sel_hi:[1,0]
    v_pk_mul_f32 v[150:151], v[150:151], v[148:149] op_sel:[0,0] op_sel_hi:[1,0]
    v_pk_mul_f32 v[166:167], v[166:167], v[164:165] op_sel:[0,0] op_sel_hi:[1,0]
    v_pk_mul_f32 v[140:141], v[142:143], v[126:127] op_sel:[0,0] op_sel_hi:[1,0]
    v_pk_mul_f32 v[156:157], v[158:159], v[134:135] op_sel:[0,0] op_sel_hi:[1,0]
    v_pk_mul_f32 v[148:149], v[150:151], v[130:131] op_sel:[0,0] op_sel_hi:[1,0]
    v_pk_mul_f32 v[164:165], v[166:167], v[138:139] op_sel:[0,0] op_sel_hi:[1,0]
    v_pk_fma_f32 v[144:145], v[142:143], v[126:127], v[140:141] op_sel:[1,1,0] op_sel_hi:[0,1,1] neg_lo:[0,1,0] neg_hi:[0,1,1]
    v_pk_fma_f32 v[160:161], v[158:159], v[134:135], v[156:157] op_sel:[1,1,0] op_sel_hi:[0,1,1] neg_lo:[0,1,0] neg_hi:[0,1,1]
    v_pk_fma_f32 v[152:153], v[150:151], v[130:131], v[148:149] op_sel:[1,1,0] op_sel_hi:[0,1,1] neg_lo:[0,1,0] neg_hi:[0,0,0]
    v_pk_fma_f32 v[168:169], v[166:167], v[138:139], v[164:165] op_sel:[1,1,0] op_sel_hi:[0,1,1] neg_lo:[0,1,0] neg_hi:[0,0,0]
    v_pk_mul_f32 v[140:141], v[144:145], v[128:129] op_sel:[0,0] op_sel_hi:[1,0]
    v_pk_mul_f32 v[156:157], v[160:161], v[136:137] op_sel:[0,0] op_sel_hi:[1,0]
    v_cvt_pk_bf16_f32 v62, v150, v151
    v_cvt_pk_bf16_f32 v63, v166, v167
    v_pk_fma_f32 v[146:147], v[144:145], v[128:129], v[140:141] op_sel:[1,1,0] op_sel_hi:[0,1,1] neg_lo:[0,0,0] neg_hi:[0,1,0]
    v_pk_fma_f32 v[162:163], v[160:161], v[136:137], v[156:157] op_sel:[1,1,0] op_sel_hi:[0,1,1] neg_lo:[0,0,0] neg_hi:[0,1,0]
    v_cvt_pk_bf16_f32 v70, v152, v153
    v_cvt_pk_bf16_f32 v71, v168, v169
    v_cvt_pk_bf16_f32 v46, v144, v145
    v_cvt_pk_bf16_f32 v47, v160, v161
    v_cvt_pk_bf16_f32 v54, v146, v147
    v_cvt_pk_bf16_f32 v55, v162, v163
    v_dot2_f32_bf16 v148, v62, v6, v150
    v_dot2_f32_bf16 v164, v63, v6, v166
    v_dot2_f32_bf16 v154, v70, v6, v152
    v_dot2_f32_bf16 v170, v71, v6, v168
    v_dot2_f32_bf16 v142, v46, v6, v144
    v_dot2_f32_bf16 v158, v47, v6, v160
    v_dot2_f32_bf16 v140, v54, v6, v146
    v_dot2_f32_bf16 v156, v55, v6, v162
    v_dot2_f32_bf16 v149, v62, v7, v151
    v_dot2_f32_bf16 v165, v63, v7, v167
    v_dot2_f32_bf16 v155, v70, v7, v153
    v_dot2_f32_bf16 v171, v71, v7, v169
    v_dot2_f32_bf16 v143, v46, v7, v145
    v_dot2_f32_bf16 v159, v47, v7, v161
    v_dot2_f32_bf16 v141, v54, v7, v147
    v_dot2_f32_bf16 v157, v55, v7, v163
    v_cvt_pk_bf16_f32 v66, v148, v149
    v_cvt_pk_bf16_f32 v67, v164, v165
    v_cvt_pk_bf16_f32 v74, v154, v155
    v_cvt_pk_bf16_f32 v75, v170, v171
    v_cvt_pk_bf16_f32 v50, v142, v143
    v_cvt_pk_bf16_f32 v51, v158, v159
    v_cvt_pk_bf16_f32 v58, v140, v141
    v_cvt_pk_bf16_f32 v59, v156, v157
    s_waitcnt lgkmcnt(0)
    v_pk_mul_f32 v[140:141], v[108:109], v[8:9]
    v_pk_mul_f32 v[148:149], v[108:109], v[10:11]
    v_pk_mul_f32 v[156:157], v[116:117], v[8:9]
    v_pk_mul_f32 v[164:165], v[116:117], v[10:11]
    v_mfma_f32_16x16x32_bf16 v[28:31], v[60:63], v[44:47], 0
    ds_read_b128 v[124:127], v197 offset:4864
    ds_read_b128 v[128:131], v197 offset:4880
    ds_read_b128 v[132:135], v197 offset:4992
    ds_read_b128 v[136:139], v197 offset:5008
    v_fract_f32 v141, v141
    v_fract_f32 v149, v149
    v_fract_f32 v157, v157
    v_fract_f32 v165, v165
    v_mfma_f32_16x16x32_bf16 v[32:35], v[60:63], v[52:55], 0
    ds_write_b128 v198, v[12:15] offset:0
    v_exp_f32 v140, v140
    v_exp_f32 v148, v148
    v_mfma_f32_16x16x32_bf16 v[36:39], v[68:71], v[44:47], 0
    s_add_u32 s74, s74, 4096
    buffer_store_dwordx4 v[232:235], v227, s[40:43], s74 offen sc1
    v_exp_f32 v156, v156
    v_exp_f32 v164, v164
    v_mfma_f32_16x16x32_bf16 v[40:43], v[68:71], v[52:55], 0
    ds_write_b128 v198, v[16:19] offset:1024
    v_cos_f32 v142, v141
    v_cos_f32 v150, v149
    v_mfma_f32_16x16x32_bf16 v[28:31], v[60:63], v[48:51], v[28:31]
    v_cos_f32 v158, v157
    v_cos_f32 v166, v165
    v_mfma_f32_16x16x32_bf16 v[32:35], v[60:63], v[56:59], v[32:35]
    ds_write2st64_b32 v199, v20, v24 offset0:0 offset1:1
    v_sin_f32 v143, v141
    v_sin_f32 v151, v149
    v_sin_f32 v159, v157
    v_sin_f32 v167, v165
    v_pk_mul_f32 v[142:143], v[142:143], v[140:141] op_sel:[0,0] op_sel_hi:[1,0]
    v_pk_mul_f32 v[158:159], v[158:159], v[156:157] op_sel:[0,0] op_sel_hi:[1,0]
    v_pk_mul_f32 v[150:151], v[150:151], v[148:149] op_sel:[0,0] op_sel_hi:[1,0]
    v_pk_mul_f32 v[166:167], v[166:167], v[164:165] op_sel:[0,0] op_sel_hi:[1,0]
    v_pk_mul_f32 v[140:141], v[142:143], v[110:111] op_sel:[0,0] op_sel_hi:[1,0]
    v_pk_mul_f32 v[156:157], v[158:159], v[118:119] op_sel:[0,0] op_sel_hi:[1,0]
    v_pk_mul_f32 v[148:149], v[150:151], v[114:115] op_sel:[0,0] op_sel_hi:[1,0]
    v_pk_mul_f32 v[164:165], v[166:167], v[122:123] op_sel:[0,0] op_sel_hi:[1,0]
    v_pk_fma_f32 v[144:145], v[142:143], v[110:111], v[140:141] op_sel:[1,1,0] op_sel_hi:[0,1,1] neg_lo:[0,1,0] neg_hi:[0,1,1]
    v_pk_fma_f32 v[160:161], v[158:159], v[118:119], v[156:157] op_sel:[1,1,0] op_sel_hi:[0,1,1] neg_lo:[0,1,0] neg_hi:[0,1,1]
    v_pk_fma_f32 v[152:153], v[150:151], v[114:115], v[148:149] op_sel:[1,1,0] op_sel_hi:[0,1,1] neg_lo:[0,1,0] neg_hi:[0,0,0]
    v_pk_fma_f32 v[168:169], v[166:167], v[122:123], v[164:165] op_sel:[1,1,0] op_sel_hi:[0,1,1] neg_lo:[0,1,0] neg_hi:[0,0,0]
    v_pk_mul_f32 v[140:141], v[144:145], v[112:113] op_sel:[0,0] op_sel_hi:[1,0]
    v_pk_mul_f32 v[156:157], v[160:161], v[120:121] op_sel:[0,0] op_sel_hi:[1,0]
    v_cvt_pk_bf16_f32 v92, v150, v151
    v_cvt_pk_bf16_f32 v93, v166, v167
    v_pk_fma_f32 v[146:147], v[144:145], v[112:113], v[140:141] op_sel:[1,1,0] op_sel_hi:[0,1,1] neg_lo:[0,0,0] neg_hi:[0,1,0]
    v_pk_fma_f32 v[162:163], v[160:161], v[120:121], v[156:157] op_sel:[1,1,0] op_sel_hi:[0,1,1] neg_lo:[0,0,0] neg_hi:[0,1,0]
    v_cvt_pk_bf16_f32 v100, v152, v153
    v_cvt_pk_bf16_f32 v101, v168, v169
    v_cvt_pk_bf16_f32 v76, v144, v145
    v_cvt_pk_bf16_f32 v77, v160, v161
    v_cvt_pk_bf16_f32 v84, v146, v147
    v_cvt_pk_bf16_f32 v85, v162, v163
    v_dot2_f32_bf16 v148, v92, v6, v150
    v_dot2_f32_bf16 v164, v93, v6, v166
    v_dot2_f32_bf16 v154, v100, v6, v152
    v_dot2_f32_bf16 v170, v101, v6, v168
    v_dot2_f32_bf16 v142, v76, v6, v144
    v_dot2_f32_bf16 v158, v77, v6, v160
    v_dot2_f32_bf16 v140, v84, v6, v146
    v_dot2_f32_bf16 v156, v85, v6, v162
    v_dot2_f32_bf16 v149, v92, v7, v151
    v_dot2_f32_bf16 v165, v93, v7, v167
    v_dot2_f32_bf16 v155, v100, v7, v153
    v_dot2_f32_bf16 v171, v101, v7, v169
    v_dot2_f32_bf16 v143, v76, v7, v145
    v_dot2_f32_bf16 v159, v77, v7, v161
    v_dot2_f32_bf16 v141, v84, v7, v147
    v_dot2_f32_bf16 v157, v85, v7, v163
    v_cvt_pk_bf16_f32 v96, v148, v149
    v_cvt_pk_bf16_f32 v97, v164, v165
    v_cvt_pk_bf16_f32 v104, v154, v155
    v_cvt_pk_bf16_f32 v105, v170, v171
    v_cvt_pk_bf16_f32 v80, v142, v143
    v_cvt_pk_bf16_f32 v81, v158, v159
    v_cvt_pk_bf16_f32 v88, v140, v141
    v_cvt_pk_bf16_f32 v89, v156, v157
    s_waitcnt lgkmcnt(3)
    v_pk_mul_f32 v[140:141], v[124:125], v[8:9]
    v_pk_mul_f32 v[148:149], v[124:125], v[10:11]
    v_pk_mul_f32 v[156:157], v[132:133], v[8:9]
    v_pk_mul_f32 v[164:165], v[132:133], v[10:11]
    v_mfma_f32_16x16x32_bf16 v[36:39], v[68:71], v[48:51], v[36:39]
    ds_read_b128 v[108:111], v197 offset:8192
    ds_read_b128 v[112:115], v197 offset:8208
    ds_read_b128 v[116:119], v197 offset:8320
    ds_read_b128 v[120:123], v197 offset:8336
    v_fract_f32 v141, v141
    v_fract_f32 v149, v149
    v_fract_f32 v157, v157
    v_fract_f32 v165, v165
    v_mfma_f32_16x16x32_bf16 v[40:43], v[68:71], v[56:59], v[40:43]
    s_add_u32 s74, s74, 4096
    s_cmp_lt_u32 s3, 2
    s_cselect_b64 exec, -1, 0
    buffer_store_dwordx4 v[232:235], v227, s[40:43], s74 offen sc1
    s_mov_b64 exec, -1
    v_exp_f32 v140, v140
    v_exp_f32 v148, v148
    v_mfma_f32_16x16x32_bf16 v[28:31], v[64:67], v[44:47], v[28:31]
    v_exp_f32 v156, v156
    v_exp_f32 v164, v164
    v_mfma_f32_16x16x32_bf16 v[32:35], v[64:67], v[52:55], v[32:35]
    v_cos_f32 v142, v141
    v_cos_f32 v150, v149
    v_mfma_f32_16x16x32_bf16 v[36:39], v[72:75], v[44:47], v[36:39]
    s_cmp_eq_u32 s3, 0
    s_cselect_b64 exec, -1, 0
    s_mov_b32 s15, 1048576
    buffer_load_dwordx4 v[190:193], v3, s[40:43], s15 offen offset:0 sc1
    s_mov_b64 exec, -1
    v_cos_f32 v158, v157
    v_cos_f32 v166, v165
    v_mfma_f32_16x16x32_bf16 v[40:43], v[72:75], v[52:55], v[40:43]
    v_sin_f32 v143, v141
    v_sin_f32 v151, v149
    v_sin_f32 v159, v157
    v_sin_f32 v167, v165
    v_pk_mul_f32 v[142:143], v[142:143], v[140:141] op_sel:[0,0] op_sel_hi:[1,0]
    v_pk_mul_f32 v[158:159], v[158:159], v[156:157] op_sel:[0,0] op_sel_hi:[1,0]
    v_pk_mul_f32 v[150:151], v[150:151], v[148:149] op_sel:[0,0] op_sel_hi:[1,0]
    v_pk_mul_f32 v[166:167], v[166:167], v[164:165] op_sel:[0,0] op_sel_hi:[1,0]
    v_pk_mul_f32 v[140:141], v[142:143], v[126:127] op_sel:[0,0] op_sel_hi:[1,0]
    v_pk_mul_f32 v[156:157], v[158:159], v[134:135] op_sel:[0,0] op_sel_hi:[1,0]
    v_pk_mul_f32 v[148:149], v[150:151], v[130:131] op_sel:[0,0] op_sel_hi:[1,0]
    v_pk_mul_f32 v[164:165], v[166:167], v[138:139] op_sel:[0,0] op_sel_hi:[1,0]
    v_pk_fma_f32 v[144:145], v[142:143], v[126:127], v[140:141] op_sel:[1,1,0] op_sel_hi:[0,1,1] neg_lo:[0,1,0] neg_hi:[0,1,1]
    v_pk_fma_f32 v[160:161], v[158:159], v[134:135], v[156:157] op_sel:[1,1,0] op_sel_hi:[0,1,1] neg_lo:[0,1,0] neg_hi:[0,1,1]
    v_pk_fma_f32 v[152:153], v[150:151], v[130:131], v[148:149] op_sel:[1,1,0] op_sel_hi:[0,1,1] neg_lo:[0,1,0] neg_hi:[0,0,0]
    v_pk_fma_f32 v[168:169], v[166:167], v[138:139], v[164:165] op_sel:[1,1,0] op_sel_hi:[0,1,1] neg_lo:[0,1,0] neg_hi:[0,0,0]
    v_pk_mul_f32 v[140:141], v[144:145], v[128:129] op_sel:[0,0] op_sel_hi:[1,0]
    v_pk_mul_f32 v[156:157], v[160:161], v[136:137] op_sel:[0,0] op_sel_hi:[1,0]
    v_cvt_pk_bf16_f32 v94, v150, v151
    v_cvt_pk_bf16_f32 v95, v166, v167
    v_pk_fma_f32 v[146:147], v[144:145], v[128:129], v[140:141] op_sel:[1,1,0] op_sel_hi:[0,1,1] neg_lo:[0,0,0] neg_hi:[0,1,0]
    v_pk_fma_f32 v[162:163], v[160:161], v[136:137], v[156:157] op_sel:[1,1,0] op_sel_hi:[0,1,1] neg_lo:[0,0,0] neg_hi:[0,1,0]
    v_cvt_pk_bf16_f32 v102, v152, v153
    v_cvt_pk_bf16_f32 v103, v168, v169
    v_cvt_pk_bf16_f32 v78, v144, v145
    v_cvt_pk_bf16_f32 v79, v160, v161
    v_cvt_pk_bf16_f32 v86, v146, v147
    v_cvt_pk_bf16_f32 v87, v162, v163
    v_dot2_f32_bf16 v148, v94, v6, v150
    v_dot2_f32_bf16 v164, v95, v6, v166
    v_dot2_f32_bf16 v154, v102, v6, v152
    v_dot2_f32_bf16 v170, v103, v6, v168
    v_dot2_f32_bf16 v142, v78, v6, v144
    v_dot2_f32_bf16 v158, v79, v6, v160
    v_dot2_f32_bf16 v140, v86, v6, v146
    v_dot2_f32_bf16 v156, v87, v6, v162
    v_dot2_f32_bf16 v149, v94, v7, v151
    v_dot2_f32_bf16 v165, v95, v7, v167
    v_dot2_f32_bf16 v155, v102, v7, v153
    v_dot2_f32_bf16 v171, v103, v7, v169
    v_dot2_f32_bf16 v143, v78, v7, v145
    v_dot2_f32_bf16 v159, v79, v7, v161
    v_dot2_f32_bf16 v141, v86, v7, v147
    v_dot2_f32_bf16 v157, v87, v7, v163
    v_cvt_pk_bf16_f32 v98, v148, v149
    v_cvt_pk_bf16_f32 v99, v164, v165
    v_cvt_pk_bf16_f32 v106, v154, v155
    v_cvt_pk_bf16_f32 v107, v170, v171
    v_cvt_pk_bf16_f32 v82, v142, v143
    v_cvt_pk_bf16_f32 v83, v158, v159
    v_cvt_pk_bf16_f32 v90, v140, v141
    v_cvt_pk_bf16_f32 v91, v156, v157
    s_waitcnt lgkmcnt(0)
    v_pk_mul_f32 v[140:141], v[108:109], v[8:9]
    v_pk_mul_f32 v[148:149], v[108:109], v[10:11]
    v_pk_mul_f32 v[156:157], v[116:117], v[8:9]
    v_pk_mul_f32 v[164:165], v[116:117], v[10:11]
    v_mfma_f32_16x16x32_bf16 v[28:31], v[92:95], v[76:79], v[28:31]
    ds_read_b128 v[124:127], v197 offset:8448
    ds_read_b128 v[128:131], v197 offset:8464
    ds_read_b128 v[132:135], v197 offset:8576
    ds_read_b128 v[136:139], v197 offset:8592
    v_fract_f32 v141, v141
    v_fract_f32 v149, v149
    v_fract_f32 v157, v157
    v_fract_f32 v165, v165
    v_mfma_f32_16x16x32_bf16 v[32:35], v[92:95], v[84:87], v[32:35]
    v_exp_f32 v140, v140
    v_exp_f32 v148, v148
    v_mfma_f32_16x16x32_bf16 v[36:39], v[100:103], v[76:79], v[36:39]
    v_exp_f32 v156, v156
    v_exp_f32 v164, v164
    v_mfma_f32_16x16x32_bf16 v[40:43], v[100:103], v[84:87], v[40:43]
    v_cos_f32 v142, v141
    v_cos_f32 v150, v149
    v_mfma_f32_16x16x32_bf16 v[28:31], v[92:95], v[80:83], v[28:31]
    v_cos_f32 v158, v157
    v_cos_f32 v166, v165
    v_mfma_f32_16x16x32_bf16 v[32:35], v[92:95], v[88:91], v[32:35]
    v_sin_f32 v143, v141
    v_sin_f32 v151, v149
    v_sin_f32 v159, v157
    v_sin_f32 v167, v165
    v_pk_mul_f32 v[142:143], v[142:143], v[140:141] op_sel:[0,0] op_sel_hi:[1,0]
    v_pk_mul_f32 v[158:159], v[158:159], v[156:157] op_sel:[0,0] op_sel_hi:[1,0]
    v_pk_mul_f32 v[150:151], v[150:151], v[148:149] op_sel:[0,0] op_sel_hi:[1,0]
    v_pk_mul_f32 v[166:167], v[166:167], v[164:165] op_sel:[0,0] op_sel_hi:[1,0]
    v_pk_mul_f32 v[140:141], v[142:143], v[110:111] op_sel:[0,0] op_sel_hi:[1,0]
    v_pk_mul_f32 v[156:157], v[158:159], v[118:119] op_sel:[0,0] op_sel_hi:[1,0]
    v_pk_mul_f32 v[148:149], v[150:151], v[114:115] op_sel:[0,0] op_sel_hi:[1,0]
    v_pk_mul_f32 v[164:165], v[166:167], v[122:123] op_sel:[0,0] op_sel_hi:[1,0]
    v_pk_fma_f32 v[144:145], v[142:143], v[110:111], v[140:141] op_sel:[1,1,0] op_sel_hi:[0,1,1] neg_lo:[0,1,0] neg_hi:[0,1,1]
    v_pk_fma_f32 v[160:161], v[158:159], v[118:119], v[156:157] op_sel:[1,1,0] op_sel_hi:[0,1,1] neg_lo:[0,1,0] neg_hi:[0,1,1]
    v_pk_fma_f32 v[152:153], v[150:151], v[114:115], v[148:149] op_sel:[1,1,0] op_sel_hi:[0,1,1] neg_lo:[0,1,0] neg_hi:[0,0,0]
    v_pk_fma_f32 v[168:169], v[166:167], v[122:123], v[164:165] op_sel:[1,1,0] op_sel_hi:[0,1,1] neg_lo:[0,1,0] neg_hi:[0,0,0]
    v_pk_mul_f32 v[140:141], v[144:145], v[112:113] op_sel:[0,0] op_sel_hi:[1,0]
    v_pk_mul_f32 v[156:157], v[160:161], v[120:121] op_sel:[0,0] op_sel_hi:[1,0]
    v_cvt_pk_bf16_f32 v60, v150, v151
    v_cvt_pk_bf16_f32 v61, v166, v167
    v_pk_fma_f32 v[146:147], v[144:145], v[112:113], v[140:141] op_sel:[1,1,0] op_sel_hi:[0,1,1] neg_lo:[0,0,0] neg_hi:[0,1,0]
    v_pk_fma_f32 v[162:163], v[160:161], v[120:121], v[156:157] op_sel:[1,1,0] op_sel_hi:[0,1,1] neg_lo:[0,0,0] neg_hi:[0,1,0]
    v_cvt_pk_bf16_f32 v68, v152, v153
    v_cvt_pk_bf16_f32 v69, v168, v169
    v_cvt_pk_bf16_f32 v44, v144, v145
    v_cvt_pk_bf16_f32 v45, v160, v161
    v_cvt_pk_bf16_f32 v52, v146, v147
    v_cvt_pk_bf16_f32 v53, v162, v163
    v_dot2_f32_bf16 v148, v60, v6, v150
    v_dot2_f32_bf16 v164, v61, v6, v166
    v_dot2_f32_bf16 v154, v68, v6, v152
    v_dot2_f32_bf16 v170, v69, v6, v168
    v_dot2_f32_bf16 v142, v44, v6, v144
    v_dot2_f32_bf16 v158, v45, v6, v160
    v_dot2_f32_bf16 v140, v52, v6, v146
    v_dot2_f32_bf16 v156, v53, v6, v162
    v_dot2_f32_bf16 v149, v60, v7, v151
    v_dot2_f32_bf16 v165, v61, v7, v167
    v_dot2_f32_bf16 v155, v68, v7, v153
    v_dot2_f32_bf16 v171, v69, v7, v169
    v_dot2_f32_bf16 v143, v44, v7, v145
    v_dot2_f32_bf16 v159, v45, v7, v161
    v_dot2_f32_bf16 v141, v52, v7, v147
    v_dot2_f32_bf16 v157, v53, v7, v163
    v_cvt_pk_bf16_f32 v64, v148, v149
    v_cvt_pk_bf16_f32 v65, v164, v165
    v_cvt_pk_bf16_f32 v72, v154, v155
    v_cvt_pk_bf16_f32 v73, v170, v171
    v_cvt_pk_bf16_f32 v48, v142, v143
    v_cvt_pk_bf16_f32 v49, v158, v159
    v_cvt_pk_bf16_f32 v56, v140, v141
    v_cvt_pk_bf16_f32 v57, v156, v157
    s_waitcnt lgkmcnt(0)
    v_pk_mul_f32 v[140:141], v[124:125], v[8:9]
    v_pk_mul_f32 v[148:149], v[124:125], v[10:11]
    v_pk_mul_f32 v[156:157], v[132:133], v[8:9]
    v_pk_mul_f32 v[164:165], v[132:133], v[10:11]
    v_mfma_f32_16x16x32_bf16 v[36:39], v[100:103], v[80:83], v[36:39]
    ds_read_b128 v[108:111], v197 offset:8704
    ds_read_b128 v[112:115], v197 offset:8720
    ds_read_b128 v[116:119], v197 offset:8832
    ds_read_b128 v[120:123], v197 offset:8848
    s_cmp_lg_u32 s3, 0
    s_cbranch_scc1 L_fc_done0
    s_waitcnt vmcnt(0)
    s_cmp_ge_u32 s2, 192
    s_cselect_b64 vcc, -1, 0
    v_cndmask_b32 v192, v192, v193, vcc
    v_cmp_eq_u32 vcc, s1, v2
    s_nop 1
    v_cndmask_b32 v192, 0, v192, vcc
    v_max3_u32 v190, v190, v191, v192
    v_cmp_eq_u32 vcc, -1, v190
    s_cbranch_vccnz L_fc_slow0
L_fc_done0:
    s_barrier
    v_fract_f32 v141, v141
    v_fract_f32 v149, v149
    v_fract_f32 v157, v157
    v_fract_f32 v165, v165
    v_mfma_f32_16x16x32_bf16 v[40:43], v[100:103], v[88:91], v[40:43]
    s_cmp_lt_u32 s1, 64
    s_cselect_b32 s15, s3, 1
    s_cmp_lg_u32 s15, 0
    s_cbranch_scc1 L_fin1
    s_add_u32 s13, s62, 15360
    buffer_load_dwordx2 v[252:253], v250, s[40:43], s62 offen
    buffer_load_dwordx2 v[254:255], v250, s[40:43], s13 offen
L_fin1:
    v_exp_f32 v140, v140
    v_exp_f32 v148, v148
    v_mfma_f32_16x16x32_bf16 v[28:31], v[96:99], v[76:79], v[28:31]
    buffer_load_dwordx4 v[174:177], v213, s[40:43], s11 offen
    v_exp_f32 v156, v156
    v_exp_f32 v164, v164
    v_mfma_f32_16x16x32_bf16 v[32:35], v[96:99], v[84:87], v[32:35]
    s_mov_b64 exec, 1
    buffer_load_dwordx2 v[172:173], v214, s[40:43], s11 offen offset:8
    s_mov_b64 exec, -1
    v_cos_f32 v142, v141
    v_cos_f32 v150, v149
    v_mfma_f32_16x16x32_bf16 v[36:39], v[104:107], v[76:79], v[36:39]
    s_waitcnt vmcnt(4)
    s_barrier
    ds_read_b64_tr_b16 a[236:237], v195 offset:0
    ds_read_b64_tr_b16 a[238:239], v196 offset:0
    ds_read_b64_tr_b16 a[240:241], v195 offset:4096
    v_cos_f32 v158, v157
    v_cos_f32 v166, v165
    v_mfma_f32_16x16x32_bf16 v[40:43], v[104:107], v[84:87], v[40:43]
    buffer_load_dwordx4 v[180:183], v213, s[40:43], s12 offen
    ds_read_b64_tr_b16 a[242:243], v196 offset:4096
    ds_read_b64_tr_b16 a[244:245], v195 offset:8192
    ds_read_b64_tr_b16 a[246:247], v196 offset:8192
    v_sin_f32 v143, v141
    v_sin_f32 v151, v149
    v_sin_f32 v159, v157
    v_sin_f32 v167, v165
    v_pk_mul_f32 v[142:143], v[142:143], v[140:141] op_sel:[0,0] op_sel_hi:[1,0]
    v_pk_mul_f32 v[158:159], v[158:159], v[156:157] op_sel:[0,0] op_sel_hi:[1,0]
    v_pk_mul_f32 v[150:151], v[150:151], v[148:149] op_sel:[0,0] op_sel_hi:[1,0]
    v_pk_mul_f32 v[166:167], v[166:167], v[164:165] op_sel:[0,0] op_sel_hi:[1,0]
    v_pk_mul_f32 v[140:141], v[142:143], v[126:127] op_sel:[0,0] op_sel_hi:[1,0]
    v_pk_mul_f32 v[156:157], v[158:159], v[134:135] op_sel:[0,0] op_sel_hi:[1,0]
    v_pk_mul_f32 v[148:149], v[150:151], v[130:131] op_sel:[0,0] op_sel_hi:[1,0]
    v_pk_mul_f32 v[164:165], v[166:167], v[138:139] op_sel:[0,0] op_sel_hi:[1,0]
    v_pk_fma_f32 v[144:145], v[142:143], v[126:127], v[140:141] op_sel:[1,1,0] op_sel_hi:[0,1,1] neg_lo:[0,1,0] neg_hi:[0,1,1]
    v_pk_fma_f32 v[160:161], v[158:159], v[134:135], v[156:157] op_sel:[1,1,0] op_sel_hi:[0,1,1] neg_lo:[0,1,0] neg_hi:[0,1,1]
    v_pk_fma_f32 v[152:153], v[150:151], v[130:131], v[148:149] op_sel:[1,1,0] op_sel_hi:[0,1,1] neg_lo:[0,1,0] neg_hi:[0,0,0]
    v_pk_fma_f32 v[168:169], v[166:167], v[138:139], v[164:165] op_sel:[1,1,0] op_sel_hi:[0,1,1] neg_lo:[0,1,0] neg_hi:[0,0,0]
    v_pk_mul_f32 v[140:141], v[144:145], v[128:129] op_sel:[0,0] op_sel_hi:[1,0]
    v_pk_mul_f32 v[156:157], v[160:161], v[136:137] op_sel:[0,0] op_sel_hi:[1,0]
    v_cvt_pk_bf16_f32 v62, v150, v151
    v_cvt_pk_bf16_f32 v63, v166, v167
    v_pk_fma_f32 v[146:147], v[144:145], v[128:129], v[140:141] op_sel:[1,1,0] op_sel_hi:[0,1,1] neg_lo:[0,0,0] neg_hi:[0,1,0]
    v_pk_fma_f32 v[162:163], v[160:161], v[136:137], v[156:157] op_sel:[1,1,0] op_sel_hi:[0,1,1] neg_lo:[0,0,0] neg_hi:[0,1,0]
    v_cvt_pk_bf16_f32 v70, v152, v153
    v_cvt_pk_bf16_f32 v71, v168, v169
    v_cvt_pk_bf16_f32 v46, v144, v145
    v_cvt_pk_bf16_f32 v47, v160, v161
    v_cvt_pk_bf16_f32 v54, v146, v147
    v_cvt_pk_bf16_f32 v55, v162, v163
    v_dot2_f32_bf16 v148, v62, v6, v150
    v_dot2_f32_bf16 v164, v63, v6, v166
    v_dot2_f32_bf16 v154, v70, v6, v152
    v_dot2_f32_bf16 v170, v71, v6, v168
    v_dot2_f32_bf16 v142, v46, v6, v144
    v_dot2_f32_bf16 v158, v47, v6, v160
    v_dot2_f32_bf16 v140, v54, v6, v146
    v_dot2_f32_bf16 v156, v55, v6, v162
    v_dot2_f32_bf16 v149, v62, v7, v151
    v_dot2_f32_bf16 v165, v63, v7, v167
    v_dot2_f32_bf16 v155, v70, v7, v153
    v_dot2_f32_bf16 v171, v71, v7, v169
    v_dot2_f32_bf16 v143, v46, v7, v145
    v_dot2_f32_bf16 v159, v47, v7, v161
    v_dot2_f32_bf16 v141, v54, v7, v147
    v_dot2_f32_bf16 v157, v55, v7, v163
    v_cvt_pk_bf16_f32 v66, v148, v149
    v_cvt_pk_bf16_f32 v67, v164, v165
    v_cvt_pk_bf16_f32 v74, v154, v155
    v_cvt_pk_bf16_f32 v75, v170, v171
    v_cvt_pk_bf16_f32 v50, v142, v143
    v_cvt_pk_bf16_f32 v51, v158, v159
    v_cvt_pk_bf16_f32 v58, v140, v141
    v_cvt_pk_bf16_f32 v59, v156, v157
    s_waitcnt lgkmcnt(6)
    v_pk_mul_f32 v[140:141], v[108:109], v[8:9]
    v_pk_mul_f32 v[148:149], v[108:109], v[10:11]
    v_pk_mul_f32 v[156:157], v[116:117], v[8:9]
    v_pk_mul_f32 v[164:165], v[116:117], v[10:11]
    v_mfma_f32_16x16x32_bf16 v[12:15], v[60:63], v[44:47], 0
    ds_read_b128 v[124:127], v197 offset:8960
    ds_read_b128 v[128:131], v197 offset:8976
    ds_read_b128 v[132:135], v197 offset:9088
    ds_read_b128 v[136:139], v197 offset:9104
    ds_read_b64_tr_b16 a[248:249], v195 offset:12288
    v_fract_f32 v141, v141
    v_fract_f32 v149, v149
    v_fract_f32 v157, v157
    v_fract_f32 v165, v165
    v_mfma_f32_16x16x32_bf16 v[16:19], v[60:63], v[52:55], 0
    ds_write_b128 v198, v[28:31] offset:25728
    v_exp_f32 v140, v140
    v_exp_f32 v148, v148
    v_mfma_f32_16x16x32_bf16 v[20:23], v[68:71], v[44:47], 0
    s_mov_b64 exec, 1
    buffer_load_dwordx2 v[178:179], v214, s[40:43], s12 offen offset:8
    s_mov_b64 exec, -1
    ds_read_b64_tr_b16 a[250:251], v196 offset:12288
    v_exp_f32 v156, v156
    v_exp_f32 v164, v164
    v_mfma_f32_16x16x32_bf16 v[24:27], v[68:71], v[52:55], 0
    ds_write_b128 v198, v[32:35] offset:26752
    v_cos_f32 v142, v141
    v_cos_f32 v150, v149
    v_mfma_f32_16x16x32_bf16 v[12:15], v[60:63], v[48:51], v[12:15]
    buffer_load_dwordx4 v[186:189], v213, s[40:43], s14 offen
    ds_write2st64_b32 v199, v36, v40 offset0:8 offset1:9
    v_cos_f32 v158, v157
    v_cos_f32 v166, v165
    v_mfma_f32_16x16x32_bf16 v[16:19], v[60:63], v[56:59], v[16:19]
    s_mov_b64 exec, 1
    buffer_load_dwordx2 v[184:185], v214, s[40:43], s14 offen offset:8
    s_mov_b64 exec, -1
    ds_read_b64_tr_b16 a[252:253], v195 offset:16384
    v_sin_f32 v143, v141
    v_sin_f32 v151, v149
    v_sin_f32 v159, v157
    v_sin_f32 v167, v165
    v_pk_mul_f32 v[142:143], v[142:143], v[140:141] op_sel:[0,0] op_sel_hi:[1,0]
    v_pk_mul_f32 v[158:159], v[158:159], v[156:157] op_sel:[0,0] op_sel_hi:[1,0]
    v_pk_mul_f32 v[150:151], v[150:151], v[148:149] op_sel:[0,0] op_sel_hi:[1,0]
    v_pk_mul_f32 v[166:167], v[166:167], v[164:165] op_sel:[0,0] op_sel_hi:[1,0]
    v_pk_mul_f32 v[140:141], v[142:143], v[110:111] op_sel:[0,0] op_sel_hi:[1,0]
    v_pk_mul_f32 v[156:157], v[158:159], v[118:119] op_sel:[0,0] op_sel_hi:[1,0]
    v_pk_mul_f32 v[148:149], v[150:151], v[114:115] op_sel:[0,0] op_sel_hi:[1,0]
    v_pk_mul_f32 v[164:165], v[166:167], v[122:123] op_sel:[0,0] op_sel_hi:[1,0]
    v_pk_fma_f32 v[144:145], v[142:143], v[110:111], v[140:141] op_sel:[1,1,0] op_sel_hi:[0,1,1] neg_lo:[0,1,0] neg_hi:[0,1,1]
    v_pk_fma_f32 v[160:161], v[158:159], v[118:119], v[156:157] op_sel:[1,1,0] op_sel_hi:[0,1,1] neg_lo:[0,1,0] neg_hi:[0,1,1]
    v_pk_fma_f32 v[152:153], v[150:151], v[114:115], v[148:149] op_sel:[1,1,0] op_sel_hi:[0,1,1] neg_lo:[0,1,0] neg_hi:[0,0,0]
    v_pk_fma_f32 v[168:169], v[166:167], v[122:123], v[164:165] op_sel:[1,1,0] op_sel_hi:[0,1,1] neg_lo:[0,1,0] neg_hi:[0,0,0]
    v_pk_mul_f32 v[140:141], v[144:145], v[112:113] op_sel:[0,0] op_sel_hi:[1,0]
    v_pk_mul_f32 v[156:157], v[160:161], v[120:121] op_sel:[0,0] op_sel_hi:[1,0]
    v_cvt_pk_bf16_f32 v92, v150, v151
    v_cvt_pk_bf16_f32 v93, v166, v167
    v_pk_fma_f32 v[146:147], v[144:145], v[112:113], v[140:141] op_sel:[1,1,0] op_sel_hi:[0,1,1] neg_lo:[0,0,0] neg_hi:[0,1,0]
    v_pk_fma_f32 v[162:163], v[160:161], v[120:121], v[156:157] op_sel:[1,1,0] op_sel_hi:[0,1,1] neg_lo:[0,0,0] neg_hi:[0,1,0]
    v_cvt_pk_bf16_f32 v100, v152, v153
    v_cvt_pk_bf16_f32 v101, v168, v169
    v_cvt_pk_bf16_f32 v76, v144, v145
    v_cvt_pk_bf16_f32 v77, v160, v161
    v_cvt_pk_bf16_f32 v84, v146, v147
    v_cvt_pk_bf16_f32 v85, v162, v163
    v_dot2_f32_bf16 v148, v92, v6, v150
    v_dot2_f32_bf16 v164, v93, v6, v166
    v_dot2_f32_bf16 v154, v100, v6, v152
    v_dot2_f32_bf16 v170, v101, v6, v168
    v_dot2_f32_bf16 v142, v76, v6, v144
    v_dot2_f32_bf16 v158, v77, v6, v160
    v_dot2_f32_bf16 v140, v84, v6, v146
    v_dot2_f32_bf16 v156, v85, v6, v162
    v_dot2_f32_bf16 v149, v92, v7, v151
    v_dot2_f32_bf16 v165, v93, v7, v167
    v_dot2_f32_bf16 v155, v100, v7, v153
    v_dot2_f32_bf16 v171, v101, v7, v169
    v_dot2_f32_bf16 v143, v76, v7, v145
    v_dot2_f32_bf16 v159, v77, v7, v161
    v_dot2_f32_bf16 v141, v84, v7, v147
    v_dot2_f32_bf16 v157, v85, v7, v163
    v_cvt_pk_bf16_f32 v96, v148, v149
    v_cvt_pk_bf16_f32 v97, v164, v165
    v_cvt_pk_bf16_f32 v104, v154, v155
    v_cvt_pk_bf16_f32 v105, v170, v171
    v_cvt_pk_bf16_f32 v80, v142, v143
    v_cvt_pk_bf16_f32 v81, v158, v159
    v_cvt_pk_bf16_f32 v88, v140, v141
    v_cvt_pk_bf16_f32 v89, v156, v157
    s_waitcnt lgkmcnt(6)
    v_pk_mul_f32 v[140:141], v[124:125], v[8:9]
    v_pk_mul_f32 v[148:149], v[124:125], v[10:11]
    v_pk_mul_f32 v[156:157], v[132:133], v[8:9]
    v_pk_mul_f32 v[164:165], v[132:133], v[10:11]
    v_mfma_f32_16x16x32_bf16 v[20:23], v[68:71], v[48:51], v[20:23]
    s_cmp_lt_u32 s1, 64
    s_cselect_b32 s15, s3, 1
    s_cmp_lg_u32 s15, 0
    s_cbranch_scc1 L_fin2
    s_sub_u32 s13, s0, 40
    s_cmp_lt_u32 s13, 10
    s_cselect_b32 s13, 1.0, 0
    s_lshl_b32 s15, s0, 8
    s_add_u32 s15, s15, 1179648
    s_waitcnt vmcnt(6)
    v_add_f64 v[252:253], v[252:253], v[254:255]
    v_cvt_f32_f64 v252, v[252:253]
    v_cvt_pk_bf16_f32 v252, v252, v252
    v_and_b32 v252, 0xffff0000, v252
    v_add_f32 v252, s13, v252
    v_cvt_pk_bf16_f32 v252, v252, v252
    v_and_b32 v252, 0xffff0000, v252
    s_nop 0
    buffer_store_dword v252, v5, s[40:43], s15 offen sc1
L_fin2:
    v_fract_f32 v141, v141
    v_fract_f32 v149, v149
    v_fract_f32 v157, v157
    v_fract_f32 v165, v165
    v_mfma_f32_16x16x32_bf16 v[24:27], v[68:71], v[56:59], v[24:27]
    ds_read_b64_tr_b16 a[254:255], v196 offset:16384
    v_exp_f32 v140, v140
    v_exp_f32 v148, v148
    v_mfma_f32_16x16x32_bf16 v[12:15], v[64:67], v[44:47], v[12:15]
    v_exp_f32 v156, v156
    v_exp_f32 v164, v164
    v_mfma_f32_16x16x32_bf16 v[16:19], v[64:67], v[52:55], v[16:19]
    v_cos_f32 v142, v141
    v_cos_f32 v150, v149
    v_mfma_f32_16x16x32_bf16 v[20:23], v[72:75], v[44:47], v[20:23]
    v_cos_f32 v158, v157
    v_cos_f32 v166, v165
    v_mfma_f32_16x16x32_bf16 v[24:27], v[72:75], v[52:55], v[24:27]
    s_cmp_eq_u32 s3, 0
    s_cselect_b64 exec, -1, 0
    s_mov_b32 s15, 1048576
    buffer_load_dwordx4 v[190:193], v3, s[40:43], s15 offen offset:0 sc1
    s_mov_b64 exec, -1
    v_sin_f32 v143, v141
    v_sin_f32 v151, v149
    v_sin_f32 v159, v157
    v_sin_f32 v167, v165
    v_pk_mul_f32 v[142:143], v[142:143], v[140:141] op_sel:[0,0] op_sel_hi:[1,0]
    v_pk_mul_f32 v[158:159], v[158:159], v[156:157] op_sel:[0,0] op_sel_hi:[1,0]
    v_pk_mul_f32 v[150:151], v[150:151], v[148:149] op_sel:[0,0] op_sel_hi:[1,0]
    v_pk_mul_f32 v[166:167], v[166:167], v[164:165] op_sel:[0,0] op_sel_hi:[1,0]
    v_pk_mul_f32 v[140:141], v[142:143], v[126:127] op_sel:[0,0] op_sel_hi:[1,0]
    v_pk_mul_f32 v[156:157], v[158:159], v[134:135] op_sel:[0,0] op_sel_hi:[1,0]
    v_pk_mul_f32 v[148:149], v[150:151], v[130:131] op_sel:[0,0] op_sel_hi:[1,0]
    v_pk_mul_f32 v[164:165], v[166:167], v[138:139] op_sel:[0,0] op_sel_hi:[1,0]
    v_pk_fma_f32 v[144:145], v[142:143], v[126:127], v[140:141] op_sel:[1,1,0] op_sel_hi:[0,1,1] neg_lo:[0,1,0] neg_hi:[0,1,1]
    v_pk_fma_f32 v[160:161], v[158:159], v[134:135], v[156:157] op_sel:[1,1,0] op_sel_hi:[0,1,1] neg_lo:[0,1,0] neg_hi:[0,1,1]
    v_pk_fma_f32 v[152:153], v[150:151], v[130:131], v[148:149] op_sel:[1,1,0] op_sel_hi:[0,1,1] neg_lo:[0,1,0] neg_hi:[0,0,0]
    v_pk_fma_f32 v[168:169], v[166:167], v[138:139], v[164:165] op_sel:[1,1,0] op_sel_hi:[0,1,1] neg_lo:[0,1,0] neg_hi:[0,0,0]
    v_pk_mul_f32 v[140:141], v[144:145], v[128:129] op_sel:[0,0] op_sel_hi:[1,0]
    v_pk_mul_f32 v[156:157], v[160:161], v[136:137] op_sel:[0,0] op_sel_hi:[1,0]
    v_cvt_pk_bf16_f32 v94, v150, v151
    v_cvt_pk_bf16_f32 v95, v166, v167
    v_pk_fma_f32 v[146:147], v[144:145], v[128:129], v[140:141] op_sel:[1,1,0] op_sel_hi:[0,1,1] neg_lo:[0,0,0] neg_hi:[0,1,0]
    v_pk_fma_f32 v[162:163], v[160:161], v[136:137], v[156:157] op_sel:[1,1,0] op_sel_hi:[0,1,1] neg_lo:[0,0,0] neg_hi:[0,1,0]
    v_cvt_pk_bf16_f32 v102, v152, v153
    v_cvt_pk_bf16_f32 v103, v168, v169
    v_cvt_pk_bf16_f32 v78, v144, v145
    v_cvt_pk_bf16_f32 v79, v160, v161
    v_cvt_pk_bf16_f32 v86, v146, v147
    v_cvt_pk_bf16_f32 v87, v162, v163
    v_dot2_f32_bf16 v148, v94, v6, v150
    v_dot2_f32_bf16 v164, v95, v6, v166
    v_dot2_f32_bf16 v154, v102, v6, v152
    v_dot2_f32_bf16 v170, v103, v6, v168
    v_dot2_f32_bf16 v142, v78, v6, v144
    v_dot2_f32_bf16 v158, v79, v6, v160
    v_dot2_f32_bf16 v140, v86, v6, v146
    v_dot2_f32_bf16 v156, v87, v6, v162
    v_dot2_f32_bf16 v149, v94, v7, v151
    v_dot2_f32_bf16 v165, v95, v7, v167
    v_dot2_f32_bf16 v155, v102, v7, v153
    v_dot2_f32_bf16 v171, v103, v7, v169
    v_dot2_f32_bf16 v143, v78, v7, v145
    v_dot2_f32_bf16 v159, v79, v7, v161
    v_dot2_f32_bf16 v141, v86, v7, v147
    v_dot2_f32_bf16 v157, v87, v7, v163
    v_cvt_pk_bf16_f32 v98, v148, v149
    v_cvt_pk_bf16_f32 v99, v164, v165
    v_cvt_pk_bf16_f32 v106, v154, v155
    v_cvt_pk_bf16_f32 v107, v170, v171
    v_cvt_pk_bf16_f32 v82, v142, v143
    v_cvt_pk_bf16_f32 v83, v158, v159
    v_cvt_pk_bf16_f32 v90, v140, v141
    v_cvt_pk_bf16_f32 v91, v156, v157
    v_mfma_f32_16x16x32_bf16 v[12:15], v[92:95], v[76:79], v[12:15]
    s_waitcnt lgkmcnt(0)
    v_mfma_f32_16x16x32_bf16 v[16:19], v[92:95], v[84:87], v[16:19]
    s_add_u32 s13, s66, 0
    buffer_store_dwordx4 a[236:239], v226, s[40:43], s13 offen sc1
    v_mfma_f32_16x16x32_bf16 v[20:23], v[100:103], v[76:79], v[20:23]
    v_mfma_f32_16x16x32_bf16 v[24:27], v[100:103], v[84:87], v[24:27]
    v_mfma_f32_16x16x32_bf16 v[12:15], v[92:95], v[80:83], v[12:15]
    v_mfma_f32_16x16x32_bf16 v[16:19], v[92:95], v[88:91], v[16:19]
    v_mfma_f32_16x16x32_bf16 v[20:23], v[100:103], v[80:83], v[20:23]
    v_mfma_f32_16x16x32_bf16 v[24:27], v[100:103], v[88:91], v[24:27]
    v_mfma_f32_16x16x32_bf16 v[12:15], v[96:99], v[76:79], v[12:15]
    s_add_u32 s13, s66, 4096
    buffer_store_dwordx4 a[240:243], v226, s[40:43], s13 offen sc1
    v_mfma_f32_16x16x32_bf16 v[16:19], v[96:99], v[84:87], v[16:19]
    v_mfma_f32_16x16x32_bf16 v[20:23], v[104:107], v[76:79], v[20:23]
    v_mfma_f32_16x16x32_bf16 v[24:27], v[104:107], v[84:87], v[24:27]
    s_add_u32 s13, s66, 8192
    buffer_store_dwordx4 a[244:247], v226, s[40:43], s13 offen sc1
    s_add_u32 s13, s66, 12288
    buffer_store_dwordx4 a[248:251], v226, s[40:43], s13 offen sc1
    s_add_u32 s13, s66, 16384
    buffer_store_dwordx4 a[252:255], v226, s[40:43], s13 offen sc1
    s_mov_b32 s4, 0x07060302
    s_mov_b32 s5, 0x05040100
    s_nop 3
    ds_write_b128 v198, v[12:15] offset:51456
    ds_write_b128 v198, v[16:19] offset:52480
    ds_write2st64_b32 v199, v20, v24 offset0:16 offset1:17
    s_mov_b32 s15, 1056768
    buffer_load_dwordx2 v[10:11], v215, s[40:43], s15 offen sc1
    s_waitcnt lgkmcnt(0)
    s_barrier
    ds_read_b64 v[12:13], v200 offset:0
    ds_read_b64 v[14:15], v200 offset:2304
    ds_read_b64 v[16:17], v200 offset:4608
    ds_read_b64 v[18:19], v200 offset:6912
    ds_read_b64 v[20:21], v200 offset:25728
    ds_read_b64 v[22:23], v200 offset:28032
    ds_read_b64 v[24:25], v200 offset:30336
    ds_read_b64 v[26:27], v200 offset:32640
    ds_read_b64 v[28:29], v200 offset:51456
    ds_read_b64 v[30:31], v200 offset:53760
    ds_read_b64 v[32:33], v200 offset:56064
    ds_read_b64 v[34:35], v200 offset:58368
    ds_read2st64_b32 v[36:37], v201 offset0:0 offset1:1
    ds_read2st64_b32 v[38:39], v201 offset0:2 offset1:3
    ds_read2st64_b32 v[40:41], v201 offset0:4 offset1:5
    ds_read2st64_b32 v[42:43], v201 offset0:6 offset1:7
    v_add_u32 v198, 4096, v202
    v_add_u32 v199, 8192, v202
    s_lshl_b32 s30, s8, 4
    s_and_b32 s30, s30, 16
    s_lshr_b32 s63, s63, s30
    s_lshl_b32 s63, s63, 16
    s_lshr_b32 s55, s63, 16
    s_mul_i32 s8, s8, 32
    s_add_u32 s8, s8, 10469376
    s_lshl_b32 s30, s9, 4
    s_and_b32 s30, s30, 16
    s_lshr_b32 s64, s64, s30
    s_lshl_b32 s64, s64, 16
    s_lshr_b32 s56, s64, 16
    s_lshr_b32 s9, s9, 1
    s_mul_i32 s9, s9, 32
    s_add_u32 s9, s9, 8388608
    s_lshl_b32 s30, s10, 4
    s_and_b32 s30, s30, 16
    s_lshr_b32 s65, s65, s30
    s_lshl_b32 s65, s65, 16
    s_lshr_b32 s57, s65, 16
    s_lshr_b32 s10, s10, 1
    s_mul_i32 s10, s10, 32
    s_add_u32 s10, s10, 9437184
    s_and_b32 s30, s2, 7
    s_lshr_b32 s31, s2, 3
    s_mul_i32 s21, s31, 37
    s_lshr_b32 s21, s21, 8
    s_mul_i32 s20, s21, 7
    s_sub_u32 s20, s31, s20
    s_and_b32 s31, s30, 1
    s_mul_i32 s31, s31, 7
    s_add_u32 s20, s20, s31
    s_lshr_b32 s30, s30, 1
    s_lshl_b32 s30, s30, 2
    s_add_u32 s21, s21, s30
    s_lshl_b32 s22, s20, 13
    s_mul_i32 s30, s3, 110592
    s_add_u32 s22, s22, s30
    s_add_u32 s22, s22, 26329088
    s_lshl_b32 s19, s3, 12
    s_waitcnt lgkmcnt(0)
    v_pk_add_f32 v[12:13], v[12:13], v[14:15]
    v_pk_add_f32 v[16:17], v[16:17], v[18:19]
    v_pk_add_f32 v[20:21], v[20:21], v[22:23]
    v_pk_add_f32 v[24:25], v[24:25], v[26:27]
    v_pk_add_f32 v[28:29], v[28:29], v[30:31]
    v_pk_add_f32 v[32:33], v[32:33], v[34:35]
    v_pk_add_f32 v[36:37], v[36:37], v[38:39]
    v_pk_add_f32 v[40:41], v[40:41], v[42:43]
    v_pk_add_f32 v[12:13], v[12:13], v[16:17]
    v_pk_add_f32 v[20:21], v[20:21], v[24:25]
    v_pk_add_f32 v[28:29], v[28:29], v[32:33]
    v_pk_add_f32 v[36:37], v[36:37], v[40:41]
    v_cvt_pk_bf16_f32 v14, v12, v13
    v_cvt_pk_bf16_f32 v22, v20, v21
    v_cvt_pk_bf16_f32 v30, v28, v29
    v_cvt_pk_bf16_f32 v38, v36, v37
    v_dot2_f32_bf16 v16, v14, v6, v12
    v_dot2_f32_bf16 v17, v14, v7, v13
    v_dot2_f32_bf16 v24, v22, v6, v20
    v_dot2_f32_bf16 v25, v22, v7, v21
    v_dot2_f32_bf16 v32, v30, v6, v28
    v_dot2_f32_bf16 v33, v30, v7, v29
    v_dot2_f32_bf16 v40, v38, v6, v36
    v_dot2_f32_bf16 v41, v38, v7, v37
    v_cvt_pk_bf16_f32 v12, v16, v12
    v_cvt_pk_bf16_f32 v13, v17, v13
    v_cvt_pk_bf16_f32 v20, v24, v20
    v_cvt_pk_bf16_f32 v21, v25, v21
    v_cvt_pk_bf16_f32 v28, v32, v28
    v_cvt_pk_bf16_f32 v29, v33, v29
    v_cvt_pk_bf16_f32 v36, v40, v36
    v_cvt_pk_bf16_f32 v37, v41, v37
    ds_write2_b32 v202, v12, v13 offset0:0 offset1:1
    ds_write2_b32 v198, v20, v21 offset0:0 offset1:1
    ds_write2_b32 v199, v28, v29 offset0:0 offset1:1
    ds_write2_b32 v203, v36, v37 offset0:0 offset1:16
    s_cmp_lg_u32 s3, 0
    s_cbranch_scc1 L_fc_done1
    s_waitcnt vmcnt(6)
    v_max_u32 v190, v192, v193
    v_cmp_eq_u32 vcc, -1, v190
    s_cbranch_vccnz L_fc_slow1
L_fc_done1:
    s_waitcnt lgkmcnt(0)
    s_barrier
    ds_read_b32 v12, v204 offset:0
    s_bfe_u32 s100, s68, 0x80000
    s_mul_i32 s100, s100, 40960
    buffer_load_dwordx4 a[0:3], v230, s[40:43], s100 offen offset:0
    ds_read_b32 v13, v205 offset:0
    ds_read_b32 v14, v206 offset:0
    ds_read_b32 v15, v207 offset:0
    ds_read_b32 v16, v208 offset:0
    ds_read_b32 v17, v209 offset:0
    ds_read_b32 v18, v210 offset:0
    ds_read_b32 v19, v211 offset:0
    ds_read_b32 v28, v204 offset:4096
    buffer_load_dwordx4 a[4:7], v230, s[40:43], s100 offen offset:1024
    ds_read_b32 v29, v205 offset:4096
    ds_read_b32 v30, v206 offset:4096
    ds_read_b32 v31, v207 offset:4096
    ds_read_b32 v32, v208 offset:4096
    ds_read_b32 v33, v209 offset:4096
    ds_read_b32 v34, v210 offset:4096
    ds_read_b32 v35, v211 offset:4096
    ds_read_b32 v44, v204 offset:8192
    buffer_load_dwordx4 a[8:11], v230, s[40:43], s100 offen offset:2048
    ds_read_b32 v45, v205 offset:8192
    ds_read_b32 v46, v206 offset:8192
    ds_read_b32 v47, v207 offset:8192
    ds_read_b32 v48, v208 offset:8192
    ds_read_b32 v49, v209 offset:8192
    ds_read_b32 v50, v210 offset:8192
    ds_read_b32 v51, v211 offset:8192
    s_waitcnt lgkmcnt(15)
    v_perm_b32 v20, v13, v12, s4
    v_perm_b32 v21, v15, v14, s4
    v_perm_b32 v22, v17, v16, s4
    v_perm_b32 v23, v19, v18, s4
    v_perm_b32 v24, v13, v12, s5
    v_perm_b32 v25, v15, v14, s5
    v_perm_b32 v26, v17, v16, s5
    v_perm_b32 v27, v19, v18, s5
    s_nop 0
    ds_write_b128 v212, v[20:23] offset:0
    buffer_load_dwordx4 a[12:15], v230, s[40:43], s100 offen offset:3072
    s_waitcnt lgkmcnt(9)
    v_perm_b32 v36, v29, v28, s4
    v_perm_b32 v37, v31, v30, s4
    v_perm_b32 v38, v33, v32, s4
    v_perm_b32 v39, v35, v34, s4
    v_perm_b32 v40, v29, v28, s5
    v_perm_b32 v41, v31, v30, s5
    v_perm_b32 v42, v33, v32, s5
    v_perm_b32 v43, v35, v34, s5
    s_nop 0
    ds_write_b128 v212, v[36:39] offset:25728
    buffer_load_dwordx4 a[16:19], v231, s[40:43], s100 offen offset:0
    s_waitcnt lgkmcnt(2)
    v_perm_b32 v52, v45, v44, s4
    v_perm_b32 v53, v47, v46, s4
    v_perm_b32 v54, v49, v48, s4
    v_perm_b32 v55, v51, v50, s4
    v_perm_b32 v56, v45, v44, s5
    v_perm_b32 v57, v47, v46, s5
    v_perm_b32 v58, v49, v48, s5
    v_perm_b32 v59, v51, v50, s5
    s_nop 0
    ds_write_b128 v212, v[52:55] offset:51456
    s_bfe_u32 s100, s68, 0x80008
    s_mul_i32 s100, s100, 40960
    buffer_load_dwordx4 a[20:23], v230, s[40:43], s100 offen offset:0
    ds_write_b128 v212, v[24:27] offset:4608
    buffer_load_dwordx4 a[24:27], v230, s[40:43], s100 offen offset:1024
    ds_write_b128 v212, v[40:43] offset:30336
    buffer_load_dwordx4 a[28:31], v230, s[40:43], s100 offen offset:2048
    ds_write_b128 v212, v[56:59] offset:56064
    buffer_load_dwordx4 a[32:35], v230, s[40:43], s100 offen offset:3072
    s_waitcnt vmcnt(9)
    s_mov_b64 exec, 0x3f3f3f
    v_cmp_eq_u32 vcc, -1, v11
    s_cbranch_vccnz L_mv_slow
L_mv_done:
    s_mov_b64 exec, -1
    v_mov_b32_dpp v8, v10 quad_perm:[1,0,3,2] row_mask:0xf bank_mask:0xf
    v_mov_b32_dpp v9, v11 quad_perm:[1,0,3,2] row_mask:0xf bank_mask:0xf
    v_add_f64 v[10:11], v[10:11], v[8:9]
    v_cvt_f32_f64 v4, v[10:11]
    v_cvt_pk_bf16_f32 v4, v4, v4
    v_and_b32 v4, 0xffff0000, v4
    v_add_f32 v3, 1.0, v4
    v_readlane_b32 s80, v4, 0
    v_readlane_b32 s81, v4, 8
    v_readlane_b32 s82, v4, 16
    v_cvt_pk_bf16_f32 v3, v3, v3
    v_readlane_b32 s86, v4, 4
    v_readlane_b32 s87, v4, 12
    v_readlane_b32 s88, v4, 20
    v_and_b32 v3, 0xffff0000, v3
    v_mov_b32 v8, 0x3f80
    v_mov_b32 v9, 0x3f800000
    v_readlane_b32 s83, v3, 2
    v_readlane_b32 s84, v3, 10
    v_readlane_b32 s85, v3, 18
    v_cmp_eq_u32 s[6:7], 0, v0
    v_mul_u32_u24 v3, 128, v2
    s_lshr_b32 s52, s83, 16
    s_lshr_b32 s53, s84, 16
    s_lshr_b32 s54, s85, 16
    buffer_load_dwordx4 a[36:39], v231, s[40:43], s100 offen offset:0
    v_mov_b32_dpp v172, v176 wave_shr:1 row_mask:0xf bank_mask:0xf
    v_mov_b32_dpp v173, v177 wave_shr:1 row_mask:0xf bank_mask:0xf
    v_dot2_f32_bf16 v45, v172, s83, 0
    v_dot2_f32_bf16 v46, v173, s52, 0
    v_dot2_f32_bf16 v47, v173, s83, 0
    v_dot2_f32_bf16 v48, v174, s52, 0
    v_dot2_f32_bf16 v49, v174, s83, 0
    v_dot2_f32_bf16 v50, v175, s52, 0
    v_dot2_f32_bf16 v51, v175, s83, 0
    v_dot2_f32_bf16 v52, v176, s52, 0
    v_dot2_f32_bf16 v53, v176, s83, 0
    v_dot2_f32_bf16 v54, v177, s52, 0
    v_dot2_f32_bf16 v55, v177, s83, 0
    v_cvt_pk_bf16_f32 v172, v45, v45
    v_cvt_pk_bf16_f32 v173, v46, v47
    v_cvt_pk_bf16_f32 v174, v48, v49
    v_cvt_pk_bf16_f32 v175, v50, v51
    v_cvt_pk_bf16_f32 v176, v52, v53
    s_bfe_u32 s100, s68, 0x80010
    s_mul_i32 s100, s100, 40960
    buffer_load_dwordx4 a[40:43], v230, s[40:43], s100 offen offset:0
    v_cvt_pk_bf16_f32 v177, v54, v55
    v_dot2_f32_bf16 v45, v172, v9, s80
    v_dot2_f32_bf16 v46, v173, v8, s80
    v_dot2_f32_bf16 v47, v173, v9, s80
    v_dot2_f32_bf16 v48, v174, v8, s80
    v_dot2_f32_bf16 v49, v174, v9, s80
    v_dot2_f32_bf16 v50, v175, v8, s80
    v_dot2_f32_bf16 v51, v175, v9, s80
    v_dot2_f32_bf16 v52, v176, v8, s80
    v_dot2_f32_bf16 v53, v176, v9, s80
    v_dot2_f32_bf16 v54, v177, v8, s80
    v_dot2_f32_bf16 v55, v177, v9, s80
    v_cndmask_b32 v45, v45, 0, s[6:7]
    v_cndmask_b32 v46, v46, 0, s[6:7]
    v_cndmask_b32 v47, v47, 0, s[6:7]
    v_mov_b32_dpp v178, v182 wave_shr:1 row_mask:0xf bank_mask:0xf
    v_cvt_pk_bf16_f32 v56, v48, v49
    v_mov_b32_dpp v179, v183 wave_shr:1 row_mask:0xf bank_mask:0xf
    buffer_load_dwordx4 a[44:47], v230, s[40:43], s100 offen offset:1024
    v_cvt_pk_bf16_f32 v57, v50, v51
    v_dot2_f32_bf16 v77, v178, s84, 0
    v_cvt_pk_bf16_f32 v58, v52, v53
    v_dot2_f32_bf16 v78, v179, s53, 0
    v_cvt_pk_bf16_f32 v59, v54, v55
    v_dot2_f32_bf16 v79, v179, s84, 0
    s_nop 0
    v_dot2_f32_bf16 v80, v180, s53, 0
    ds_write_b128 v216, v[56:59] offset:0
    buffer_load_dwordx4 a[48:51], v230, s[40:43], s100 offen offset:2048
    v_dot2_f32_bf16 v81, v180, s84, 0
    v_cvt_pk_bf16_f32 v60, v47, v48
    v_dot2_f32_bf16 v82, v181, s53, 0
    v_cvt_pk_bf16_f32 v61, v49, v50
    v_dot2_f32_bf16 v83, v181, s84, 0
    v_cvt_pk_bf16_f32 v62, v51, v52
    v_dot2_f32_bf16 v84, v182, s53, 0
    v_cvt_pk_bf16_f32 v63, v53, v54
    v_dot2_f32_bf16 v85, v182, s84, 0
    v_cvt_pk_bf16_f32 v64, v46, v47
    v_dot2_f32_bf16 v86, v183, s53, 0
    v_cvt_pk_bf16_f32 v65, v48, v49
    v_dot2_f32_bf16 v87, v183, s84, 0
    v_cvt_pk_bf16_f32 v66, v50, v51
    v_cvt_pk_bf16_f32 v178, v77, v77
    v_cvt_pk_bf16_f32 v67, v52, v53
    v_cvt_pk_bf16_f32 v179, v78, v79
    s_nop 0
    v_cvt_pk_bf16_f32 v180, v80, v81
    buffer_load_dwordx4 a[52:55], v230, s[40:43], s100 offen offset:3072
    ds_write_b128 v216, v[60:63] offset:4128
    v_cvt_pk_bf16_f32 v181, v82, v83
    v_cvt_pk_bf16_f32 v68, v45, v46
    v_cvt_pk_bf16_f32 v182, v84, v85
    v_cvt_pk_bf16_f32 v69, v47, v48
    v_cvt_pk_bf16_f32 v183, v86, v87
    v_cvt_pk_bf16_f32 v70, v49, v50
    v_dot2_f32_bf16 v77, v178, v9, s81
    v_cvt_pk_bf16_f32 v71, v51, v52
    v_dot2_f32_bf16 v78, v179, v8, s81
    s_nop 0
    v_dot2_f32_bf16 v79, v179, v9, s81
    ds_write_b128 v216, v[64:67] offset:8256
    buffer_load_dwordx4 a[56:59], v231, s[40:43], s100 offen offset:0
    v_dot2_f32_bf16 v80, v180, v8, s81
    s_nop 0
    v_dot2_f32_bf16 v81, v180, v9, s81
    ds_write_b128 v216, v[68:71] offset:12384
    s_bfe_u32 s100, s68, 0x80018
    s_mul_i32 s100, s100, 40960
    buffer_load_dwordx4 a[60:63], v230, s[40:43], s100 offen offset:0
    v_dot2_f32_bf16 v82, v181, v8, s81
    v_dot2_f32_bf16 v83, v181, v9, s81
    v_dot2_f32_bf16 v84, v182, v8, s81
    v_dot2_f32_bf16 v85, v182, v9, s81
    v_dot2_f32_bf16 v86, v183, v8, s81
    v_dot2_f32_bf16 v87, v183, v9, s81
    v_cndmask_b32 v77, v77, 0, s[6:7]
    v_cndmask_b32 v78, v78, 0, s[6:7]
    v_cndmask_b32 v79, v79, 0, s[6:7]
    v_mov_b32_dpp v184, v188 wave_shr:1 row_mask:0xf bank_mask:0xf
    v_cvt_pk_bf16_f32 v88, v80, v81
    v_mov_b32_dpp v185, v189 wave_shr:1 row_mask:0xf bank_mask:0xf
    v_cvt_pk_bf16_f32 v89, v82, v83
    v_dot2_f32_bf16 v109, v184, s85, 0
    v_cvt_pk_bf16_f32 v90, v84, v85
    v_dot2_f32_bf16 v110, v185, s54, 0
    v_cvt_pk_bf16_f32 v91, v86, v87
    v_dot2_f32_bf16 v111, v185, s85, 0
    buffer_load_dwordx4 a[64:67], v230, s[40:43], s100 offen offset:1024
    s_nop 0
    v_dot2_f32_bf16 v112, v186, s54, 0
    ds_write_b128 v216, v[88:91] offset:25728
    buffer_load_dwordx4 a[68:71], v230, s[40:43], s100 offen offset:2048
    v_dot2_f32_bf16 v113, v186, s85, 0
    v_cvt_pk_bf16_f32 v92, v79, v80
    v_dot2_f32_bf16 v114, v187, s54, 0
    v_cvt_pk_bf16_f32 v93, v81, v82
    v_dot2_f32_bf16 v115, v187, s85, 0
    v_cvt_pk_bf16_f32 v94, v83, v84
    v_dot2_f32_bf16 v116, v188, s54, 0
    v_cvt_pk_bf16_f32 v95, v85, v86
    v_dot2_f32_bf16 v117, v188, s85, 0
    v_cvt_pk_bf16_f32 v96, v78, v79
    v_dot2_f32_bf16 v118, v189, s54, 0
    v_cvt_pk_bf16_f32 v97, v80, v81
    v_dot2_f32_bf16 v119, v189, s85, 0
    v_cvt_pk_bf16_f32 v98, v82, v83
    v_cvt_pk_bf16_f32 v184, v109, v109
    v_cvt_pk_bf16_f32 v99, v84, v85
    v_cvt_pk_bf16_f32 v185, v110, v111
    s_nop 0
    v_cvt_pk_bf16_f32 v186, v112, v113
    buffer_load_dwordx4 a[72:75], v230, s[40:43], s100 offen offset:3072
    ds_write_b128 v216, v[92:95] offset:29856
    v_cvt_pk_bf16_f32 v187, v114, v115
    v_cvt_pk_bf16_f32 v100, v77, v78
    v_cvt_pk_bf16_f32 v188, v116, v117
    v_cvt_pk_bf16_f32 v101, v79, v80
    v_cvt_pk_bf16_f32 v189, v118, v119
    v_cvt_pk_bf16_f32 v102, v81, v82
    v_dot2_f32_bf16 v109, v184, v9, s82
    v_cvt_pk_bf16_f32 v103, v83, v84
    v_dot2_f32_bf16 v110, v185, v8, s82
    v_dot2_f32_bf16 v76, v88, s56, 0
    v_dot2_f32_bf16 v111, v185, v9, s82
    v_dot2_f32_bf16 v77, v88, s64, 0
    v_dot2_f32_bf16 v112, v186, v8, s82
    buffer_load_dwordx4 a[76:79], v231, s[40:43], s100 offen offset:0
    v_dot2_f32_bf16 v78, v89, s56, 0
    v_dot2_f32_bf16 v113, v186, v9, s82
    v_dot2_f32_bf16 v79, v89, s64, 0
    v_dot2_f32_bf16 v114, v187, v8, s82
    s_nop 0
    v_dot2_f32_bf16 v115, v187, v9, s82
    ds_write_b128 v216, v[96:99] offset:33984
    s_bfe_u32 s100, s69, 0x80000
    s_mul_i32 s100, s100, 40960
    buffer_load_dwordx4 a[80:83], v230, s[40:43], s100 offen offset:0
    v_dot2_f32_bf16 v116, v188, v8, s82
    v_dot2_f32_bf16 v80, v90, s56, 0
    v_dot2_f32_bf16 v117, v188, v9, s82
    v_dot2_f32_bf16 v81, v90, s64, 0
    v_dot2_f32_bf16 v118, v189, v8, s82
    v_dot2_f32_bf16 v82, v91, s56, 0
    v_dot2_f32_bf16 v119, v189, v9, s82
    v_dot2_f32_bf16 v83, v91, s64, 0
    v_cndmask_b32 v109, v109, 0, s[6:7]
    v_cvt_pk_bf16_f32 v156, v76, v77
    v_cvt_pk_bf16_f32 v157, v78, v79
    v_cvt_pk_bf16_f32 v158, v80, v81
    v_cvt_pk_bf16_f32 v159, v82, v83
    s_nop 0
    ds_write_b128 v216, v[100:103] offset:38112
    buffer_load_dwordx4 a[84:87], v230, s[40:43], s100 offen offset:1024
    v_cndmask_b32 v110, v110, 0, s[6:7]
    v_cndmask_b32 v111, v111, 0, s[6:7]
    v_cvt_pk_bf16_f32 v120, v112, v113
    v_cvt_pk_bf16_f32 v121, v114, v115
    v_cvt_pk_bf16_f32 v122, v116, v117
    v_cvt_pk_bf16_f32 v123, v118, v119
    s_nop 0
    ds_write_b128 v216, v[120:123] offset:51456
    buffer_load_dwordx4 a[88:91], v230, s[40:43], s100 offen offset:2048
    v_cvt_pk_bf16_f32 v124, v111, v112
    v_cvt_pk_bf16_f32 v125, v113, v114
    v_cvt_pk_bf16_f32 v126, v115, v116
    v_cvt_pk_bf16_f32 v127, v117, v118
    v_cvt_pk_bf16_f32 v128, v110, v111
    v_cvt_pk_bf16_f32 v129, v112, v113
    v_cvt_pk_bf16_f32 v130, v114, v115
    v_cvt_pk_bf16_f32 v131, v116, v117
    s_nop 0
    ds_write_b128 v216, v[124:127] offset:55584
    buffer_load_dwordx4 a[92:95], v230, s[40:43], s100 offen offset:3072
    v_cvt_pk_bf16_f32 v132, v109, v110
    v_cvt_pk_bf16_f32 v133, v111, v112
    v_cvt_pk_bf16_f32 v134, v113, v114
    v_cvt_pk_bf16_f32 v135, v115, v116
    v_dot2_f32_bf16 v108, v120, s57, 0
    v_dot2_f32_bf16 v109, v120, s65, 0
    v_dot2_f32_bf16 v110, v121, s57, 0
    v_dot2_f32_bf16 v111, v121, s65, 0
    s_nop 0
    ds_write_b128 v216, v[128:131] offset:59712
    buffer_load_dwordx4 a[96:99], v231, s[40:43], s100 offen offset:0
    v_dot2_f32_bf16 v112, v122, s57, 0
    v_dot2_f32_bf16 v113, v122, s65, 0
    v_dot2_f32_bf16 v114, v123, s57, 0
    v_dot2_f32_bf16 v115, v123, s65, 0
    v_cvt_pk_bf16_f32 v160, v108, v109
    v_cvt_pk_bf16_f32 v161, v110, v111
    v_cvt_pk_bf16_f32 v162, v112, v113
    v_cvt_pk_bf16_f32 v163, v114, v115
    s_nop 0
    ds_write_b128 v216, v[132:135] offset:63840
    s_bfe_u32 s100, s69, 0x80008
    s_mul_i32 s100, s100, 40960
    buffer_load_dwordx4 a[100:103], v230, s[40:43], s100 offen offset:0
    s_cmp_lg_u32 s89, 0
    s_cbranch_scc1 L_cv_1
    s_waitcnt lgkmcnt(0)
    s_barrier
    ds_read2_b64 v[124:127], v219 offset0:192 offset1:193
    ds_read_b128 v[128:131], v220 offset:32
    ds_read2_b64 v[132:135], v219 offset0:128 offset1:129
    ds_read2_b64 v[136:139], v218 offset0:64 offset1:65
    ds_read2_b64 v[140:143], v218 offset0:0 offset1:1
    ds_read_b128 v[144:147], v220 offset:4640
    ds_read_b128 v[148:151], v220 offset:288
    ds_read2_b64 v[152:155], v219 offset0:64 offset1:65
    s_cmp_lg_u32 s3, 0
    s_cbranch_scc1 L_arrB_skip0
    s_mov_b64 exec, 1
    buffer_store_dword v5, v5, s[40:43], s101 offen offset:16 sc1
    s_mov_b64 exec, -1
L_arrB_skip0:
    s_waitcnt lgkmcnt(6)
    v_mfma_f32_16x16x32_bf16 v[12:15], v[124:127], v[128:131], 0
    ds_read_b128 v[92:95], v220 offset:4896
    ds_read_b128 v[96:99], v220 offset:544
    s_waitcnt lgkmcnt(7)
    v_mfma_f32_16x16x32_bf16 v[16:19], v[132:135], v[128:131], 0
    ds_read2_b64 v[100:103], v219 offset0:0 offset1:1
    ds_read_b128 v[104:107], v220 offset:5152
    s_waitcnt lgkmcnt(8)
    v_mfma_f32_16x16x32_bf16 v[20:23], v[136:139], v[128:131], 0
    ds_read_b128 v[108:111], v220 offset:800
    ds_read2_b64 v[112:115], v218 offset0:192 offset1:193
    s_waitcnt lgkmcnt(9)
    v_mfma_f32_16x16x32_bf16 v[24:27], v[140:143], v[128:131], 0
    ds_read_b128 v[116:119], v220 offset:5408
    ds_read_b128 v[120:123], v220 offset:1056
    s_waitcnt lgkmcnt(10)
    v_mfma_f32_16x16x32_bf16 v[12:15], v[124:127], v[144:147], v[12:15]
    ds_read2_b64 v[128:131], v218 offset0:128 offset1:129
    ds_read_b128 v[124:127], v220 offset:5664
    v_mfma_f32_16x16x32_bf16 v[16:19], v[132:135], v[144:147], v[16:19]
    s_mul_i32 s74, s2, 37888
    s_add_u32 s74, s74, 13627392
    v_mfma_f32_16x16x32_bf16 v[20:23], v[136:139], v[144:147], v[20:23]
    s_add_u32 s74, s74, 4096
    buffer_store_dwordx4 v[232:235], v227, s[40:43], s74 offen sc1
    v_mfma_f32_16x16x32_bf16 v[24:27], v[140:143], v[144:147], v[24:27]
    ds_read_b128 v[144:147], v220 offset:1312
    v_add_u32 v213, 25728, v218
    s_waitcnt lgkmcnt(11)
    v_mfma_f32_16x16x32_bf16 v[12:15], v[132:135], v[148:151], v[12:15]
    v_add_u32 v214, 25728, v219
    v_add_u32 v215, 51456, v218
    v_mfma_f32_16x16x32_bf16 v[16:19], v[152:155], v[148:151], v[16:19]
    v_add_u32 v217, 51456, v219
    s_mov_b64 s[44:45], s[40:41]
    v_mfma_f32_16x16x32_bf16 v[20:23], v[140:143], v[148:151], v[20:23]
    ds_read_b128 v[148:151], v220 offset:5920
    s_mov_b32 s47, s43
    s_waitcnt lgkmcnt(6)
    v_mfma_f32_16x16x32_bf16 v[12:15], v[132:135], v[92:95], v[12:15]
    ds_read_b128 v[132:135], v220 offset:1568
    v_mfma_f32_16x16x32_bf16 v[16:19], v[152:155], v[92:95], v[16:19]
    buffer_load_dwordx4 a[104:107], v230, s[40:43], s100 offen offset:1024
    v_mfma_f32_16x16x32_bf16 v[20:23], v[140:143], v[92:95], v[20:23]
    ds_read_b128 v[92:95], v220 offset:6176
    v_mfma_f32_16x16x32_bf16 v[12:15], v[152:155], v[96:99], v[12:15]
    s_cmp_ge_u32 s2, 224
    s_cselect_b32 s46, 0, s42
    v_mfma_f32_16x16x32_bf16 v[16:19], v[100:103], v[96:99], v[16:19]
    ds_read_b128 v[96:99], v220 offset:1824
    v_lshrrev_b32 v216, 5, v227
    v_mfma_f32_16x16x32_bf16 v[12:15], v[152:155], v[104:107], v[12:15]
    ds_read2_b64 v[152:155], v219 offset0:136 offset1:137
    v_mul_u32_u24 v216, 8160, v216
    v_mfma_f32_16x16x32_bf16 v[16:19], v[100:103], v[104:107], v[16:19]
    ds_read_b128 v[104:107], v220 offset:0
    v_add_u32 v216, v216, v227
    v_mfma_f32_16x16x32_bf16 v[12:15], v[100:103], v[108:111], v[12:15]
    v_lshrrev_b32 v226, 5, v227
    v_mul_u32_u24 v226, 8160, v226
    v_mfma_f32_16x16x32_bf16 v[16:19], v[112:115], v[108:111], v[16:19]
    ds_read_b128 v[108:111], v220 offset:6432
    v_add_u32 v226, v226, v227
    s_waitcnt lgkmcnt(6)
    v_mfma_f32_16x16x32_bf16 v[12:15], v[100:103], v[116:119], v[12:15]
    ds_read2_b64 v[100:103], v218 offset0:72 offset1:73
    s_lshl_b32 s60, s21, 4
    v_mfma_f32_16x16x32_bf16 v[16:19], v[112:115], v[116:119], v[16:19]
    ds_read2_b64 v[116:119], v219 offset0:200 offset1:201
    s_add_u32 s60, s60, s20
    v_mfma_f32_16x16x32_bf16 v[12:15], v[112:115], v[120:123], v[12:15]
    s_add_u32 s74, s74, 4096
    buffer_store_dwordx4 v[232:235], v227, s[40:43], s74 offen sc1
    v_mfma_f32_16x16x32_bf16 v[16:19], v[128:131], v[120:123], v[16:19]
    ds_read2_b64 v[120:123], v218 offset0:8 offset1:9
    s_bfe_u32 s24, s2, 0x20001
    v_mfma_f32_16x16x32_bf16 v[12:15], v[112:115], v[124:127], v[12:15]
    ds_read_b128 v[112:115], v220 offset:4608
    s_lshl_b32 s24, s24, 2
    v_mfma_f32_16x16x32_bf16 v[16:19], v[128:131], v[124:127], v[16:19]
    ds_read_b128 v[124:127], v220 offset:256
    s_bfe_u32 s61, s2, 0x20003
    v_mfma_f32_16x16x32_bf16 v[12:15], v[128:131], v[144:147], v[12:15]
    buffer_load_dwordx4 a[108:111], v230, s[40:43], s100 offen offset:2048
    v_mfma_f32_16x16x32_bf16 v[16:19], v[136:139], v[144:147], v[16:19]
    ds_read2_b64 v[144:147], v219 offset0:72 offset1:73
    s_add_u32 s24, s24, s61
    v_mfma_f32_16x16x32_bf16 v[12:15], v[128:131], v[148:151], v[12:15]
    ds_read_b128 v[128:131], v220 offset:4864
    s_lshl_b32 s24, s24, 4
    v_mfma_f32_16x16x32_bf16 v[16:19], v[136:139], v[148:151], v[16:19]
    ds_read_b128 v[148:151], v220 offset:512
    s_and_b32 s61, s2, 1
    s_waitcnt lgkmcnt(7)
    v_mfma_f32_16x16x32_bf16 v[12:15], v[136:139], v[132:135], v[12:15]
    s_add_u32 s24, s24, s61
    s_add_u32 s24, s24, 14
    v_mfma_f32_16x16x32_bf16 v[16:19], v[140:143], v[132:135], v[16:19]
    ds_read2_b64 v[132:135], v219 offset0:8 offset1:9
    v_mfma_f32_16x16x32_bf16 v[12:15], v[136:139], v[92:95], v[12:15]
    ds_read_b128 v[136:139], v220 offset:5120
    v_mfma_f32_16x16x32_bf16 v[16:19], v[140:143], v[92:95], v[16:19]
    ds_read_b128 v[92:95], v220 offset:768
    v_mfma_f32_16x16x32_bf16 v[12:15], v[140:143], v[96:99], v[12:15]
    ds_read2_b64 v[96:99], v218 offset0:200 offset1:201
    v_mfma_f32_16x16x32_bf16 v[16:19], v[152:155], v[104:107], v[16:19]
    buffer_load_dwordx4 a[112:115], v230, s[40:43], s100 offen offset:3072
    v_mfma_f32_16x16x32_bf16 v[12:15], v[140:143], v[108:111], v[12:15]
    ds_read_b128 v[140:143], v220 offset:5376
    ds_read_b128 v[108:111], v220 offset:1024
    v_mfma_f32_16x16x32_bf16 v[20:23], v[100:103], v[104:107], v[20:23]
    s_cmp_ge_u32 s2, 224
    s_cselect_b32 s60, s24, s60
    s_waitcnt lgkmcnt(7)
    v_mfma_f32_16x16x32_bf16 v[12:15], v[116:119], v[104:107], v[12:15]
    s_add_u32 s74, s74, 4096
    buffer_store_dwordx4 v[232:235], v227, s[40:43], s74 offen sc1
    v_mfma_f32_16x16x32_bf16 v[24:27], v[120:123], v[104:107], v[24:27]
    ds_read2_b64 v[104:107], v218 offset0:136 offset1:137
    s_mul_i32 s24, s60, 10240
    v_mfma_f32_16x16x32_bf16 v[12:15], v[116:119], v[112:115], v[12:15]
    ds_read_b128 v[116:119], v220 offset:5632
    s_lshl_b32 s25, s60, 4
    v_mfma_f32_16x16x32_bf16 v[16:19], v[152:155], v[112:115], v[16:19]
    s_lshr_b32 s77, s25, 5
    s_mul_i32 s77, s77, 8160
    v_mfma_f32_16x16x32_bf16 v[20:23], v[100:103], v[112:115], v[20:23]
    s_add_u32 s77, s77, s25
    s_add_u32 s77, s77, 9437184
    v_mfma_f32_16x16x32_bf16 v[24:27], v[120:123], v[112:115], v[24:27]
    ds_read_b128 v[112:115], v220 offset:1280
    s_lshr_b32 s75, s25, 5
    v_mfma_f32_16x16x32_bf16 v[12:15], v[152:155], v[124:127], v[12:15]
    buffer_load_dwordx4 a[116:119], v231, s[40:43], s100 offen offset:0
    v_mfma_f32_16x16x32_bf16 v[16:19], v[144:147], v[124:127], v[16:19]
    s_mul_i32 s61, s75, 8160
    s_add_u32 s61, s61, s25
    v_mfma_f32_16x16x32_bf16 v[20:23], v[120:123], v[124:127], v[20:23]
    ds_read_b128 v[124:127], v220 offset:5888
    s_add_u32 s61, s61, 8388608
    v_mfma_f32_16x16x32_bf16 v[12:15], v[152:155], v[128:131], v[12:15]
    ds_read_b128 v[152:155], v220 offset:1536
    s_mul_i32 s75, s75, 4064
    v_mfma_f32_16x16x32_bf16 v[16:19], v[144:147], v[128:131], v[16:19]
    ds_write_b128 v221, v[24:27] offset:40320
    v_mfma_f32_16x16x32_bf16 v[20:23], v[120:123], v[128:131], v[20:23]
    ds_read_b128 v[128:131], v220 offset:6144
    s_add_u32 s75, s75, s25
    s_waitcnt lgkmcnt(5)
    v_mfma_f32_16x16x32_bf16 v[12:15], v[144:147], v[148:151], v[12:15]
    s_mul_i32 s25, s3, 1024
    s_add_u32 s75, s75, s25
    v_mfma_f32_16x16x32_bf16 v[16:19], v[132:135], v[148:151], v[16:19]
    ds_read_b128 v[148:151], v220 offset:1792
    s_add_u32 s75, s75, 10485760
    v_mfma_f32_16x16x32_bf16 v[12:15], v[144:147], v[136:139], v[12:15]
    ds_read_b128 v[144:147], v220 offset:6400
    ds_read2_b64 v[60:63], v214 offset0:192 offset1:193
    v_mfma_f32_16x16x32_bf16 v[16:19], v[132:135], v[136:139], v[16:19]
    ds_read_b128 v[64:67], v220 offset:25760
    ds_read2_b64 v[68:71], v214 offset0:128 offset1:129
    v_mfma_f32_16x16x32_bf16 v[12:15], v[132:135], v[92:95], v[12:15]
    ds_read2_b64 v[72:75], v214 offset0:64 offset1:65
    ds_read2_b64 v[76:79], v214 offset0:0 offset1:1
    v_mfma_f32_16x16x32_bf16 v[16:19], v[96:99], v[92:95], v[16:19]
    ds_read2_b64 v[80:83], v213 offset0:192 offset1:193
    ds_read2_b64 v[84:87], v213 offset0:128 offset1:129
    v_mfma_f32_16x16x32_bf16 v[12:15], v[132:135], v[140:143], v[12:15]
    ds_read2_b64 v[88:91], v213 offset0:64 offset1:65
    s_mul_i32 s76, s3, 2816
    v_mfma_f32_16x16x32_bf16 v[16:19], v[96:99], v[140:143], v[16:19]
    ds_write_b128 v221, v[20:23] offset:39168
    v_mfma_f32_16x16x32_bf16 v[12:15], v[96:99], v[108:111], v[12:15]
    s_bfe_u32 s100, s69, 0x80010
    s_mul_i32 s100, s100, 40960
    buffer_load_dwordx4 a[120:123], v230, s[40:43], s100 offen offset:0
    v_mfma_f32_16x16x32_bf16 v[16:19], v[104:107], v[108:111], v[16:19]
    s_add_u32 s76, s76, 151552
    s_mov_b64 s[48:49], s[16:17]
    v_mfma_f32_16x16x32_bf16 v[12:15], v[96:99], v[116:119], v[12:15]
    s_mov_b32 s50, 2621440
    s_mov_b32 s51, 0x00020000
    v_mfma_f32_16x16x32_bf16 v[16:19], v[104:107], v[116:119], v[16:19]
    s_mov_b32 s25, 1187328
    v_lshrrev_b32 v198, 2, v0
    s_waitcnt lgkmcnt(7)
    v_mfma_f32_16x16x32_bf16 v[12:15], v[104:107], v[112:115], v[12:15]
    v_and_b32 v199, 3, v0
    v_mul_u32_u24 v194, 2560, v199
    v_mfma_f32_16x16x32_bf16 v[16:19], v[100:103], v[112:115], v[16:19]
    v_lshl_add_u32 v195, v198, 2, v194
    v_add_u32 v195, 1024, v195
    v_mfma_f32_16x16x32_bf16 v[12:15], v[104:107], v[124:127], v[12:15]
    v_lshl_add_u32 v194, v198, 4, v194
    v_lshlrev_b32 v201, 3, v198
    v_mfma_f32_16x16x32_bf16 v[16:19], v[100:103], v[124:127], v[16:19]
    v_lshlrev_b32 v200, 5, v198
    v_add_u32 v201, 2048, v201
    v_mfma_f32_16x16x32_bf16 v[12:15], v[100:103], v[152:155], v[12:15]
    s_mul_i32 s18, s26, 320
    s_add_u32 s18, s18, 1192448
    v_mfma_f32_16x16x32_bf16 v[16:19], v[120:123], v[152:155], v[16:19]
    buffer_load_dwordx4 a[124:127], v230, s[40:43], s100 offen offset:1024
    v_mfma_f32_16x16x32_bf16 v[12:15], v[100:103], v[128:131], v[12:15]
    v_and_b32 v196, 0x1f0, v1
    v_lshrrev_b32 v197, 2, v2
    v_mfma_f32_16x16x32_bf16 v[16:19], v[120:123], v[128:131], v[16:19]
    v_lshlrev_b32 v197, 4, v197
    v_mfma_f32_16x16x32_bf16 v[12:15], v[120:123], v[148:151], v[12:15]
    v_mfma_f32_16x16x32_bf16 v[12:15], v[120:123], v[144:147], v[12:15]
    s_waitcnt lgkmcnt(0)
    s_branch L_cv_j
L_cv_1:
    s_waitcnt lgkmcnt(0)
    s_barrier
    ds_read2_b64 v[124:127], v219 offset0:64 offset1:65
    ds_read_b128 v[128:131], v220 offset:32
    ds_read2_b64 v[132:135], v219 offset0:0 offset1:1
    ds_read2_b64 v[136:139], v218 offset0:192 offset1:193
    ds_read2_b64 v[140:143], v218 offset0:128 offset1:129
    ds_read_b128 v[144:147], v220 offset:4640
    ds_read_b128 v[148:151], v220 offset:288
    ds_read2_b64 v[152:155], v218 offset0:64 offset1:65
    s_cmp_lg_u32 s3, 0
    s_cbranch_scc1 L_arrB_skip1
    s_mov_b64 exec, 1
    buffer_store_dword v5, v5, s[40:43], s101 offen offset:16 sc1
    s_mov_b64 exec, -1
L_arrB_skip1:
    s_waitcnt lgkmcnt(6)
    v_mfma_f32_16x16x32_bf16 v[12:15], v[124:127], v[128:131], 0
    ds_read_b128 v[92:95], v220 offset:4896
    ds_read_b128 v[96:99], v220 offset:544
    s_waitcnt lgkmcnt(7)
    v_mfma_f32_16x16x32_bf16 v[16:19], v[132:135], v[128:131], 0
    ds_read2_b64 v[100:103], v218 offset0:0 offset1:1
    ds_read_b128 v[104:107], v220 offset:5152
    s_waitcnt lgkmcnt(8)
    v_mfma_f32_16x16x32_bf16 v[20:23], v[136:139], v[128:131], 0
    ds_read_b128 v[108:111], v220 offset:800
    ds_read_b128 v[112:115], v220 offset:5408
    s_waitcnt lgkmcnt(9)
    v_mfma_f32_16x16x32_bf16 v[24:27], v[140:143], v[128:131], 0
    ds_read_b128 v[116:119], v220 offset:1056
    ds_read_b128 v[120:123], v220 offset:5664
    s_waitcnt lgkmcnt(10)
    v_mfma_f32_16x16x32_bf16 v[12:15], v[124:127], v[144:147], v[12:15]
    ds_read_b128 v[128:131], v220 offset:1312
    ds_read2_b64 v[124:127], v219 offset0:8 offset1:9
    v_mfma_f32_16x16x32_bf16 v[16:19], v[132:135], v[144:147], v[16:19]
    s_mul_i32 s74, s2, 37888
    s_add_u32 s74, s74, 13627392
    v_mfma_f32_16x16x32_bf16 v[20:23], v[136:139], v[144:147], v[20:23]
    s_add_u32 s74, s74, 4096
    buffer_store_dwordx4 v[232:235], v227, s[40:43], s74 offen sc1
    v_mfma_f32_16x16x32_bf16 v[24:27], v[140:143], v[144:147], v[24:27]
    ds_read_b128 v[144:147], v220 offset:0
    v_add_u32 v213, 25728, v218
    s_waitcnt lgkmcnt(11)
    v_mfma_f32_16x16x32_bf16 v[12:15], v[132:135], v[148:151], v[12:15]
    v_add_u32 v214, 25728, v219
    v_add_u32 v215, 51456, v218
    v_mfma_f32_16x16x32_bf16 v[16:19], v[136:139], v[148:151], v[16:19]
    v_add_u32 v217, 51456, v219
    s_mov_b64 s[44:45], s[40:41]
    v_mfma_f32_16x16x32_bf16 v[20:23], v[140:143], v[148:151], v[20:23]
    buffer_load_dwordx4 a[104:107], v230, s[40:43], s100 offen offset:1024
    v_mfma_f32_16x16x32_bf16 v[24:27], v[152:155], v[148:151], v[24:27]
    ds_read_b128 v[148:151], v220 offset:5920
    s_mov_b32 s47, s43
    s_waitcnt lgkmcnt(5)
    v_mfma_f32_16x16x32_bf16 v[12:15], v[132:135], v[92:95], v[12:15]
    ds_read2_b64 v[132:135], v218 offset0:200 offset1:201
    v_mfma_f32_16x16x32_bf16 v[16:19], v[136:139], v[92:95], v[16:19]
    s_cmp_ge_u32 s2, 224
    s_cselect_b32 s46, 0, s42
    v_mfma_f32_16x16x32_bf16 v[20:23], v[140:143], v[92:95], v[20:23]
    v_lshrrev_b32 v216, 5, v227
    v_mul_u32_u24 v216, 8160, v216
    v_mfma_f32_16x16x32_bf16 v[24:27], v[152:155], v[92:95], v[24:27]
    ds_read2_b64 v[92:95], v219 offset0:72 offset1:73
    v_add_u32 v216, v216, v227
    v_mfma_f32_16x16x32_bf16 v[12:15], v[136:139], v[96:99], v[12:15]
    v_lshrrev_b32 v226, 5, v227
    v_mul_u32_u24 v226, 8160, v226
    v_mfma_f32_16x16x32_bf16 v[16:19], v[140:143], v[96:99], v[16:19]
    v_add_u32 v226, v226, v227
    s_lshl_b32 s60, s21, 4
    v_mfma_f32_16x16x32_bf16 v[20:23], v[152:155], v[96:99], v[20:23]
    s_add_u32 s60, s60, s20
    s_bfe_u32 s24, s2, 0x20001
    v_mfma_f32_16x16x32_bf16 v[24:27], v[100:103], v[96:99], v[24:27]
    ds_read2_b64 v[96:99], v218 offset0:136 offset1:137
    s_lshl_b32 s24, s24, 2
    v_mfma_f32_16x16x32_bf16 v[12:15], v[136:139], v[104:107], v[12:15]
    ds_read_b128 v[136:139], v220 offset:4608
    s_bfe_u32 s61, s2, 0x20003
    v_mfma_f32_16x16x32_bf16 v[16:19], v[140:143], v[104:107], v[16:19]
    buffer_load_dwordx4 a[108:111], v230, s[40:43], s100 offen offset:2048
    v_mfma_f32_16x16x32_bf16 v[20:23], v[152:155], v[104:107], v[20:23]
    s_add_u32 s74, s74, 4096
    buffer_store_dwordx4 v[232:235], v227, s[40:43], s74 offen sc1
    v_mfma_f32_16x16x32_bf16 v[24:27], v[100:103], v[104:107], v[24:27]
    ds_read_b128 v[104:107], v220 offset:256
    s_add_u32 s24, s24, s61
    v_mfma_f32_16x16x32_bf16 v[12:15], v[140:143], v[108:111], v[12:15]
    s_lshl_b32 s24, s24, 4
    s_and_b32 s61, s2, 1
    v_mfma_f32_16x16x32_bf16 v[16:19], v[152:155], v[108:111], v[16:19]
    s_add_u32 s24, s24, s61
    s_add_u32 s24, s24, 14
    v_mfma_f32_16x16x32_bf16 v[20:23], v[100:103], v[108:111], v[20:23]
    ds_read2_b64 v[108:111], v218 offset0:72 offset1:73
    v_mfma_f32_16x16x32_bf16 v[12:15], v[140:143], v[112:115], v[12:15]
    ds_read_b128 v[140:143], v220 offset:4864
    v_mfma_f32_16x16x32_bf16 v[16:19], v[152:155], v[112:115], v[16:19]
    s_cmp_ge_u32 s2, 224
    s_cselect_b32 s60, s24, s60
    v_mfma_f32_16x16x32_bf16 v[20:23], v[100:103], v[112:115], v[20:23]
    ds_read_b128 v[112:115], v220 offset:512
    s_mul_i32 s24, s60, 10240
    v_mfma_f32_16x16x32_bf16 v[12:15], v[152:155], v[116:119], v[12:15]
    buffer_load_dwordx4 a[112:115], v230, s[40:43], s100 offen offset:3072
    v_mfma_f32_16x16x32_bf16 v[16:19], v[100:103], v[116:119], v[16:19]
    ds_read2_b64 v[116:119], v218 offset0:8 offset1:9
    s_lshl_b32 s25, s60, 4
    s_waitcnt lgkmcnt(5)
    v_mfma_f32_16x16x32_bf16 v[12:15], v[152:155], v[120:123], v[12:15]
    ds_read_b128 v[152:155], v220 offset:5120
    s_lshr_b32 s77, s25, 5
    v_mfma_f32_16x16x32_bf16 v[16:19], v[100:103], v[120:123], v[16:19]
    ds_read_b128 v[120:123], v220 offset:768
    s_mul_i32 s77, s77, 8160
    v_mfma_f32_16x16x32_bf16 v[12:15], v[100:103], v[128:131], v[12:15]
    ds_read_b128 v[128:131], v220 offset:5376
    s_add_u32 s77, s77, s25
    v_mfma_f32_16x16x32_bf16 v[16:19], v[124:127], v[144:147], v[16:19]
    s_add_u32 s77, s77, 9437184
    s_lshr_b32 s75, s25, 5
    v_mfma_f32_16x16x32_bf16 v[12:15], v[100:103], v[148:151], v[12:15]
    ds_read_b128 v[100:103], v220 offset:1024
    ds_read_b128 v[148:151], v220 offset:5632
    v_mfma_f32_16x16x32_bf16 v[20:23], v[132:135], v[144:147], v[20:23]
    s_mul_i32 s61, s75, 8160
    s_add_u32 s61, s61, s25
    v_mfma_f32_16x16x32_bf16 v[12:15], v[92:95], v[144:147], v[12:15]
    s_add_u32 s74, s74, 4096
    buffer_store_dwordx4 v[232:235], v227, s[40:43], s74 offen sc1
    v_mfma_f32_16x16x32_bf16 v[24:27], v[96:99], v[144:147], v[24:27]
    ds_read_b128 v[144:147], v220 offset:1280
    s_add_u32 s61, s61, 8388608
    v_mfma_f32_16x16x32_bf16 v[12:15], v[92:95], v[136:139], v[12:15]
    ds_read_b128 v[92:95], v220 offset:5888
    ds_read2_b64 v[60:63], v214 offset0:192 offset1:193
    v_mfma_f32_16x16x32_bf16 v[16:19], v[124:127], v[136:139], v[16:19]
    ds_read_b128 v[64:67], v220 offset:25760
    ds_read2_b64 v[68:71], v214 offset0:128 offset1:129
    v_mfma_f32_16x16x32_bf16 v[20:23], v[132:135], v[136:139], v[20:23]
    ds_read2_b64 v[72:75], v214 offset0:64 offset1:65
    ds_read2_b64 v[76:79], v214 offset0:0 offset1:1
    v_mfma_f32_16x16x32_bf16 v[24:27], v[96:99], v[136:139], v[24:27]
    ds_read2_b64 v[80:83], v213 offset0:192 offset1:193
    ds_read2_b64 v[84:87], v213 offset0:128 offset1:129
    s_waitcnt lgkmcnt(11)
    v_mfma_f32_16x16x32_bf16 v[12:15], v[124:127], v[104:107], v[12:15]
    ds_read2_b64 v[88:91], v213 offset0:64 offset1:65
    s_mul_i32 s75, s75, 4064
    v_mfma_f32_16x16x32_bf16 v[16:19], v[132:135], v[104:107], v[16:19]
    buffer_load_dwordx4 a[116:119], v231, s[40:43], s100 offen offset:0
    v_mfma_f32_16x16x32_bf16 v[20:23], v[96:99], v[104:107], v[20:23]
    s_add_u32 s75, s75, s25
    s_mul_i32 s25, s3, 1024
    v_mfma_f32_16x16x32_bf16 v[24:27], v[108:111], v[104:107], v[24:27]
    s_add_u32 s75, s75, s25
    s_add_u32 s75, s75, 10485760
    v_mfma_f32_16x16x32_bf16 v[12:15], v[124:127], v[140:143], v[12:15]
    s_mul_i32 s76, s3, 2816
    s_add_u32 s76, s76, 151552
    v_mfma_f32_16x16x32_bf16 v[16:19], v[132:135], v[140:143], v[16:19]
    s_mov_b64 s[48:49], s[16:17]
    s_mov_b32 s50, 2621440
    v_mfma_f32_16x16x32_bf16 v[20:23], v[96:99], v[140:143], v[20:23]
    s_mov_b32 s51, 0x00020000
    s_mov_b32 s25, 1187328
    v_mfma_f32_16x16x32_bf16 v[24:27], v[108:111], v[140:143], v[24:27]
    v_lshrrev_b32 v198, 2, v0
    v_and_b32 v199, 3, v0
    v_mfma_f32_16x16x32_bf16 v[12:15], v[132:135], v[112:115], v[12:15]
    v_mul_u32_u24 v194, 2560, v199
    v_lshl_add_u32 v195, v198, 2, v194
    v_mfma_f32_16x16x32_bf16 v[16:19], v[96:99], v[112:115], v[16:19]
    v_add_u32 v195, 1024, v195
    v_lshl_add_u32 v194, v198, 4, v194
    v_mfma_f32_16x16x32_bf16 v[20:23], v[108:111], v[112:115], v[20:23]
    s_bfe_u32 s100, s69, 0x80010
    s_mul_i32 s100, s100, 40960
    buffer_load_dwordx4 a[120:123], v230, s[40:43], s100 offen offset:0
    v_mfma_f32_16x16x32_bf16 v[24:27], v[116:119], v[112:115], v[24:27]
    v_lshlrev_b32 v201, 3, v198
    v_lshlrev_b32 v200, 5, v198
    v_mfma_f32_16x16x32_bf16 v[12:15], v[132:135], v[152:155], v[12:15]
    v_add_u32 v201, 2048, v201
    s_mul_i32 s18, s26, 320
    v_mfma_f32_16x16x32_bf16 v[16:19], v[96:99], v[152:155], v[16:19]
    s_add_u32 s18, s18, 1192448
    v_and_b32 v196, 0x1f0, v1
    v_mfma_f32_16x16x32_bf16 v[20:23], v[108:111], v[152:155], v[20:23]
    v_lshrrev_b32 v197, 2, v2
    v_lshlrev_b32 v197, 4, v197
    v_mfma_f32_16x16x32_bf16 v[24:27], v[116:119], v[152:155], v[24:27]
    v_mfma_f32_16x16x32_bf16 v[12:15], v[96:99], v[120:123], v[12:15]
    v_mfma_f32_16x16x32_bf16 v[16:19], v[108:111], v[120:123], v[16:19]
    v_mfma_f32_16x16x32_bf16 v[20:23], v[116:119], v[120:123], v[20:23]
    v_mfma_f32_16x16x32_bf16 v[12:15], v[96:99], v[128:131], v[12:15]
    buffer_load_dwordx4 a[124:127], v230, s[40:43], s100 offen offset:1024
    v_mfma_f32_16x16x32_bf16 v[16:19], v[108:111], v[128:131], v[16:19]
    s_nop 1
    ds_write_b128 v221, v[24:27] offset:40320
    v_mfma_f32_16x16x32_bf16 v[20:23], v[116:119], v[128:131], v[20:23]
    s_waitcnt lgkmcnt(1)
    v_mfma_f32_16x16x32_bf16 v[12:15], v[108:111], v[100:103], v[12:15]
    v_mfma_f32_16x16x32_bf16 v[16:19], v[116:119], v[100:103], v[16:19]
    v_mfma_f32_16x16x32_bf16 v[12:15], v[108:111], v[148:151], v[12:15]
    v_mfma_f32_16x16x32_bf16 v[16:19], v[116:119], v[148:151], v[16:19]
    v_mfma_f32_16x16x32_bf16 v[12:15], v[116:119], v[144:147], v[12:15]
    s_nop 1
    ds_write_b128 v221, v[20:23] offset:39168
    v_mfma_f32_16x16x32_bf16 v[12:15], v[116:119], v[92:95], v[12:15]
    s_waitcnt lgkmcnt(0)
L_cv_j:
    v_mfma_f32_16x16x32_bf16 v[56:59], v[60:63], v[64:67], 0
    ds_read2_b64 v[92:95], v213 offset0:0 offset1:1
    ds_read_b128 v[96:99], v220 offset:30368
    v_mfma_f32_16x16x32_bf16 v[52:55], v[68:71], v[64:67], 0
    ds_read_b128 v[100:103], v220 offset:26016
    ds_read_b128 v[104:107], v220 offset:30624
    v_mfma_f32_16x16x32_bf16 v[48:51], v[72:75], v[64:67], 0
    ds_read_b128 v[108:111], v220 offset:26272
    ds_read_b128 v[112:115], v220 offset:30880
    v_mfma_f32_16x16x32_bf16 v[44:47], v[76:79], v[64:67], 0
    ds_read_b128 v[116:119], v220 offset:26528
    ds_read_b128 v[120:123], v220 offset:31136
    v_mfma_f32_16x16x32_bf16 v[40:43], v[80:83], v[64:67], 0
    ds_read_b128 v[124:127], v220 offset:26784
    ds_read_b128 v[128:131], v220 offset:31392
    v_mfma_f32_16x16x32_bf16 v[36:39], v[84:87], v[64:67], 0
    ds_read_b128 v[132:135], v220 offset:27040
    ds_read_b128 v[136:139], v220 offset:31648
    v_mfma_f32_16x16x32_bf16 v[32:35], v[88:91], v[64:67], 0
    ds_read_b128 v[140:143], v220 offset:27296
    ds_read_b128 v[144:147], v220 offset:31904
    s_waitcnt lgkmcnt(13)
    v_mfma_f32_16x16x32_bf16 v[28:31], v[92:95], v[64:67], 0
    ds_read_b128 v[148:151], v220 offset:27552
    ds_read2_b64 v[152:155], v214 offset0:136 offset1:137
    s_waitcnt lgkmcnt(14)
    v_mfma_f32_16x16x32_bf16 v[56:59], v[60:63], v[96:99], v[56:59]
    ds_write_b128 v221, v[16:19] offset:38016
    v_mfma_f32_16x16x32_bf16 v[52:55], v[68:71], v[96:99], v[52:55]
    ds_read_b64 v[204:205], v225
    v_mfma_f32_16x16x32_bf16 v[48:51], v[72:75], v[96:99], v[48:51]
    s_add_u32 s74, s74, 4096
    buffer_store_dwordx4 v[232:235], v227, s[40:43], s74 offen sc1
    v_mfma_f32_16x16x32_bf16 v[44:47], v[76:79], v[96:99], v[44:47]
    ds_write_b128 v221, v[12:15] offset:36864
    v_mfma_f32_16x16x32_bf16 v[40:43], v[80:83], v[96:99], v[40:43]
    buffer_load_dwordx4 v[164:167], v194, s[48:51], s24 offen
    v_mfma_f32_16x16x32_bf16 v[36:39], v[84:87], v[96:99], v[36:39]
    v_mfma_f32_16x16x32_bf16 v[32:35], v[88:91], v[96:99], v[32:35]
    s_waitcnt lgkmcnt(1)
    v_lshlrev_b32 v206, 16, v204
    v_mfma_f32_16x16x32_bf16 v[28:31], v[92:95], v[96:99], v[28:31]
    ds_read_b128 v[96:99], v220 offset:25728
    v_and_b32 v207, 0xffff0000, v204
    v_mfma_f32_16x16x32_bf16 v[56:59], v[68:71], v[100:103], v[56:59]
    v_lshlrev_b32 v208, 16, v205
    v_and_b32 v209, 0xffff0000, v205
    v_mfma_f32_16x16x32_bf16 v[52:55], v[72:75], v[100:103], v[52:55]
    v_mul_f32 v206, s63, v206
    v_mul_f32 v207, s63, v207
    v_mfma_f32_16x16x32_bf16 v[48:51], v[76:79], v[100:103], v[48:51]
    v_mul_f32 v208, s63, v208
    v_mul_f32 v209, s63, v209
    v_mfma_f32_16x16x32_bf16 v[44:47], v[80:83], v[100:103], v[44:47]
    buffer_load_dwordx4 v[168:171], v194, s[48:51], s24 offen offset:1280
    v_mfma_f32_16x16x32_bf16 v[40:43], v[84:87], v[100:103], v[40:43]
    v_cvt_pk_bf16_f32 v204, v206, v207
    v_cvt_pk_bf16_f32 v205, v208, v209
    v_mfma_f32_16x16x32_bf16 v[36:39], v[88:91], v[100:103], v[36:39]
    v_lshlrev_b32 v206, 16, v204
    v_and_b32 v207, 0xffff0000, v204
    v_mfma_f32_16x16x32_bf16 v[32:35], v[92:95], v[100:103], v[32:35]
    ds_read_b128 v[100:103], v220 offset:32160
    v_lshlrev_b32 v208, 16, v205
    v_mfma_f32_16x16x32_bf16 v[56:59], v[68:71], v[104:107], v[56:59]
    v_and_b32 v209, 0xffff0000, v205
    v_mfma_f32_16x16x32_bf16 v[52:55], v[72:75], v[104:107], v[52:55]
    v_mfma_f32_16x16x32_bf16 v[48:51], v[76:79], v[104:107], v[48:51]
    v_mfma_f32_16x16x32_bf16 v[44:47], v[80:83], v[104:107], v[44:47]
    buffer_load_dword v172, v195, s[48:51], s24 offen
    v_mfma_f32_16x16x32_bf16 v[40:43], v[84:87], v[104:107], v[40:43]
    v_mfma_f32_16x16x32_bf16 v[36:39], v[88:91], v[104:107], v[36:39]
    s_waitcnt lgkmcnt(2)
    s_barrier
    v_mfma_f32_16x16x32_bf16 v[32:35], v[92:95], v[104:107], v[32:35]
    ds_read2_b64 v[104:107], v214 offset0:72 offset1:73
    ds_read_b128 v[12:15], v223 offset:36864
    v_mfma_f32_16x16x32_bf16 v[56:59], v[72:75], v[108:111], v[56:59]
    ds_read_b128 v[16:19], v223 offset:46080
    ds_read_b128 v[20:23], v223 offset:55296
    v_mfma_f32_16x16x32_bf16 v[52:55], v[76:79], v[108:111], v[52:55]
    ds_read_b128 v[24:27], v223 offset:64512
    v_mfma_f32_16x16x32_bf16 v[48:51], v[80:83], v[108:111], v[48:51]
    buffer_load_dword v173, v195, s[48:51], s24 offen offset:1280
    v_mfma_f32_16x16x32_bf16 v[44:47], v[84:87], v[108:111], v[44:47]
    v_mfma_f32_16x16x32_bf16 v[40:43], v[88:91], v[108:111], v[40:43]
    s_add_u32 s74, s74, 4096
    buffer_store_dwordx4 v[232:235], v227, s[40:43], s74 offen sc1
    v_mfma_f32_16x16x32_bf16 v[36:39], v[92:95], v[108:111], v[36:39]
    ds_read2_b64 v[108:111], v214 offset0:200 offset1:201
    v_mfma_f32_16x16x32_bf16 v[56:59], v[72:75], v[112:115], v[56:59]
    buffer_load_dwordx4 a[128:131], v230, s[40:43], s100 offen offset:2048
    v_mfma_f32_16x16x32_bf16 v[52:55], v[76:79], v[112:115], v[52:55]
    s_waitcnt lgkmcnt(1)
    v_add_f32 v12, v12, v16
    v_mfma_f32_16x16x32_bf16 v[48:51], v[80:83], v[112:115], v[48:51]
    v_add_f32 v20, v20, v24
    v_add_f32 v13, v13, v17
    v_mfma_f32_16x16x32_bf16 v[44:47], v[84:87], v[112:115], v[44:47]
    v_add_f32 v21, v21, v25
    v_add_f32 v14, v14, v18
    v_mfma_f32_16x16x32_bf16 v[40:43], v[88:91], v[112:115], v[40:43]
    v_add_f32 v22, v22, v26
    v_add_f32 v15, v15, v19
    v_mfma_f32_16x16x32_bf16 v[36:39], v[92:95], v[112:115], v[36:39]
    ds_read2_b64 v[112:115], v214 offset0:8 offset1:9
    v_add_f32 v23, v23, v27
    v_mfma_f32_16x16x32_bf16 v[56:59], v[76:79], v[116:119], v[56:59]
    v_add_f32 v12, v12, v20
    v_add_f32 v13, v13, v21
    v_mfma_f32_16x16x32_bf16 v[52:55], v[80:83], v[116:119], v[52:55]
    buffer_load_dwordx4 a[132:135], v230, s[40:43], s100 offen offset:3072
    v_mfma_f32_16x16x32_bf16 v[48:51], v[84:87], v[116:119], v[48:51]
    v_add_f32 v14, v14, v22
    v_add_f32 v15, v15, v23
    v_mfma_f32_16x16x32_bf16 v[44:47], v[88:91], v[116:119], v[44:47]
    v_cvt_pk_bf16_f32 v16, v12, v13
    v_cvt_pk_bf16_f32 v17, v14, v15
    v_mfma_f32_16x16x32_bf16 v[40:43], v[92:95], v[116:119], v[40:43]
    ds_read2_b64 v[116:119], v213 offset0:200 offset1:201
    v_lshlrev_b32 v12, 16, v16
    v_mfma_f32_16x16x32_bf16 v[56:59], v[76:79], v[120:123], v[56:59]
    v_and_b32 v13, 0xffff0000, v16
    v_lshlrev_b32 v14, 16, v17
    v_mfma_f32_16x16x32_bf16 v[52:55], v[80:83], v[120:123], v[52:55]
    v_and_b32 v15, 0xffff0000, v17
    v_add_f32 v12, v12, v206
    v_mfma_f32_16x16x32_bf16 v[48:51], v[84:87], v[120:123], v[48:51]
    v_add_f32 v13, v13, v207
    v_add_f32 v14, v14, v208
    v_mfma_f32_16x16x32_bf16 v[44:47], v[88:91], v[120:123], v[44:47]
    buffer_load_dwordx4 a[136:139], v231, s[40:43], s100 offen offset:0
    v_mfma_f32_16x16x32_bf16 v[40:43], v[92:95], v[120:123], v[40:43]
    ds_read2_b64 v[120:123], v213 offset0:136 offset1:137
    v_add_f32 v15, v15, v209
    v_mfma_f32_16x16x32_bf16 v[56:59], v[80:83], v[124:127], v[56:59]
    v_cvt_pk_bf16_f32 v16, v12, v13
    v_cvt_pk_bf16_f32 v17, v14, v15
    v_mfma_f32_16x16x32_bf16 v[52:55], v[84:87], v[124:127], v[52:55]
    v_lshlrev_b32 v12, 16, v16
    v_and_b32 v13, 0xffff0000, v16
    v_mfma_f32_16x16x32_bf16 v[48:51], v[88:91], v[124:127], v[48:51]
    v_lshlrev_b32 v14, 16, v17
    v_and_b32 v15, 0xffff0000, v17
    v_mfma_f32_16x16x32_bf16 v[44:47], v[92:95], v[124:127], v[44:47]
    ds_read2_b64 v[124:127], v213 offset0:72 offset1:73
    v_mul_f32 v12, s86, v12
    v_mfma_f32_16x16x32_bf16 v[56:59], v[80:83], v[128:131], v[56:59]
    v_mul_f32 v13, s86, v13
    v_mul_f32 v14, s86, v14
    v_mfma_f32_16x16x32_bf16 v[52:55], v[84:87], v[128:131], v[52:55]
    s_bfe_u32 s100, s69, 0x80018
    s_mul_i32 s100, s100, 40960
    buffer_load_dwordx4 a[140:143], v230, s[40:43], s100 offen offset:0
    v_mfma_f32_16x16x32_bf16 v[48:51], v[88:91], v[128:131], v[48:51]
    s_add_u32 s74, s74, 4096
    buffer_store_dwordx4 v[232:235], v227, s[40:43], s74 offen sc1
    v_mfma_f32_16x16x32_bf16 v[44:47], v[92:95], v[128:131], v[44:47]
    ds_read2_b64 v[128:131], v213 offset0:8 offset1:9
    v_mul_f32 v15, s86, v15
    v_mfma_f32_16x16x32_bf16 v[56:59], v[84:87], v[132:135], v[56:59]
    v_cvt_pk_bf16_f32 v16, v12, v13
    v_cvt_pk_bf16_f32 v17, v14, v15
    v_mfma_f32_16x16x32_bf16 v[52:55], v[88:91], v[132:135], v[52:55]
    v_lshl_add_u32 v197, v2, 5, v197
    v_add_u32 v197, s76, v197
    v_mfma_f32_16x16x32_bf16 v[48:51], v[92:95], v[132:135], v[48:51]
    ds_read_b128 v[132:135], v220 offset:30336
    v_mul_u32_u24 v240, 32, v0
    v_mfma_f32_16x16x32_bf16 v[56:59], v[84:87], v[136:139], v[56:59]
    buffer_load_dwordx4 a[144:147], v230, s[40:43], s100 offen offset:1024
    v_mfma_f32_16x16x32_bf16 v[52:55], v[88:91], v[136:139], v[52:55]
    v_mul_u32_u24 v241, 32, v0
    v_add_u32 v202, s76, v196
    v_mfma_f32_16x16x32_bf16 v[48:51], v[92:95], v[136:139], v[48:51]
    ds_read_b128 v[136:139], v220 offset:25984
    v_mul_u32_u24 v196, 2, v196
    v_mfma_f32_16x16x32_bf16 v[56:59], v[88:91], v[140:143], v[56:59]
    v_lshrrev_b32 v212, 2, v2
    v_mul_u32_u24 v203, 144, v212
    v_mfma_f32_16x16x32_bf16 v[52:55], v[92:95], v[140:143], v[52:55]
    ds_read_b128 v[140:143], v220 offset:30592
    v_lshl_add_u32 v203, v199, 2, v203
    v_mfma_f32_16x16x32_bf16 v[56:59], v[88:91], v[144:147], v[56:59]
    v_add_u32 v203, s76, v203
    v_lshlrev_b32 v212, 5, v212
    v_mfma_f32_16x16x32_bf16 v[52:55], v[92:95], v[144:147], v[52:55]
    ds_read_b128 v[144:147], v220 offset:26240
    v_lshl_add_u32 v212, v199, 2, v212
    v_mfma_f32_16x16x32_bf16 v[56:59], v[92:95], v[148:151], v[56:59]
    ds_read_b128 v[148:151], v220 offset:30848
    v_add_u32 v212, s76, v212
    v_mfma_f32_16x16x32_bf16 v[52:55], v[152:155], v[96:99], v[52:55]
    buffer_load_dwordx4 a[148:151], v230, s[40:43], s100 offen offset:2048
    v_mfma_f32_16x16x32_bf16 v[56:59], v[92:95], v[100:103], v[56:59]
    ds_read_b128 v[92:95], v220 offset:26496
    ds_read_b128 v[100:103], v220 offset:31104
    v_mfma_f32_16x16x32_bf16 v[48:51], v[104:107], v[96:99], v[48:51]
    v_add_u32 v212, 2304, v212
    s_waitcnt lgkmcnt(6)
    v_mfma_f32_16x16x32_bf16 v[56:59], v[108:111], v[96:99], v[56:59]
    v_mfma_f32_16x16x32_bf16 v[44:47], v[112:115], v[96:99], v[44:47]
    v_mfma_f32_16x16x32_bf16 v[40:43], v[116:119], v[96:99], v[40:43]
    v_mfma_f32_16x16x32_bf16 v[36:39], v[120:123], v[96:99], v[36:39]
    v_mfma_f32_16x16x32_bf16 v[32:35], v[124:127], v[96:99], v[32:35]
    buffer_load_dwordx4 a[152:155], v230, s[40:43], s100 offen offset:3072
    v_mfma_f32_16x16x32_bf16 v[28:31], v[128:131], v[96:99], v[28:31]
    ds_read_b128 v[96:99], v220 offset:26752
    v_mfma_f32_16x16x32_bf16 v[56:59], v[108:111], v[132:135], v[56:59]
    ds_read_b128 v[108:111], v220 offset:31360
    v_mfma_f32_16x16x32_bf16 v[52:55], v[152:155], v[132:135], v[52:55]
    v_mfma_f32_16x16x32_bf16 v[48:51], v[104:107], v[132:135], v[48:51]
    v_mfma_f32_16x16x32_bf16 v[44:47], v[112:115], v[132:135], v[44:47]
    s_add_u32 s74, s74, 4096
    buffer_store_dwordx4 v[232:235], v227, s[40:43], s74 offen sc1
    v_mfma_f32_16x16x32_bf16 v[40:43], v[116:119], v[132:135], v[40:43]
    buffer_load_dwordx4 a[156:159], v231, s[40:43], s100 offen offset:0
    v_mfma_f32_16x16x32_bf16 v[36:39], v[120:123], v[132:135], v[36:39]
    v_mfma_f32_16x16x32_bf16 v[32:35], v[124:127], v[132:135], v[32:35]
    v_mfma_f32_16x16x32_bf16 v[28:31], v[128:131], v[132:135], v[28:31]
    ds_read_b128 v[132:135], v220 offset:27008
    s_waitcnt lgkmcnt(3)
    v_mfma_f32_16x16x32_bf16 v[56:59], v[152:155], v[136:139], v[56:59]
    v_mfma_f32_16x16x32_bf16 v[52:55], v[104:107], v[136:139], v[52:55]
    v_mfma_f32_16x16x32_bf16 v[48:51], v[112:115], v[136:139], v[48:51]
    v_mfma_f32_16x16x32_bf16 v[44:47], v[116:119], v[136:139], v[44:47]
    s_bfe_u32 s100, s70, 0x80000
    s_mul_i32 s100, s100, 40960
    buffer_load_dwordx4 a[160:163], v230, s[40:43], s100 offen offset:0
    v_mfma_f32_16x16x32_bf16 v[40:43], v[120:123], v[136:139], v[40:43]
    ds_write_b128 v221, v[28:31] offset:0
    v_mfma_f32_16x16x32_bf16 v[36:39], v[124:127], v[136:139], v[36:39]
    v_mfma_f32_16x16x32_bf16 v[32:35], v[128:131], v[136:139], v[32:35]
    ds_read_b128 v[136:139], v220 offset:31616
    v_mfma_f32_16x16x32_bf16 v[56:59], v[152:155], v[140:143], v[56:59]
    ds_read_b128 v[152:155], v220 offset:27264
    v_mfma_f32_16x16x32_bf16 v[52:55], v[104:107], v[140:143], v[52:55]
    v_mfma_f32_16x16x32_bf16 v[48:51], v[112:115], v[140:143], v[48:51]
    buffer_load_dwordx4 a[164:167], v230, s[40:43], s100 offen offset:1024
    v_mfma_f32_16x16x32_bf16 v[44:47], v[116:119], v[140:143], v[44:47]
    v_mfma_f32_16x16x32_bf16 v[40:43], v[120:123], v[140:143], v[40:43]
    v_mfma_f32_16x16x32_bf16 v[36:39], v[124:127], v[140:143], v[36:39]
    v_mfma_f32_16x16x32_bf16 v[32:35], v[128:131], v[140:143], v[32:35]
    ds_read_b128 v[140:143], v220 offset:31872
    v_mfma_f32_16x16x32_bf16 v[56:59], v[104:107], v[144:147], v[56:59]
    v_mfma_f32_16x16x32_bf16 v[52:55], v[112:115], v[144:147], v[52:55]
    v_mfma_f32_16x16x32_bf16 v[48:51], v[116:119], v[144:147], v[48:51]
    buffer_load_dwordx4 a[168:171], v230, s[40:43], s100 offen offset:2048
    v_mfma_f32_16x16x32_bf16 v[44:47], v[120:123], v[144:147], v[44:47]
    v_mfma_f32_16x16x32_bf16 v[40:43], v[124:127], v[144:147], v[40:43]
    s_nop 0
    ds_write_b128 v221, v[32:35] offset:1152
    v_mfma_f32_16x16x32_bf16 v[36:39], v[128:131], v[144:147], v[36:39]
    ds_read_b128 v[144:147], v220 offset:27520
    v_mfma_f32_16x16x32_bf16 v[56:59], v[104:107], v[148:151], v[56:59]
    ds_read2_b64 v[104:107], v217 offset0:192 offset1:193
    v_mfma_f32_16x16x32_bf16 v[52:55], v[112:115], v[148:151], v[52:55]
    s_add_u32 s74, s74, 4096
    buffer_store_dwordx4 v[232:235], v227, s[40:43], s74 offen sc1
    v_mfma_f32_16x16x32_bf16 v[48:51], v[116:119], v[148:151], v[48:51]
    buffer_load_dwordx4 a[172:175], v230, s[40:43], s100 offen offset:3072
    v_mfma_f32_16x16x32_bf16 v[44:47], v[120:123], v[148:151], v[44:47]
    v_mfma_f32_16x16x32_bf16 v[40:43], v[124:127], v[148:151], v[40:43]
    v_mfma_f32_16x16x32_bf16 v[36:39], v[128:131], v[148:151], v[36:39]
    ds_read_b128 v[148:151], v220 offset:51488
    v_mfma_f32_16x16x32_bf16 v[56:59], v[112:115], v[92:95], v[56:59]
    v_mfma_f32_16x16x32_bf16 v[52:55], v[116:119], v[92:95], v[52:55]
    v_mfma_f32_16x16x32_bf16 v[48:51], v[120:123], v[92:95], v[48:51]
    v_mfma_f32_16x16x32_bf16 v[44:47], v[124:127], v[92:95], v[44:47]
    buffer_load_dwordx4 a[176:179], v231, s[40:43], s100 offen offset:0
    v_mfma_f32_16x16x32_bf16 v[40:43], v[128:131], v[92:95], v[40:43]
    ds_read_b128 v[92:95], v220 offset:32128
    v_mfma_f32_16x16x32_bf16 v[56:59], v[112:115], v[100:103], v[56:59]
    ds_read2_b64 v[112:115], v217 offset0:128 offset1:129
    v_mfma_f32_16x16x32_bf16 v[52:55], v[116:119], v[100:103], v[52:55]
    ds_write_b128 v221, v[36:39] offset:2304
    v_mfma_f32_16x16x32_bf16 v[48:51], v[120:123], v[100:103], v[48:51]
    s_cmp_eq_u32 s3, 0
    s_cselect_b64 exec, -1, 0
    s_mov_b32 s15, 1048576
    buffer_load_dwordx4 v[236:239], v3, s[40:43], s15 offen offset:16 sc1
    s_mov_b64 exec, -1
    v_mfma_f32_16x16x32_bf16 v[44:47], v[124:127], v[100:103], v[44:47]
    s_bfe_u32 s100, s70, 0x80008
    s_mul_i32 s100, s100, 40960
    buffer_load_dwordx4 a[180:183], v230, s[40:43], s100 offen offset:0
    v_mfma_f32_16x16x32_bf16 v[40:43], v[128:131], v[100:103], v[40:43]
    ds_read2_b64 v[100:103], v217 offset0:64 offset1:65
    s_waitcnt lgkmcnt(4)
    v_mfma_f32_16x16x32_bf16 v[56:59], v[116:119], v[96:99], v[56:59]
    v_mfma_f32_16x16x32_bf16 v[52:55], v[120:123], v[96:99], v[52:55]
    v_mfma_f32_16x16x32_bf16 v[48:51], v[124:127], v[96:99], v[48:51]
    v_mfma_f32_16x16x32_bf16 v[44:47], v[128:131], v[96:99], v[44:47]
    ds_read2_b64 v[96:99], v217 offset0:0 offset1:1
    v_mfma_f32_16x16x32_bf16 v[56:59], v[116:119], v[108:111], v[56:59]
    ds_read2_b64 v[116:119], v215 offset0:192 offset1:193
    v_mfma_f32_16x16x32_bf16 v[52:55], v[120:123], v[108:111], v[52:55]
    ds_write_b128 v221, v[40:43] offset:3456
    v_mfma_f32_16x16x32_bf16 v[48:51], v[124:127], v[108:111], v[48:51]
    buffer_load_dwordx4 a[184:187], v230, s[40:43], s100 offen offset:1024
    v_mfma_f32_16x16x32_bf16 v[44:47], v[128:131], v[108:111], v[44:47]
    ds_read2_b64 v[108:111], v215 offset0:128 offset1:129
    v_mfma_f32_16x16x32_bf16 v[56:59], v[120:123], v[132:135], v[56:59]
    s_add_u32 s74, s74, 4096
    buffer_store_dwordx4 v[232:235], v227, s[40:43], s74 offen sc1
    v_mfma_f32_16x16x32_bf16 v[52:55], v[124:127], v[132:135], v[52:55]
    v_mfma_f32_16x16x32_bf16 v[48:51], v[128:131], v[132:135], v[48:51]
    ds_read2_b64 v[132:135], v215 offset0:64 offset1:65
    v_mfma_f32_16x16x32_bf16 v[56:59], v[120:123], v[136:139], v[56:59]
    ds_read2_b64 v[120:123], v215 offset0:0 offset1:1
    v_mfma_f32_16x16x32_bf16 v[52:55], v[124:127], v[136:139], v[52:55]
    ds_write_b128 v221, v[44:47] offset:4608
    v_mfma_f32_16x16x32_bf16 v[48:51], v[128:131], v[136:139], v[48:51]
    ds_read_b128 v[136:139], v220 offset:56096
    v_mfma_f32_16x16x32_bf16 v[56:59], v[124:127], v[152:155], v[56:59]
    buffer_load_dwordx4 a[188:191], v230, s[40:43], s100 offen offset:2048
    v_mfma_f32_16x16x32_bf16 v[52:55], v[128:131], v[152:155], v[52:55]
    ds_read_b128 v[152:155], v220 offset:51744
    v_mfma_f32_16x16x32_bf16 v[56:59], v[124:127], v[140:143], v[56:59]
    ds_read_b128 v[124:127], v220 offset:56352
    v_mfma_f32_16x16x32_bf16 v[52:55], v[128:131], v[140:143], v[52:55]
    ds_read_b128 v[140:143], v220 offset:52000
    v_mfma_f32_16x16x32_bf16 v[56:59], v[128:131], v[144:147], v[56:59]
    ds_read_b128 v[144:147], v220 offset:56608
    v_mfma_f32_16x16x32_bf16 v[88:91], v[104:107], v[148:151], 0
    ds_write_b128 v221, v[48:51] offset:5760
    s_waitcnt lgkmcnt(7)
    v_mfma_f32_16x16x32_bf16 v[56:59], v[128:131], v[92:95], v[56:59]
    ds_read_b128 v[128:131], v220 offset:52256
    ds_read_b128 v[92:95], v220 offset:56864
    v_mfma_f32_16x16x32_bf16 v[84:87], v[112:115], v[148:151], 0
    buffer_load_dwordx4 a[192:195], v230, s[40:43], s100 offen offset:3072
    v_mfma_f32_16x16x32_bf16 v[80:83], v[100:103], v[148:151], 0
    ds_write_b128 v221, v[52:55] offset:6912
    v_mfma_f32_16x16x32_bf16 v[76:79], v[96:99], v[148:151], 0
    v_mfma_f32_16x16x32_bf16 v[72:75], v[116:119], v[148:151], 0
    v_mfma_f32_16x16x32_bf16 v[68:71], v[108:111], v[148:151], 0
    ds_write_b128 v221, v[56:59] offset:8064
    v_mfma_f32_16x16x32_bf16 v[64:67], v[132:135], v[148:151], 0
    v_mfma_f32_16x16x32_bf16 v[60:63], v[120:123], v[148:151], 0
    ds_read_b128 v[148:151], v220 offset:52512
    s_waitcnt lgkmcnt(5)
    v_mfma_f32_16x16x32_bf16 v[88:91], v[104:107], v[136:139], v[88:91]
    ds_read_b128 v[104:107], v220 offset:57120
    v_mfma_f32_16x16x32_bf16 v[84:87], v[112:115], v[136:139], v[84:87]
    s_add_u32 s74, s74, 4096
    s_cmp_eq_u32 s3, 0
    s_cselect_b64 exec, -1, 0
    buffer_store_dwordx4 v[232:235], v227, s[40:43], s74 offen sc1
    s_mov_b64 exec, -1
    v_mfma_f32_16x16x32_bf16 v[80:83], v[100:103], v[136:139], v[80:83]
    s_waitcnt lgkmcnt(2)
    s_barrier
    v_mfma_f32_16x16x32_bf16 v[76:79], v[96:99], v[136:139], v[76:79]
    ds_read_b128 v[28:31], v222 offset:0
    ds_read_b128 v[32:35], v222 offset:256
    v_mfma_f32_16x16x32_bf16 v[72:75], v[116:119], v[136:139], v[72:75]
    ds_read_b128 v[36:39], v222 offset:9216
    ds_read_b128 v[40:43], v222 offset:9472
    v_mfma_f32_16x16x32_bf16 v[68:71], v[108:111], v[136:139], v[68:71]
    ds_read_b128 v[44:47], v222 offset:18432
    ds_read_b128 v[48:51], v222 offset:18688
    v_mfma_f32_16x16x32_bf16 v[64:67], v[132:135], v[136:139], v[64:67]
    ds_read_b128 v[52:55], v222 offset:27648
    ds_read_b128 v[56:59], v222 offset:27904
    s_cmp_lg_u32 s3, 0
    s_cbranch_scc1 L_fb_skip
    s_waitcnt vmcnt(5)
    v_max3_u32 v236, v236, v237, v238
    v_max_u32 v236, v236, v239
    v_cmp_eq_u32 vcc, -1, v236
    s_cbranch_vccnz L_fb_slow
L_fb_done:
L_fb_skip:
    v_mfma_f32_16x16x32_bf16 v[60:63], v[120:123], v[136:139], v[60:63]
    ds_read_b128 v[136:139], v220 offset:52768
    v_mfma_f32_16x16x32_bf16 v[88:91], v[112:115], v[152:155], v[88:91]
    buffer_load_dwordx4 a[196:199], v231, s[40:43], s100 offen offset:0
    v_mfma_f32_16x16x32_bf16 v[84:87], v[100:103], v[152:155], v[84:87]
    v_mfma_f32_16x16x32_bf16 v[80:83], v[96:99], v[152:155], v[80:83]
    v_mfma_f32_16x16x32_bf16 v[76:79], v[116:119], v[152:155], v[76:79]
    s_waitcnt lgkmcnt(1)
    s_barrier
    v_mfma_f32_16x16x32_bf16 v[72:75], v[108:111], v[152:155], v[72:75]
    v_add_f32 v28, v28, v36
    v_add_f32 v44, v44, v52
    v_mfma_f32_16x16x32_bf16 v[68:71], v[132:135], v[152:155], v[68:71]
    v_add_f32 v29, v29, v37
    v_add_f32 v45, v45, v53
    v_mfma_f32_16x16x32_bf16 v[64:67], v[120:123], v[152:155], v[64:67]
    ds_read_b128 v[152:155], v220 offset:57376
    v_add_f32 v30, v30, v38
    v_mfma_f32_16x16x32_bf16 v[88:91], v[112:115], v[124:127], v[88:91]
    ds_read_b128 v[112:115], v220 offset:53024
    v_add_f32 v46, v46, v54
    v_mfma_f32_16x16x32_bf16 v[84:87], v[100:103], v[124:127], v[84:87]
    s_bfe_u32 s100, s70, 0x80010
    s_mul_i32 s100, s100, 40960
    buffer_load_dwordx4 a[200:203], v230, s[40:43], s100 offen offset:0
    v_mfma_f32_16x16x32_bf16 v[80:83], v[96:99], v[124:127], v[80:83]
    v_add_f32 v31, v31, v39
    v_add_f32 v47, v47, v55
    v_mfma_f32_16x16x32_bf16 v[76:79], v[116:119], v[124:127], v[76:79]
    v_add_f32 v32, v32, v40
    v_add_f32 v48, v48, v56
    v_mfma_f32_16x16x32_bf16 v[72:75], v[108:111], v[124:127], v[72:75]
    v_add_f32 v33, v33, v41
    v_add_f32 v49, v49, v57
    v_mfma_f32_16x16x32_bf16 v[68:71], v[132:135], v[124:127], v[68:71]
    v_add_f32 v34, v34, v42
    v_add_f32 v50, v50, v58
    v_mfma_f32_16x16x32_bf16 v[64:67], v[120:123], v[124:127], v[64:67]
    ds_read_b128 v[124:127], v220 offset:57632
    v_add_f32 v35, v35, v43
    v_mfma_f32_16x16x32_bf16 v[88:91], v[100:103], v[140:143], v[88:91]
    v_add_f32 v51, v51, v59
    v_add_f32 v28, v28, v44
    v_mfma_f32_16x16x32_bf16 v[84:87], v[96:99], v[140:143], v[84:87]
    buffer_load_dwordx4 a[204:207], v230, s[40:43], s100 offen offset:1024
    v_mfma_f32_16x16x32_bf16 v[80:83], v[116:119], v[140:143], v[80:83]
    v_add_f32 v29, v29, v45
    v_add_f32 v30, v30, v46
    v_mfma_f32_16x16x32_bf16 v[76:79], v[108:111], v[140:143], v[76:79]
    v_add_f32 v31, v31, v47
    v_add_f32 v32, v32, v48
    v_mfma_f32_16x16x32_bf16 v[72:75], v[132:135], v[140:143], v[72:75]
    v_add_f32 v33, v33, v49
    v_add_f32 v34, v34, v50
    v_mfma_f32_16x16x32_bf16 v[68:71], v[120:123], v[140:143], v[68:71]
    ds_read_b128 v[140:143], v220 offset:53280
    v_add_f32 v35, v35, v51
    v_mfma_f32_16x16x32_bf16 v[88:91], v[100:103], v[144:147], v[88:91]
    ds_read2_b64 v[100:103], v217 offset0:136 offset1:137
    v_lshlrev_b32 v44, 16, v156
    v_mfma_f32_16x16x32_bf16 v[84:87], v[96:99], v[144:147], v[84:87]
    v_and_b32 v45, 0xffff0000, v156
    v_lshlrev_b32 v46, 16, v157
    v_mfma_f32_16x16x32_bf16 v[80:83], v[116:119], v[144:147], v[80:83]
    buffer_load_dwordx4 a[208:211], v230, s[40:43], s100 offen offset:2048
    v_mfma_f32_16x16x32_bf16 v[76:79], v[108:111], v[144:147], v[76:79]
    v_and_b32 v47, 0xffff0000, v157
    v_lshlrev_b32 v48, 16, v158
    v_mfma_f32_16x16x32_bf16 v[72:75], v[132:135], v[144:147], v[72:75]
    v_and_b32 v49, 0xffff0000, v158
    v_lshlrev_b32 v50, 16, v159
    v_mfma_f32_16x16x32_bf16 v[68:71], v[120:123], v[144:147], v[68:71]
    ds_read_b128 v[144:147], v220 offset:51456
    v_and_b32 v51, 0xffff0000, v159
    v_mfma_f32_16x16x32_bf16 v[88:91], v[96:99], v[128:131], v[88:91]
    v_cvt_pk_bf16_f32 v36, v28, v29
    v_cvt_pk_bf16_f32 v37, v30, v31
    v_mfma_f32_16x16x32_bf16 v[84:87], v[116:119], v[128:131], v[84:87]
    v_cvt_pk_bf16_f32 v38, v32, v33
    v_cvt_pk_bf16_f32 v39, v34, v35
    v_mfma_f32_16x16x32_bf16 v[80:83], v[108:111], v[128:131], v[80:83]
    v_lshlrev_b32 v28, 16, v36
    v_and_b32 v29, 0xffff0000, v36
    v_mfma_f32_16x16x32_bf16 v[76:79], v[132:135], v[128:131], v[76:79]
    buffer_load_dwordx4 a[212:215], v230, s[40:43], s100 offen offset:3072
    v_mfma_f32_16x16x32_bf16 v[72:75], v[120:123], v[128:131], v[72:75]
    ds_read_b128 v[128:131], v220 offset:57888
    v_lshlrev_b32 v30, 16, v37
    v_mfma_f32_16x16x32_bf16 v[88:91], v[96:99], v[92:95], v[88:91]
    ds_read2_b64 v[96:99], v217 offset0:72 offset1:73
    v_and_b32 v31, 0xffff0000, v37
    v_mfma_f32_16x16x32_bf16 v[84:87], v[116:119], v[92:95], v[84:87]
    v_lshlrev_b32 v32, 16, v38
    v_and_b32 v33, 0xffff0000, v38
    v_mfma_f32_16x16x32_bf16 v[80:83], v[108:111], v[92:95], v[80:83]
    v_lshlrev_b32 v34, 16, v39
    v_and_b32 v35, 0xffff0000, v39
    v_mfma_f32_16x16x32_bf16 v[76:79], v[132:135], v[92:95], v[76:79]
    v_add_f32 v28, v28, v44
    v_add_f32 v29, v29, v45
    v_mfma_f32_16x16x32_bf16 v[72:75], v[120:123], v[92:95], v[72:75]
    ds_read2_b64 v[92:95], v217 offset0:200 offset1:201
    v_add_f32 v30, v30, v46
    v_mfma_f32_16x16x32_bf16 v[88:91], v[116:119], v[148:151], v[88:91]
    buffer_load_dwordx4 a[216:219], v231, s[40:43], s100 offen offset:0
    v_mfma_f32_16x16x32_bf16 v[84:87], v[108:111], v[148:151], v[84:87]
    v_add_f32 v31, v31, v47
    v_add_f32 v32, v32, v48
    v_mfma_f32_16x16x32_bf16 v[80:83], v[132:135], v[148:151], v[80:83]
    v_add_f32 v33, v33, v49
    v_add_f32 v34, v34, v50
    v_mfma_f32_16x16x32_bf16 v[76:79], v[120:123], v[148:151], v[76:79]
    ds_read2_b64 v[148:151], v217 offset0:8 offset1:9
    v_add_f32 v35, v35, v51
    v_mfma_f32_16x16x32_bf16 v[88:91], v[116:119], v[104:107], v[88:91]
    ds_read2_b64 v[116:119], v215 offset0:200 offset1:201
    v_cvt_pk_bf16_f32 v36, v28, v29
    v_mfma_f32_16x16x32_bf16 v[84:87], v[108:111], v[104:107], v[84:87]
    v_cvt_pk_bf16_f32 v37, v30, v31
    v_cvt_pk_bf16_f32 v38, v32, v33
    v_mfma_f32_16x16x32_bf16 v[80:83], v[132:135], v[104:107], v[80:83]
    v_cvt_pk_bf16_f32 v39, v34, v35
    v_lshlrev_b32 v28, 16, v36
    v_mfma_f32_16x16x32_bf16 v[76:79], v[120:123], v[104:107], v[76:79]
    ds_read2_b64 v[104:107], v215 offset0:136 offset1:137
    v_and_b32 v29, 0xffff0000, v36
    s_waitcnt lgkmcnt(4)
    v_mfma_f32_16x16x32_bf16 v[88:91], v[108:111], v[136:139], v[88:91]
    s_bfe_u32 s100, s70, 0x80018
    s_mul_i32 s100, s100, 40960
    buffer_load_dwordx4 a[220:223], v230, s[40:43], s100 offen offset:0
    v_mfma_f32_16x16x32_bf16 v[84:87], v[132:135], v[136:139], v[84:87]
    v_lshlrev_b32 v30, 16, v37
    v_and_b32 v31, 0xffff0000, v37
    v_mfma_f32_16x16x32_bf16 v[80:83], v[120:123], v[136:139], v[80:83]
    ds_read2_b64 v[136:139], v215 offset0:72 offset1:73
    v_lshlrev_b32 v32, 16, v38
    v_mfma_f32_16x16x32_bf16 v[88:91], v[108:111], v[152:155], v[88:91]
    ds_read2_b64 v[108:111], v215 offset0:8 offset1:9
    v_and_b32 v33, 0xffff0000, v38
    v_mfma_f32_16x16x32_bf16 v[84:87], v[132:135], v[152:155], v[84:87]
    v_lshlrev_b32 v34, 16, v39
    v_and_b32 v35, 0xffff0000, v39
    v_mfma_f32_16x16x32_bf16 v[80:83], v[120:123], v[152:155], v[80:83]
    ds_read_b128 v[152:155], v220 offset:56064
    v_mul_f32 v28, s87, v28
    v_mfma_f32_16x16x32_bf16 v[88:91], v[132:135], v[112:115], v[88:91]
    v_mul_f32 v29, s87, v29
    v_mul_f32 v30, s87, v30
    v_mfma_f32_16x16x32_bf16 v[84:87], v[120:123], v[112:115], v[84:87]
    ds_read_b128 v[112:115], v220 offset:51712
    v_mul_f32 v31, s87, v31
    v_mfma_f32_16x16x32_bf16 v[88:91], v[132:135], v[124:127], v[88:91]
    ds_read_b128 v[132:135], v220 offset:56320
    v_mul_f32 v32, s87, v32
    v_mfma_f32_16x16x32_bf16 v[84:87], v[120:123], v[124:127], v[84:87]
    ds_read_b128 v[124:127], v220 offset:51968
    v_mul_f32 v33, s87, v33
    v_mfma_f32_16x16x32_bf16 v[88:91], v[120:123], v[140:143], v[88:91]
    ds_read_b128 v[140:143], v220 offset:56576
    v_mul_f32 v34, s87, v34
    v_mfma_f32_16x16x32_bf16 v[84:87], v[100:103], v[144:147], v[84:87]
    buffer_store_dwordx2 v[16:17], v224, s[40:43], s8 offen sc1
    v_mfma_f32_16x16x32_bf16 v[88:91], v[120:123], v[128:131], v[88:91]
    ds_read_b128 v[120:123], v220 offset:52224
    ds_read_b128 v[128:131], v220 offset:56832
    v_mfma_f32_16x16x32_bf16 v[80:83], v[96:99], v[144:147], v[80:83]
    v_mul_f32 v35, s87, v35
    v_cvt_pk_bf16_f32 v36, v28, v29
    s_waitcnt lgkmcnt(7)
    v_mfma_f32_16x16x32_bf16 v[88:91], v[92:95], v[144:147], v[88:91]
    v_cvt_pk_bf16_f32 v37, v30, v31
    v_cvt_pk_bf16_f32 v38, v32, v33
    v_mfma_f32_16x16x32_bf16 v[76:79], v[148:151], v[144:147], v[76:79]
    v_cvt_pk_bf16_f32 v39, v34, v35
    v_mfma_f32_16x16x32_bf16 v[72:75], v[116:119], v[144:147], v[72:75]
    buffer_store_dwordx4 v[36:39], v216, s[40:43], s9 offen sc1
    v_mfma_f32_16x16x32_bf16 v[68:71], v[104:107], v[144:147], v[68:71]
    s_lshr_b32 s52, s88, 16
    v_lshlrev_b32 v12, 16, v160
    v_mfma_f32_16x16x32_bf16 v[64:67], v[136:139], v[144:147], v[64:67]
    v_and_b32 v13, 0xffff0000, v160
    v_lshlrev_b32 v14, 16, v161
    v_mfma_f32_16x16x32_bf16 v[60:63], v[108:111], v[144:147], v[60:63]
    ds_read_b128 v[144:147], v220 offset:52480
    v_and_b32 v15, 0xffff0000, v161
    s_waitcnt lgkmcnt(3)
    v_mfma_f32_16x16x32_bf16 v[88:91], v[92:95], v[152:155], v[88:91]
    ds_read_b128 v[92:95], v220 offset:57088
    v_lshlrev_b32 v16, 16, v162
    v_mfma_f32_16x16x32_bf16 v[84:87], v[100:103], v[152:155], v[84:87]
    v_and_b32 v17, 0xffff0000, v162
    v_lshlrev_b32 v18, 16, v163
    v_mfma_f32_16x16x32_bf16 v[80:83], v[96:99], v[152:155], v[80:83]
    buffer_load_dwordx4 v[174:177], v200, s[40:43], s25 offen
    v_mfma_f32_16x16x32_bf16 v[76:79], v[148:151], v[152:155], v[76:79]
    v_and_b32 v19, 0xffff0000, v163
    v_mfma_f32_16x16x32_bf16 v[72:75], v[116:119], v[152:155], v[72:75]
    v_mfma_f32_16x16x32_bf16 v[68:71], v[104:107], v[152:155], v[68:71]
    v_mfma_f32_16x16x32_bf16 v[64:67], v[136:139], v[152:155], v[64:67]
    v_mfma_f32_16x16x32_bf16 v[60:63], v[108:111], v[152:155], v[60:63]
    ds_read_b128 v[152:155], v220 offset:52736
    v_mfma_f32_16x16x32_bf16 v[88:91], v[100:103], v[112:115], v[88:91]
    v_mfma_f32_16x16x32_bf16 v[84:87], v[96:99], v[112:115], v[84:87]
    buffer_load_dwordx4 v[178:181], v200, s[40:43], s25 offen offset:16
    v_mfma_f32_16x16x32_bf16 v[80:83], v[148:151], v[112:115], v[80:83]
    v_mfma_f32_16x16x32_bf16 v[76:79], v[116:119], v[112:115], v[76:79]
    v_mfma_f32_16x16x32_bf16 v[72:75], v[104:107], v[112:115], v[72:75]
    s_nop 0
    ds_write_b128 v221, v[60:63] offset:0
    v_mfma_f32_16x16x32_bf16 v[68:71], v[136:139], v[112:115], v[68:71]
    v_mfma_f32_16x16x32_bf16 v[64:67], v[108:111], v[112:115], v[64:67]
    ds_read_b128 v[112:115], v220 offset:57344
    v_mfma_f32_16x16x32_bf16 v[88:91], v[100:103], v[132:135], v[88:91]
    ds_read_b128 v[100:103], v220 offset:52992
    v_mfma_f32_16x16x32_bf16 v[84:87], v[96:99], v[132:135], v[84:87]
    buffer_load_dwordx2 v[182:183], v201, s[40:43], s25 offen
    v_mfma_f32_16x16x32_bf16 v[80:83], v[148:151], v[132:135], v[80:83]
    v_mfma_f32_16x16x32_bf16 v[76:79], v[116:119], v[132:135], v[76:79]
    v_mfma_f32_16x16x32_bf16 v[72:75], v[104:107], v[132:135], v[72:75]
    v_mfma_f32_16x16x32_bf16 v[68:71], v[136:139], v[132:135], v[68:71]
    buffer_load_dwordx4 v[184:187], v200, s[40:43], s25 offen offset:2560
    v_mfma_f32_16x16x32_bf16 v[64:67], v[108:111], v[132:135], v[64:67]
    ds_read_b128 v[132:135], v220 offset:57600
    v_mfma_f32_16x16x32_bf16 v[88:91], v[96:99], v[124:127], v[88:91]
    v_mfma_f32_16x16x32_bf16 v[84:87], v[148:151], v[124:127], v[84:87]
    v_mfma_f32_16x16x32_bf16 v[80:83], v[116:119], v[124:127], v[80:83]
    v_mfma_f32_16x16x32_bf16 v[76:79], v[104:107], v[124:127], v[76:79]
    v_mfma_f32_16x16x32_bf16 v[72:75], v[136:139], v[124:127], v[72:75]
    s_nop 1
    ds_write_b128 v221, v[64:67] offset:1152
    v_mfma_f32_16x16x32_bf16 v[68:71], v[108:111], v[124:127], v[68:71]
    ds_read_b128 v[124:127], v220 offset:53248
    v_mfma_f32_16x16x32_bf16 v[88:91], v[96:99], v[140:143], v[88:91]
    ds_read_b128 v[96:99], v220 offset:57856
    v_mfma_f32_16x16x32_bf16 v[84:87], v[148:151], v[140:143], v[84:87]
    buffer_load_dwordx4 v[188:191], v200, s[40:43], s25 offen offset:2576
    v_mfma_f32_16x16x32_bf16 v[80:83], v[116:119], v[140:143], v[80:83]
    v_mfma_f32_16x16x32_bf16 v[76:79], v[104:107], v[140:143], v[76:79]
    v_mfma_f32_16x16x32_bf16 v[72:75], v[136:139], v[140:143], v[72:75]
    v_mfma_f32_16x16x32_bf16 v[68:71], v[108:111], v[140:143], v[68:71]
    s_waitcnt lgkmcnt(3)
    v_mfma_f32_16x16x32_bf16 v[88:91], v[148:151], v[120:123], v[88:91]
    v_mfma_f32_16x16x32_bf16 v[84:87], v[116:119], v[120:123], v[84:87]
    v_mfma_f32_16x16x32_bf16 v[80:83], v[104:107], v[120:123], v[80:83]
    buffer_load_dwordx2 v[192:193], v201, s[40:43], s25 offen offset:2560
    v_mfma_f32_16x16x32_bf16 v[76:79], v[136:139], v[120:123], v[76:79]
    v_mfma_f32_16x16x32_bf16 v[72:75], v[108:111], v[120:123], v[72:75]
    s_nop 0
    ds_write_b128 v221, v[68:71] offset:2304
    v_mfma_f32_16x16x32_bf16 v[88:91], v[148:151], v[128:131], v[88:91]
    s_add_u32 m0, s19, 36864
    s_add_u32 s30, s22, 0
    buffer_load_dwordx4 v1, s[44:47], s30 offen offset:0 lds
    v_mfma_f32_16x16x32_bf16 v[84:87], v[116:119], v[128:131], v[84:87]
    v_mfma_f32_16x16x32_bf16 v[80:83], v[104:107], v[128:131], v[80:83]
    v_mfma_f32_16x16x32_bf16 v[76:79], v[136:139], v[128:131], v[76:79]
    v_mfma_f32_16x16x32_bf16 v[72:75], v[108:111], v[128:131], v[72:75]
    v_mfma_f32_16x16x32_bf16 v[88:91], v[116:119], v[144:147], v[88:91]
    v_mfma_f32_16x16x32_bf16 v[84:87], v[104:107], v[144:147], v[84:87]
    v_mfma_f32_16x16x32_bf16 v[80:83], v[136:139], v[144:147], v[80:83]
    buffer_load_dwordx4 v1, s[44:47], s30 offen offset:1024 lds
    v_mfma_f32_16x16x32_bf16 v[76:79], v[108:111], v[144:147], v[76:79]
    v_mfma_f32_16x16x32_bf16 v[88:91], v[116:119], v[92:95], v[88:91]
    s_nop 1
    ds_write_b128 v221, v[72:75] offset:3456
    v_mfma_f32_16x16x32_bf16 v[84:87], v[104:107], v[92:95], v[84:87]
    v_mfma_f32_16x16x32_bf16 v[80:83], v[136:139], v[92:95], v[80:83]
    v_mfma_f32_16x16x32_bf16 v[76:79], v[108:111], v[92:95], v[76:79]
    v_mfma_f32_16x16x32_bf16 v[88:91], v[104:107], v[152:155], v[88:91]
    buffer_load_dwordx4 v1, s[44:47], s30 offen offset:2048 lds
    v_mfma_f32_16x16x32_bf16 v[84:87], v[136:139], v[152:155], v[84:87]
    v_mfma_f32_16x16x32_bf16 v[80:83], v[108:111], v[152:155], v[80:83]
    v_mfma_f32_16x16x32_bf16 v[88:91], v[104:107], v[112:115], v[88:91]
    v_mfma_f32_16x16x32_bf16 v[84:87], v[136:139], v[112:115], v[84:87]
    s_nop 1
    ds_write_b128 v221, v[76:79] offset:4608
    v_mfma_f32_16x16x32_bf16 v[80:83], v[108:111], v[112:115], v[80:83]
    v_mfma_f32_16x16x32_bf16 v[88:91], v[136:139], v[100:103], v[88:91]
    buffer_load_dwordx4 v1, s[44:47], s30 offen offset:3072 lds
    v_mfma_f32_16x16x32_bf16 v[84:87], v[108:111], v[100:103], v[84:87]
    s_nop 4
    ds_write_b128 v221, v[80:83] offset:5760
    v_mfma_f32_16x16x32_bf16 v[88:91], v[136:139], v[132:135], v[88:91]
    v_mfma_f32_16x16x32_bf16 v[84:87], v[108:111], v[132:135], v[84:87]
    s_waitcnt lgkmcnt(2)
    v_mfma_f32_16x16x32_bf16 v[88:91], v[108:111], v[124:127], v[88:91]
    v_mfma_f32_16x16x32_bf16 v[88:91], v[108:111], v[96:99], v[88:91]
    s_add_u32 m0, s19, 53248
    s_add_u32 s30, s22, 442368
    buffer_load_dwordx4 v1, s[44:47], s30 offen offset:0 lds
    s_nop 1
    ds_write_b128 v221, v[84:87] offset:6912
    s_nop 1
    ds_write_b128 v221, v[88:91] offset:8064
    s_mov_b32 s28, 0xfffffffe
    s_mov_b32 s15, 0
    s_waitcnt vmcnt(20)
    s_waitcnt lgkmcnt(0)
    s_barrier
    ds_read_b128 v[60:63], v222 offset:0
    ds_read_b128 v[64:67], v222 offset:256
    ds_read_b128 v[68:71], v222 offset:9216
    ds_read_b128 v[72:75], v222 offset:9472
    ds_read_b128 v[76:79], v222 offset:18432
    ds_read_b128 v[80:83], v222 offset:18688
    ds_read_b128 v[84:87], v222 offset:27648
    ds_read_b128 v[88:91], v222 offset:27904
    s_waitcnt lgkmcnt(4)
    v_pk_add_f32 v[60:61], v[60:61], v[68:69]
    v_pk_add_f32 v[62:63], v[62:63], v[70:71]
    v_pk_add_f32 v[64:65], v[64:65], v[72:73]
    v_pk_add_f32 v[66:67], v[66:67], v[74:75]
    s_waitcnt lgkmcnt(0)
    v_pk_add_f32 v[76:77], v[76:77], v[84:85]
    v_pk_add_f32 v[78:79], v[78:79], v[86:87]
    v_pk_add_f32 v[80:81], v[80:81], v[88:89]
    v_pk_add_f32 v[82:83], v[82:83], v[90:91]
    v_pk_add_f32 v[60:61], v[60:61], v[76:77]
    v_pk_add_f32 v[62:63], v[62:63], v[78:79]
    v_pk_add_f32 v[64:65], v[64:65], v[80:81]
    v_pk_add_f32 v[66:67], v[66:67], v[82:83]
    v_cvt_pk_bf16_f32 v68, v60, v61
    v_cvt_pk_bf16_f32 v69, v62, v63
    v_cvt_pk_bf16_f32 v70, v64, v65
    v_cvt_pk_bf16_f32 v71, v66, v67
    v_dot2_f32_bf16 v60, v68, v8, v12
    v_dot2_f32_bf16 v61, v68, v9, v13
    v_dot2_f32_bf16 v62, v69, v8, v14
    v_dot2_f32_bf16 v63, v69, v9, v15
    v_dot2_f32_bf16 v64, v70, v8, v16
    v_dot2_f32_bf16 v65, v70, v9, v17
    v_dot2_f32_bf16 v66, v71, v8, v18
    v_dot2_f32_bf16 v67, v71, v9, v19
    v_cvt_pk_bf16_f32 v68, v60, v61
    v_cvt_pk_bf16_f32 v69, v62, v63
    v_cvt_pk_bf16_f32 v70, v64, v65
    v_cvt_pk_bf16_f32 v71, v66, v67
    v_dot2_f32_bf16 v60, v68, s52, 0
    v_dot2_f32_bf16 v61, v68, s88, 0
    v_dot2_f32_bf16 v62, v69, s52, 0
    v_dot2_f32_bf16 v63, v69, s88, 0
    v_dot2_f32_bf16 v64, v70, s52, 0
    v_dot2_f32_bf16 v65, v70, s88, 0
    v_dot2_f32_bf16 v66, v71, s52, 0
    v_dot2_f32_bf16 v67, v71, s88, 0
    v_cvt_pk_bf16_f32 v68, v60, v61
    v_cvt_pk_bf16_f32 v69, v62, v63
    v_cvt_pk_bf16_f32 v70, v64, v65
    v_cvt_pk_bf16_f32 v71, v66, v67
    buffer_store_dwordx4 v[68:71], v226, s[40:43], s10 offen sc1
    s_barrier
L_rp0:
    buffer_load_dwordx4 v1, s[44:47], s30 offen offset:1024 lds
    v_lshrrev_b32 v104, 2, v198
    v_lshlrev_b32 v104, 13, v104
    v_and_b32 v14, 3, v198
    v_lshl_add_u32 v104, v14, 8, v104
    v_lshl_add_u32 v104, v199, 4, v104
    v_lshrrev_b32 v105, 6, v0
    v_lshlrev_b32 v105, 13, v105
    v_bfe_u32 v15, v0, 4, 2
    v_lshl_add_u32 v105, v15, 8, v105
    v_lshl_add_u32 v105, v199, 4, v105
    v_lshl_add_u32 v105, v14, 2, v105
    v_add_u32 v105, 0x20000, v105
    buffer_load_dwordx4 v1, s[44:47], s30 offen offset:2048 lds
    s_lshr_b32 s6, s60, 4
    s_mul_i32 s6, s6, 163840
    s_bfe_u32 s7, s60, 0x30001
    s_lshl_b32 s7, s7, 10
    s_add_u32 s6, s6, s7
    s_and_b32 s7, s60, 1
    s_lshl_b32 s7, s7, 7
    s_add_u32 s6, s6, s7
    s_add_u32 s6, s6, 13631488
    s_mov_b32 s13, 0x3f803f80
    buffer_load_dwordx4 v1, s[44:47], s30 offen offset:3072 lds
    s_lshl_b32 s7, s3, 6
    v_lshlrev_b32 v108, 4, v199
    v_add_u32 v108, 162816, v108
    v_add_u32 v109, s7, v108
    s_lshr_b32 s26, s2, 5
    s_and_b32 s27, s2, 7
    s_lshl_b32 s27, s27, 2
    s_bfe_u32 s7, s2, 0x20003
    s_add_u32 s27, s27, s7
    s_add_u32 s7, s3, 0
    s_and_b32 s7, s7, 3
    s_lshl_b32 s7, s7, 10
    s_add_u32 m0, s19, 69632
    s_add_u32 s30, s22, 884736
    buffer_load_dwordx4 v1, s[44:47], s30 offen offset:0 lds
    v_add_u32 v4, s7, v1
    s_add_u32 s7, s3, 1
    s_and_b32 s7, s7, 3
    s_lshl_b32 s7, s7, 10
    v_add_u32 v5, s7, v1
    s_add_u32 s7, s3, 2
    s_and_b32 s7, s7, 3
    s_lshl_b32 s7, s7, 10
    v_add_u32 v6, s7, v1
    s_add_u32 s7, s3, 3
    buffer_load_dwordx4 v1, s[44:47], s30 offen offset:1024 lds
    s_and_b32 s7, s7, 3
    s_lshl_b32 s7, s7, 10
    v_add_u32 v7, s7, v1
    s_mul_i32 s9, s27, 221184
    s_add_u32 s9, s9, 16252928
    v_and_b32 v12, 3, v2
    v_lshl_add_u32 v13, v12, 2, 3
    v_add_u32 v12, 16, v12
    v_and_b32 v14, 16, v2
    v_cmp_eq_u32 vcc, 0, v14
    s_nop 1
    v_cndmask_b32 v12, v13, v12, vcc
    buffer_load_dwordx4 v1, s[44:47], s30 offen offset:2048 lds
    v_lshlrev_b32 v12, 13, v12
    v_bfe_u32 v13, v2, 2, 1
    v_lshl_add_u32 v12, v13, 7, v12
    v_bfe_u32 v13, v2, 3, 1
    v_lshl_add_u32 v225, v13, 10, v12
    v_add_u32 v10, 0x10000, v1
    v_add_u32 v11, 0x20000, v1
    s_mul_i32 s23, s21, 163840
    s_lshl_b32 s7, s3, 11
    s_add_u32 s23, s23, s7
    buffer_load_dwordx4 v1, s[44:47], s30 offen offset:3072 lds
    s_add_u32 s23, s23, 13631488
    s_lshl_b32 s7, s21, 1
    s_lshr_b32 s12, s3, 1
    s_add_u32 s7, s7, s12
    s_mul_i32 s7, s7, 54
    s_lshl_b32 s12, s20, 2
    s_add_u32 s7, s7, s12
    s_lshl_b32 s62, s7, 12
    s_and_b32 s12, s3, 1
    s_lshl_b32 s12, s12, 11
    s_add_u32 s62, s62, s12
    s_add_u32 s62, s62, 16252928
    s_add_u32 m0, s19, 86016
    s_add_u32 s30, s22, 1327104
    buffer_load_dwordx4 v1, s[44:47], s30 offen offset:0 lds
    s_cmp_eq_u32 s20, 13
    s_cselect_b32 s7, 0x70000000, 0
    v_add_u32 v3, s7, v1
    buffer_load_dwordx4 v1, s[44:47], s30 offen offset:1024 lds
    buffer_load_dwordx4 v1, s[44:47], s30 offen offset:2048 lds
    buffer_load_dwordx4 v1, s[44:47], s30 offen offset:3072 lds
    s_add_u32 m0, s19, 102400
    s_add_u32 s30, s22, 1769472
    buffer_load_dwordx4 v1, s[44:47], s30 offen offset:0 lds
    buffer_load_dwordx4 v1, s[44:47], s30 offen offset:1024 lds
    buffer_load_dwordx4 v1, s[44:47], s30 offen offset:2048 lds
    buffer_load_dwordx4 v1, s[44:47], s30 offen offset:3072 lds
    s_add_u32 m0, s19, 118784
    s_add_u32 s30, s22, 4096
    buffer_load_dwordx4 v1, s[44:47], s30 offen offset:0 lds
    buffer_load_dwordx4 v[100:103], v196, s[40:43], s75 offen sc1
    buffer_load_dwordx4 v[92:95], v241, s[40:43], s61 offen sc1
    buffer_load_dwordx4 v[96:99], v240, s[40:43], s77 offen sc1
    buffer_load_dwordx4 v1, s[44:47], s30 offen offset:1024 lds
    buffer_load_dwordx4 v1, s[44:47], s30 offen offset:2048 lds
    buffer_load_dwordx4 v1, s[44:47], s30 offen offset:3072 lds
    s_add_u32 m0, s19, 135168
    s_add_u32 s30, s22, 446464
    buffer_load_dwordx4 v1, s[44:47], s30 offen offset:0 lds
    buffer_load_dwordx4 v1, s[44:47], s30 offen offset:1024 lds
    buffer_load_dwordx4 v1, s[44:47], s30 offen offset:2048 lds
    buffer_load_dwordx4 v1, s[44:47], s30 offen offset:3072 lds
    s_waitcnt vmcnt(32)
    v_lshrrev_b32 v88, 1, v198
    v_lshlrev_b32 v194, 5, v199
    v_and_b32 v89, 1, v198
    v_lshl_add_u32 v195, v89, 4, v194
    v_lshrrev_b32 v90, 3, v198
    v_and_b32 v89, 7, v198
    v_lshl_add_u32 v194, v89, 2, v194
    s_lshr_b32 s25, s60, 1
    s_mul_i32 s25, s25, 20480
    s_and_b32 s5, s60, 1
    s_lshl_b32 s5, s5, 8
    s_add_u32 s25, s25, s5
    v_lshl_add_u32 v90, v90, 9, v194
    v_lshl_add_u32 v194, v88, 9, v195
    v_add_u32 v195, 16384, v90
    s_add_u32 s25, s25, 29360128
    s_mov_b32 s29, 2
    s_waitcnt vmcnt(7)
    v_max3_u32 v60, v92, v93, v94
    v_max3_u32 v61, v95, v96, v97
    v_max3_u32 v62, v98, v99, v100
    v_max3_u32 v63, v101, v102, v103
    v_max3_u32 v60, v60, v61, v62
    v_max_u32 v60, v60, v63
    v_cmp_lt_u32 vcc, s28, v60
    s_cbranch_vccnz L_rt_slow2
L_rt_ok:
    ds_write_b128 v197, v[92:95]
    ds_write_b128 v197, v[96:99] offset:16
    ds_write_b128 v202, v[100:103] offset:2304
    ds_read2_b32 v[110:111], v203 offset0:0 offset1:4
    ds_read2_b32 v[112:113], v203 offset0:8 offset1:12
    ds_read2_b32 v[114:115], v203 offset0:16 offset1:20
    ds_read2_b32 v[116:117], v203 offset0:24 offset1:28
    ds_read2_b32 v[118:119], v212 offset0:0 offset1:4
    s_waitcnt lgkmcnt(4)
    v_lshlrev_b32 v60, 16, v110
    v_and_b32 v61, 0xffff0000, v110
    v_lshlrev_b32 v62, 16, v111
    v_and_b32 v63, 0xffff0000, v111
    s_waitcnt lgkmcnt(3)
    v_lshlrev_b32 v64, 16, v112
    v_and_b32 v65, 0xffff0000, v112
    v_lshlrev_b32 v66, 16, v113
    v_and_b32 v67, 0xffff0000, v113
    s_waitcnt lgkmcnt(2)
    v_lshlrev_b32 v68, 16, v114
    v_and_b32 v69, 0xffff0000, v114
    v_lshlrev_b32 v70, 16, v115
    v_and_b32 v71, 0xffff0000, v115
    s_waitcnt lgkmcnt(1)
    v_lshlrev_b32 v72, 16, v116
    v_and_b32 v73, 0xffff0000, v116
    v_lshlrev_b32 v74, 16, v117
    v_and_b32 v75, 0xffff0000, v117
    s_waitcnt lgkmcnt(0)
    v_lshlrev_b32 v76, 16, v118
    v_and_b32 v77, 0xffff0000, v118
    v_lshlrev_b32 v78, 16, v119
    v_and_b32 v79, 0xffff0000, v119
    v_dot2_f32_bf16 v60, v164, v8, v60
    v_dot2_f32_bf16 v61, v168, v8, v61
    v_dot2_f32_bf16 v62, v164, v9, v62
    v_dot2_f32_bf16 v63, v168, v9, v63
    v_dot2_f32_bf16 v64, v165, v8, v64
    v_dot2_f32_bf16 v65, v169, v8, v65
    v_dot2_f32_bf16 v66, v165, v9, v66
    v_dot2_f32_bf16 v67, v169, v9, v67
    v_dot2_f32_bf16 v68, v166, v8, v68
    v_dot2_f32_bf16 v69, v170, v8, v69
    v_dot2_f32_bf16 v70, v166, v9, v70
    v_dot2_f32_bf16 v71, v170, v9, v71
    v_dot2_f32_bf16 v72, v167, v8, v72
    v_dot2_f32_bf16 v73, v171, v8, v73
    v_dot2_f32_bf16 v74, v167, v9, v74
    v_dot2_f32_bf16 v75, v171, v9, v75
    v_dot2_f32_bf16 v76, v172, v8, v76
    v_dot2_f32_bf16 v77, v173, v8, v77
    v_dot2_f32_bf16 v78, v172, v9, v78
    v_dot2_f32_bf16 v79, v173, v9, v79
    v_cvt_pk_bf16_f32 v164, v60, v62
    v_cvt_pk_bf16_f32 v168, v61, v63
    v_cvt_pk_bf16_f32 v165, v64, v66
    v_cvt_pk_bf16_f32 v169, v65, v67
    v_cvt_pk_bf16_f32 v166, v68, v70
    v_cvt_pk_bf16_f32 v170, v69, v71
    v_cvt_pk_bf16_f32 v167, v72, v74
    v_cvt_pk_bf16_f32 v171, v73, v75
    v_cvt_pk_bf16_f32 v172, v76, v78
    v_cvt_pk_bf16_f32 v173, v77, v79
    v_dot2_f32_bf16 v80, v164, s13, 0
    v_dot2_f32_bf16 v82, v164, v164, 0
    v_dot2_f32_bf16 v81, v168, s13, 0
    v_dot2_f32_bf16 v83, v168, v168, 0
    v_dot2_f32_bf16 v80, v165, s13, v80
    v_dot2_f32_bf16 v82, v165, v165, v82
    v_dot2_f32_bf16 v81, v169, s13, v81
    v_dot2_f32_bf16 v83, v169, v169, v83
    v_dot2_f32_bf16 v80, v166, s13, v80
    v_dot2_f32_bf16 v82, v166, v166, v82
    v_dot2_f32_bf16 v81, v170, s13, v81
    v_dot2_f32_bf16 v83, v170, v170, v83
    v_dot2_f32_bf16 v80, v167, s13, v80
    v_dot2_f32_bf16 v82, v167, v167, v82
    v_dot2_f32_bf16 v81, v171, s13, v81
    v_dot2_f32_bf16 v83, v171, v171, v83
    v_dot2_f32_bf16 v80, v172, s13, v80
    v_dot2_f32_bf16 v82, v172, v172, v82
    v_dot2_f32_bf16 v81, v173, s13, v81
    v_dot2_f32_bf16 v83, v173, v173, v83
    v_add_f32_dpp v80, v80, v80 row_ror:4 row_mask:0xf bank_mask:0xf
    s_nop 0
    v_add_f32_dpp v81, v81, v81 row_ror:4 row_mask:0xf bank_mask:0xf
    v_add_f32_dpp v82, v82, v82 row_ror:4 row_mask:0xf bank_mask:0xf
    v_add_f32_dpp v83, v83, v83 row_ror:4 row_mask:0xf bank_mask:0xf
    v_add_f32_dpp v80, v80, v80 row_ror:8 row_mask:0xf bank_mask:0xf
    v_add_f32_dpp v81, v81, v81 row_ror:8 row_mask:0xf bank_mask:0xf
    v_add_f32_dpp v82, v82, v82 row_ror:8 row_mask:0xf bank_mask:0xf
    v_add_f32_dpp v83, v83, v83 row_ror:8 row_mask:0xf bank_mask:0xf
    v_mov_b32 v84, v80
    v_mov_b32 v85, v81
    v_mov_b32 v86, v82
    v_mov_b32 v87, v83
    v_permlane16_swap_b32 v80, v84
    v_permlane16_swap_b32 v81, v85
    v_permlane16_swap_b32 v82, v86
    v_permlane16_swap_b32 v83, v87
    v_add_f32 v80, v80, v84
    v_add_f32 v81, v81, v85
    v_add_f32 v82, v82, v86
    v_add_f32 v83, v83, v87
    v_mov_b32 v84, v80
    v_mov_b32 v85, v81
    v_mov_b32 v86, v82
    v_mov_b32 v87, v83
    v_permlane32_swap_b32 v80, v84
    v_permlane32_swap_b32 v81, v85
    v_permlane32_swap_b32 v82, v86
    v_permlane32_swap_b32 v83, v87
    v_add_f32 v80, v80, v84
    v_add_f32 v81, v81, v85
    v_add_f32 v82, v82, v86
    v_add_f32 v83, v83, v87
    s_mov_b64 exec, 15
    ds_write_b128 v109, v[80:83]
    s_mov_b64 exec, -1
    s_waitcnt lgkmcnt(0)
    s_barrier
    ds_read_b128 v[60:63], v108 offset:0
    ds_read_b128 v[64:67], v108 offset:64
    ds_read_b128 v[68:71], v108 offset:128
    ds_read_b128 v[72:75], v108 offset:192
    s_cmp_lt_u32 s2, 224
    s_cbranch_scc1 L_x1e
    buffer_store_dwordx4 v[164:167], v194, s[40:43], s25 offen sc1
    buffer_store_dwordx4 v[168:171], v194, s[40:43], s25 offen offset:128 sc1
    buffer_store_dword v172, v195, s[40:43], s25 offen sc1
    buffer_store_dword v173, v195, s[40:43], s25 offen offset:128 sc1
L_x1e:
    s_waitcnt lgkmcnt(0)
    s_barrier
    v_pk_add_f32 v[80:81], v[60:61], v[64:65]
    v_pk_add_f32 v[68:69], v[68:69], v[72:73]
    v_pk_add_f32 v[82:83], v[62:63], v[66:67]
    v_pk_add_f32 v[70:71], v[70:71], v[74:75]
    v_pk_add_f32 v[80:81], v[80:81], v[68:69]
    v_pk_add_f32 v[82:83], v[82:83], v[70:71]
    v_mul_f32 v80, 0x3acccccd, v80
    v_mul_f32 v81, 0x3acccccd, v81
    v_mul_f32 v82, 0x3acccccd, v82
    v_mul_f32 v83, 0x3acccccd, v83
    v_fma_f32 v82, -v80, v80, v82
    v_fma_f32 v83, -v81, v81, v83
    v_max_f32 v82, 0, v82
    v_max_f32 v83, 0, v83
    v_cvt_pk_bf16_f32 v82, v82, v82
    v_cvt_pk_bf16_f32 v83, v83, v83
    v_and_b32 v82, 0xffff0000, v82
    v_and_b32 v83, 0xffff0000, v83
    v_add_f32 v82, 0x3727c5ac, v82
    v_add_f32 v83, 0x3727c5ac, v83
    v_cvt_pk_bf16_f32 v82, v82, v82
    v_cvt_pk_bf16_f32 v83, v83, v83
    v_and_b32 v82, 0xffff0000, v82
    v_and_b32 v83, 0xffff0000, v83
    v_sqrt_f32 v84, v82
    v_sqrt_f32 v85, v83
    v_rcp_f32 v86, v84
    v_rcp_f32 v88, v85
    v_fma_f32 v87, -v84, v84, v82
    v_fma_f32 v89, -v85, v85, v83
    v_mul_f32 v86, 0.5, v86
    v_mul_f32 v88, 0.5, v88
    v_fmac_f32 v84, v87, v86
    v_fmac_f32 v85, v89, v88
    v_cvt_pk_bf16_f32 v84, v84, v84
    v_cvt_pk_bf16_f32 v85, v85, v85
    v_and_b32 v84, 0xffff0000, v84
    v_and_b32 v85, 0xffff0000, v85
    v_rcp_f32 v86, v84
    v_rcp_f32 v88, v85
    v_cvt_pk_bf16_f32 v80, v80, v80
    v_cvt_pk_bf16_f32 v81, v81, v81
    v_fma_f32 v87, -v84, v86, 1.0
    v_fma_f32 v89, -v85, v88, 1.0
    v_and_b32 v80, 0xffff0000, v80
    v_and_b32 v81, 0xffff0000, v81
    v_fmac_f32 v86, v87, v86
    v_fmac_f32 v88, v89, v88
    v_xor_b32 v80, 0x80000000, v80
    v_xor_b32 v81, 0x80000000, v81
    v_dot2_f32_bf16 v60, v164, v8, v80
    v_dot2_f32_bf16 v61, v164, v9, v80
    v_dot2_f32_bf16 v64, v165, v8, v80
    v_dot2_f32_bf16 v65, v165, v9, v80
    v_dot2_f32_bf16 v68, v166, v8, v80
    v_dot2_f32_bf16 v69, v166, v9, v80
    v_dot2_f32_bf16 v72, v167, v8, v80
    v_dot2_f32_bf16 v73, v167, v9, v80
    v_dot2_f32_bf16 v76, v172, v8, v80
    v_dot2_f32_bf16 v77, v172, v9, v80
    v_cvt_pk_bf16_f32 v62, v60, v61
    v_cvt_pk_bf16_f32 v66, v64, v65
    v_cvt_pk_bf16_f32 v70, v68, v69
    v_cvt_pk_bf16_f32 v74, v72, v73
    v_cvt_pk_bf16_f32 v78, v76, v77
    v_lshlrev_b32 v60, 16, v62
    v_and_b32 v61, 0xffff0000, v62
    v_lshlrev_b32 v64, 16, v66
    v_and_b32 v65, 0xffff0000, v66
    v_lshlrev_b32 v68, 16, v70
    v_and_b32 v69, 0xffff0000, v70
    v_lshlrev_b32 v72, 16, v74
    v_and_b32 v73, 0xffff0000, v74
    v_lshlrev_b32 v76, 16, v78
    v_and_b32 v77, 0xffff0000, v78
    v_pk_mul_f32 v[60:61], v[60:61], v[86:87] op_sel:[0,0] op_sel_hi:[1,0]
    v_pk_mul_f32 v[64:65], v[64:65], v[86:87] op_sel:[0,0] op_sel_hi:[1,0]
    v_pk_mul_f32 v[68:69], v[68:69], v[86:87] op_sel:[0,0] op_sel_hi:[1,0]
    v_pk_mul_f32 v[72:73], v[72:73], v[86:87] op_sel:[0,0] op_sel_hi:[1,0]
    v_pk_mul_f32 v[76:77], v[76:77], v[86:87] op_sel:[0,0] op_sel_hi:[1,0]
    v_cvt_pk_bf16_f32 v62, v60, v61
    v_cvt_pk_bf16_f32 v66, v64, v65
    v_cvt_pk_bf16_f32 v70, v68, v69
    v_cvt_pk_bf16_f32 v74, v72, v73
    v_cvt_pk_bf16_f32 v78, v76, v77
    v_lshlrev_b32 v60, 16, v62
    v_and_b32 v61, 0xffff0000, v62
    v_lshlrev_b32 v64, 16, v66
    v_and_b32 v65, 0xffff0000, v66
    v_lshlrev_b32 v68, 16, v70
    v_and_b32 v69, 0xffff0000, v70
    v_lshlrev_b32 v72, 16, v74
    v_and_b32 v73, 0xffff0000, v74
    v_lshlrev_b32 v76, 16, v78
    v_and_b32 v77, 0xffff0000, v78
    v_pk_mul_f32 v[60:61], v[60:61], v[184:185]
    v_pk_mul_f32 v[64:65], v[64:65], v[186:187]
    v_pk_mul_f32 v[68:69], v[68:69], v[188:189]
    v_pk_mul_f32 v[72:73], v[72:73], v[190:191]
    v_pk_mul_f32 v[76:77], v[76:77], v[192:193]
    v_cvt_pk_bf16_f32 v62, v60, v61
    v_cvt_pk_bf16_f32 v66, v64, v65
    v_cvt_pk_bf16_f32 v70, v68, v69
    v_cvt_pk_bf16_f32 v74, v72, v73
    v_cvt_pk_bf16_f32 v78, v76, v77
    v_lshlrev_b32 v60, 16, v62
    v_and_b32 v61, 0xffff0000, v62
    v_lshlrev_b32 v64, 16, v66
    v_and_b32 v65, 0xffff0000, v66
    v_lshlrev_b32 v68, 16, v70
    v_and_b32 v69, 0xffff0000, v70
    v_lshlrev_b32 v72, 16, v74
    v_and_b32 v73, 0xffff0000, v74
    v_lshlrev_b32 v76, 16, v78
    v_and_b32 v77, 0xffff0000, v78
    v_pk_add_f32 v[60:61], v[60:61], v[174:175]
    v_pk_add_f32 v[64:65], v[64:65], v[176:177]
    v_pk_add_f32 v[68:69], v[68:69], v[178:179]
    v_pk_add_f32 v[72:73], v[72:73], v[180:181]
    v_pk_add_f32 v[76:77], v[76:77], v[182:183]
    v_cvt_pk_bf16_f32 v92, v60, v61
    v_cvt_pk_bf16_f32 v93, v64, v65
    v_cvt_pk_bf16_f32 v94, v68, v69
    v_cvt_pk_bf16_f32 v95, v72, v73
    v_cvt_pk_bf16_f32 v100, v76, v77
    s_cmp_lt_u32 s2, 224
    s_cbranch_scc1 L_x1w
    s_waitcnt vmcnt(0)
L_x1w:
    buffer_store_dwordx4 v[92:95], v104, s[40:43], s6 offen offset:0 sc1
    buffer_store_dword v100, v105, s[40:43], s6 offen offset:0 sc1
    v_dot2_f32_bf16 v60, v168, v8, v81
    v_dot2_f32_bf16 v61, v168, v9, v81
    v_dot2_f32_bf16 v64, v169, v8, v81
    v_dot2_f32_bf16 v65, v169, v9, v81
    v_dot2_f32_bf16 v68, v170, v8, v81
    v_dot2_f32_bf16 v69, v170, v9, v81
    v_dot2_f32_bf16 v72, v171, v8, v81
    v_dot2_f32_bf16 v73, v171, v9, v81
    v_dot2_f32_bf16 v76, v173, v8, v81
    v_dot2_f32_bf16 v77, v173, v9, v81
    v_cvt_pk_bf16_f32 v62, v60, v61
    v_cvt_pk_bf16_f32 v66, v64, v65
    v_cvt_pk_bf16_f32 v70, v68, v69
    v_cvt_pk_bf16_f32 v74, v72, v73
    v_cvt_pk_bf16_f32 v78, v76, v77
    v_lshlrev_b32 v60, 16, v62
    v_and_b32 v61, 0xffff0000, v62
    v_lshlrev_b32 v64, 16, v66
    v_and_b32 v65, 0xffff0000, v66
    v_lshlrev_b32 v68, 16, v70
    v_and_b32 v69, 0xffff0000, v70
    v_lshlrev_b32 v72, 16, v74
    v_and_b32 v73, 0xffff0000, v74
    v_lshlrev_b32 v76, 16, v78
    v_and_b32 v77, 0xffff0000, v78
    v_pk_mul_f32 v[60:61], v[60:61], v[88:89] op_sel:[0,0] op_sel_hi:[1,0]
    v_pk_mul_f32 v[64:65], v[64:65], v[88:89] op_sel:[0,0] op_sel_hi:[1,0]
    v_pk_mul_f32 v[68:69], v[68:69], v[88:89] op_sel:[0,0] op_sel_hi:[1,0]
    v_pk_mul_f32 v[72:73], v[72:73], v[88:89] op_sel:[0,0] op_sel_hi:[1,0]
    v_pk_mul_f32 v[76:77], v[76:77], v[88:89] op_sel:[0,0] op_sel_hi:[1,0]
    v_cvt_pk_bf16_f32 v62, v60, v61
    v_cvt_pk_bf16_f32 v66, v64, v65
    v_cvt_pk_bf16_f32 v70, v68, v69
    v_cvt_pk_bf16_f32 v74, v72, v73
    v_cvt_pk_bf16_f32 v78, v76, v77
    v_lshlrev_b32 v60, 16, v62
    v_and_b32 v61, 0xffff0000, v62
    v_lshlrev_b32 v64, 16, v66
    v_and_b32 v65, 0xffff0000, v66
    v_lshlrev_b32 v68, 16, v70
    v_and_b32 v69, 0xffff0000, v70
    v_lshlrev_b32 v72, 16, v74
    v_and_b32 v73, 0xffff0000, v74
    v_lshlrev_b32 v76, 16, v78
    v_and_b32 v77, 0xffff0000, v78
    v_pk_mul_f32 v[60:61], v[60:61], v[184:185]
    v_pk_mul_f32 v[64:65], v[64:65], v[186:187]
    v_pk_mul_f32 v[68:69], v[68:69], v[188:189]
    v_pk_mul_f32 v[72:73], v[72:73], v[190:191]
    v_pk_mul_f32 v[76:77], v[76:77], v[192:193]
    v_cvt_pk_bf16_f32 v62, v60, v61
    v_cvt_pk_bf16_f32 v66, v64, v65
    v_cvt_pk_bf16_f32 v70, v68, v69
    v_cvt_pk_bf16_f32 v74, v72, v73
    v_cvt_pk_bf16_f32 v78, v76, v77
    v_lshlrev_b32 v60, 16, v62
    v_and_b32 v61, 0xffff0000, v62
    v_lshlrev_b32 v64, 16, v66
    v_and_b32 v65, 0xffff0000, v66
    v_lshlrev_b32 v68, 16, v70
    v_and_b32 v69, 0xffff0000, v70
    v_lshlrev_b32 v72, 16, v74
    v_and_b32 v73, 0xffff0000, v74
    v_lshlrev_b32 v76, 16, v78
    v_and_b32 v77, 0xffff0000, v78
    v_pk_add_f32 v[60:61], v[60:61], v[174:175]
    v_pk_add_f32 v[64:65], v[64:65], v[176:177]
    v_pk_add_f32 v[68:69], v[68:69], v[178:179]
    v_pk_add_f32 v[72:73], v[72:73], v[180:181]
    v_pk_add_f32 v[76:77], v[76:77], v[182:183]
    v_cvt_pk_bf16_f32 v96, v60, v61
    v_cvt_pk_bf16_f32 v97, v64, v65
    v_cvt_pk_bf16_f32 v98, v68, v69
    v_cvt_pk_bf16_f32 v99, v72, v73
    v_cvt_pk_bf16_f32 v101, v76, v77
    buffer_store_dwordx4 v[96:99], v104, s[40:43], s6 offen offset:64 sc1
    buffer_store_dword v101, v105, s[40:43], s6 offen offset:64 sc1
    buffer_store_dwordx4 v[164:167], v194, s[40:43], s25 offen sc1
    buffer_store_dwordx4 v[168:171], v194, s[40:43], s25 offen offset:128 sc1
    buffer_store_dword v172, v195, s[40:43], s25 offen sc1
    buffer_store_dword v173, v195, s[40:43], s25 offen offset:128 sc1
    s_add_u32 s30, s19, 147456
    s_cmp_eq_u32 s3, 0
    s_cselect_b32 m0, 32768, s30
    s_add_u32 s30, s22, 1773568
    buffer_load_dwordx4 v1, s[44:47], s30 offen offset:0 lds
    buffer_load_dwordx4 v1, s[44:47], s30 offen offset:1024 lds
    buffer_load_dwordx4 v1, s[44:47], s30 offen offset:2048 lds
    buffer_load_dwordx4 v1, s[44:47], s30 offen offset:3072 lds
    s_cmp_gt_u32 s29, 2
    s_cbranch_scc1 L_w1s20
    s_add_u32 m0, s19, 0
    s_add_u32 s30, s22, 888832
    buffer_load_dwordx4 v1, s[44:47], s30 offen offset:0 lds
    buffer_load_dwordx4 v1, s[44:47], s30 offen offset:1024 lds
    buffer_load_dwordx4 v1, s[44:47], s30 offen offset:2048 lds
    buffer_load_dwordx4 v1, s[44:47], s30 offen offset:3072 lds
L_w1s20:
    s_cmp_gt_u32 s29, 2
    s_cbranch_scc1 L_w1s21
    s_add_u32 m0, s19, 16384
    s_add_u32 s30, s22, 1331200
    buffer_load_dwordx4 v1, s[44:47], s30 offen offset:0 lds
    buffer_load_dwordx4 v1, s[44:47], s30 offen offset:1024 lds
    buffer_load_dwordx4 v1, s[44:47], s30 offen offset:2048 lds
    buffer_load_dwordx4 v1, s[44:47], s30 offen offset:3072 lds
L_w1s21:
    s_mov_b32 s22, s23
    s_mov_b32 s24, s62
    s_cmp_ge_u32 s2, 224
    s_cbranch_scc1 L_idle
    s_waitcnt vmcnt(0)
    s_barrier
L_g1:
    v_mov_b32 v226, 0
    v_mov_b32 v227, 0
    ds_read_b128 v[204:207], v1 offset:36864
    ds_read_b128 v[208:211], v1 offset:37888
    ds_read_b128 v[212:215], v1 offset:38912
    ds_read_b128 v[216:219], v1 offset:39936
    ds_read_b128 v[220:223], v10 offset:53248
    buffer_load_dword v224, v225, s[40:43], s22 offen offset:892 sc1
    s_add_u32 s10, s22, 0
    buffer_load_dwordx4 v[12:15], v1, s[40:43], s10 offen offset:0 sc1
    buffer_load_dwordx4 v[16:19], v1, s[40:43], s10 offen offset:1024 sc1
    s_add_u32 s10, s22, 8192
    buffer_load_dwordx4 v[20:23], v1, s[40:43], s10 offen offset:0 sc1
    buffer_load_dwordx4 v[24:27], v1, s[40:43], s10 offen offset:1024 sc1
    s_add_u32 s10, s22, 16384
    buffer_load_dwordx4 v[28:31], v1, s[40:43], s10 offen offset:0 sc1
    buffer_load_dwordx4 v[32:35], v1, s[40:43], s10 offen offset:1024 sc1
    s_add_u32 s10, s22, 24576
    buffer_load_dwordx4 v[36:39], v1, s[40:43], s10 offen offset:0 sc1
    buffer_load_dwordx4 v[40:43], v1, s[40:43], s10 offen offset:1024 sc1
    s_waitcnt vmcnt(8)
    v_cmp_lt_u32 vcc, s28, v224
    s_cbranch_vccz L_hs_ok
    s_mov_b64 exec, vcc
L_p1_loop:
    buffer_load_dword v224, v225, s[40:43], s22 offen offset:892 sc1
    s_waitcnt vmcnt(0)
    v_cmp_lt_u32 vcc, s28, v224
    s_cbranch_vccz L_p1_done
    s_add_u32 s15, s15, 1
    s_cmp_gt_u32 s15, 65536
    s_cselect_b32 s28, -1, s28
    s_mov_b64 exec, vcc
    s_branch L_p1_loop
L_p1_done:
    s_mov_b64 exec, -1
    s_add_u32 s10, s22, 0
    buffer_load_dwordx4 v[12:15], v1, s[40:43], s10 offen offset:0 sc1
    buffer_load_dwordx4 v[16:19], v1, s[40:43], s10 offen offset:1024 sc1
    s_add_u32 s10, s22, 8192
    buffer_load_dwordx4 v[20:23], v1, s[40:43], s10 offen offset:0 sc1
    buffer_load_dwordx4 v[24:27], v1, s[40:43], s10 offen offset:1024 sc1
    s_add_u32 s10, s22, 16384
    buffer_load_dwordx4 v[28:31], v1, s[40:43], s10 offen offset:0 sc1
    buffer_load_dwordx4 v[32:35], v1, s[40:43], s10 offen offset:1024 sc1
    s_add_u32 s10, s22, 24576
    buffer_load_dwordx4 v[36:39], v1, s[40:43], s10 offen offset:0 sc1
    buffer_load_dwordx4 v[40:43], v1, s[40:43], s10 offen offset:1024 sc1
L_hs_ok:
    s_waitcnt vmcnt(6)
    s_waitcnt lgkmcnt(4)
    v_mfma_f32_16x16x32_bf16 v[172:175], v[204:207], v[12:15], 0
    s_add_u32 s10, s22, 32768
    buffer_load_dwordx4 v[44:47], v1, s[40:43], s10 offen offset:0 sc1
    v_mfma_f32_16x16x32_bf16 v[176:179], v[204:207], v[16:19], 0
    ds_read_b128 v[204:207], v1 offset:40960
    v_max3_u32 v226, v12, v16, v226
    s_waitcnt lgkmcnt(4)
    v_mfma_f32_16x16x32_bf16 v[180:183], v[208:211], v[12:15], 0
    v_mfma_f32_16x16x32_bf16 v[184:187], v[208:211], v[16:19], 0
    ds_read_b128 v[208:211], v1 offset:41984
    s_waitcnt lgkmcnt(4)
    v_mfma_f32_16x16x32_bf16 v[188:191], v[212:215], v[12:15], 0
    buffer_load_dwordx4 v[48:51], v1, s[40:43], s10 offen offset:1024 sc1
    v_mfma_f32_16x16x32_bf16 v[192:195], v[212:215], v[16:19], 0
    ds_read_b128 v[212:215], v1 offset:43008
    s_waitcnt lgkmcnt(4)
    v_mfma_f32_16x16x32_bf16 v[196:199], v[216:219], v[12:15], 0
    v_mfma_f32_16x16x32_bf16 v[200:203], v[216:219], v[16:19], 0
    ds_read_b128 v[216:219], v1 offset:44032
    s_waitcnt lgkmcnt(3)
    v_mfma_f32_16x16x32_bf16 v[248:251], v[220:223], v[12:15], 0
    s_add_u32 s10, s22, 40960
    buffer_load_dwordx4 v[52:55], v1, s[40:43], s10 offen offset:0 sc1
    v_mfma_f32_16x16x32_bf16 v[252:255], v[220:223], v[16:19], 0
    ds_read_b128 v[220:223], v10 offset:57344
    s_waitcnt vmcnt(7)
    v_mfma_f32_16x16x32_bf16 v[172:175], v[204:207], v[20:23], v[172:175]
    v_max3_u32 v226, v20, v24, v226
    v_mfma_f32_16x16x32_bf16 v[176:179], v[204:207], v[24:27], v[176:179]
    ds_read_b128 v[204:207], v1 offset:45056
    s_waitcnt lgkmcnt(3)
    v_mfma_f32_16x16x32_bf16 v[180:183], v[208:211], v[20:23], v[180:183]
    buffer_load_dwordx4 v[56:59], v1, s[40:43], s10 offen offset:1024 sc1
    v_mfma_f32_16x16x32_bf16 v[184:187], v[208:211], v[24:27], v[184:187]
    ds_read_b128 v[208:211], v1 offset:46080
    v_mfma_f32_16x16x32_bf16 v[188:191], v[212:215], v[20:23], v[188:191]
    v_mfma_f32_16x16x32_bf16 v[192:195], v[212:215], v[24:27], v[192:195]
    ds_read_b128 v[212:215], v1 offset:47104
    s_waitcnt lgkmcnt(4)
    v_mfma_f32_16x16x32_bf16 v[196:199], v[216:219], v[20:23], v[196:199]
    s_add_u32 s10, s22, 49152
    buffer_load_dwordx4 v[60:63], v1, s[40:43], s10 offen offset:0 sc1
    v_mfma_f32_16x16x32_bf16 v[200:203], v[216:219], v[24:27], v[200:203]
    ds_read_b128 v[216:219], v1 offset:48128
    s_waitcnt lgkmcnt(3)
    v_mfma_f32_16x16x32_bf16 v[248:251], v[220:223], v[20:23], v[248:251]
    v_mfma_f32_16x16x32_bf16 v[252:255], v[220:223], v[24:27], v[252:255]
    ds_read_b128 v[220:223], v10 offset:61440
    s_waitcnt vmcnt(7)
    v_mfma_f32_16x16x32_bf16 v[172:175], v[204:207], v[28:31], v[172:175]
    buffer_load_dwordx4 v[64:67], v1, s[40:43], s10 offen offset:1024 sc1
    v_mfma_f32_16x16x32_bf16 v[176:179], v[204:207], v[32:35], v[176:179]
    ds_read_b128 v[204:207], v1 offset:49152
    v_max3_u32 v226, v28, v32, v226
    s_waitcnt lgkmcnt(3)
    v_mfma_f32_16x16x32_bf16 v[180:183], v[208:211], v[28:31], v[180:183]
    v_mfma_f32_16x16x32_bf16 v[184:187], v[208:211], v[32:35], v[184:187]
    ds_read_b128 v[208:211], v1 offset:50176
    v_mfma_f32_16x16x32_bf16 v[188:191], v[212:215], v[28:31], v[188:191]
    s_add_u32 s10, s22, 57344
    buffer_load_dwordx4 v[68:71], v1, s[40:43], s10 offen offset:0 sc1
    v_mfma_f32_16x16x32_bf16 v[192:195], v[212:215], v[32:35], v[192:195]
    ds_read_b128 v[212:215], v1 offset:51200
    s_waitcnt lgkmcnt(3)
    v_mfma_f32_16x16x32_bf16 v[196:199], v[216:219], v[28:31], v[196:199]
    v_mfma_f32_16x16x32_bf16 v[200:203], v[216:219], v[32:35], v[200:203]
    ds_read_b128 v[216:219], v1 offset:52224
    v_mfma_f32_16x16x32_bf16 v[248:251], v[220:223], v[28:31], v[248:251]
    buffer_load_dwordx4 v[72:75], v1, s[40:43], s10 offen offset:1024 sc1
    v_mfma_f32_16x16x32_bf16 v[252:255], v[220:223], v[32:35], v[252:255]
    ds_read_b128 v[220:223], v11 offset:0
    s_waitcnt vmcnt(8)
    s_waitcnt lgkmcnt(3)
    v_mfma_f32_16x16x32_bf16 v[172:175], v[204:207], v[36:39], v[172:175]
    v_max3_u32 v226, v36, v40, v226
    v_mfma_f32_16x16x32_bf16 v[176:179], v[204:207], v[40:43], v[176:179]
    ds_read_b128 v[204:207], v1 offset:53248
    v_mfma_f32_16x16x32_bf16 v[180:183], v[208:211], v[36:39], v[180:183]
    s_add_u32 s10, s22, 65536
    buffer_load_dwordx4 v[76:79], v1, s[40:43], s10 offen offset:0 sc1
    v_mfma_f32_16x16x32_bf16 v[184:187], v[208:211], v[40:43], v[184:187]
    ds_read_b128 v[208:211], v1 offset:54272
    s_waitcnt lgkmcnt(3)
    v_mfma_f32_16x16x32_bf16 v[188:191], v[212:215], v[36:39], v[188:191]
    v_mfma_f32_16x16x32_bf16 v[192:195], v[212:215], v[40:43], v[192:195]
    ds_read_b128 v[212:215], v1 offset:55296
    v_mfma_f32_16x16x32_bf16 v[196:199], v[216:219], v[36:39], v[196:199]
    buffer_load_dwordx4 v[80:83], v1, s[40:43], s10 offen offset:1024 sc1
    v_mfma_f32_16x16x32_bf16 v[200:203], v[216:219], v[40:43], v[200:203]
    ds_read_b128 v[216:219], v1 offset:56320
    s_waitcnt lgkmcnt(3)
    v_mfma_f32_16x16x32_bf16 v[248:251], v[220:223], v[36:39], v[248:251]
    v_mfma_f32_16x16x32_bf16 v[252:255], v[220:223], v[40:43], v[252:255]
    ds_read_b128 v[220:223], v11 offset:4096
    s_waitcnt vmcnt(8)
    v_mfma_f32_16x16x32_bf16 v[172:175], v[204:207], v[44:47], v[172:175]
    s_add_u32 s10, s22, 73728
    buffer_load_dwordx4 v[84:87], v1, s[40:43], s10 offen offset:0 sc1
    v_mfma_f32_16x16x32_bf16 v[176:179], v[204:207], v[48:51], v[176:179]
    ds_read_b128 v[204:207], v1 offset:57344
    v_max3_u32 v226, v44, v48, v226
    s_waitcnt lgkmcnt(3)
    v_mfma_f32_16x16x32_bf16 v[180:183], v[208:211], v[44:47], v[180:183]
    v_mfma_f32_16x16x32_bf16 v[184:187], v[208:211], v[48:51], v[184:187]
    ds_read_b128 v[208:211], v1 offset:58368
    v_mfma_f32_16x16x32_bf16 v[188:191], v[212:215], v[44:47], v[188:191]
    buffer_load_dwordx4 v[88:91], v1, s[40:43], s10 offen offset:1024 sc1
    v_mfma_f32_16x16x32_bf16 v[192:195], v[212:215], v[48:51], v[192:195]
    ds_read_b128 v[212:215], v1 offset:59392
    s_waitcnt lgkmcnt(3)
    v_mfma_f32_16x16x32_bf16 v[196:199], v[216:219], v[44:47], v[196:199]
    v_mfma_f32_16x16x32_bf16 v[200:203], v[216:219], v[48:51], v[200:203]
    ds_read_b128 v[216:219], v1 offset:60416
    v_mfma_f32_16x16x32_bf16 v[248:251], v[220:223], v[44:47], v[248:251]
    s_add_u32 s10, s22, 81920
    buffer_load_dwordx4 v[92:95], v1, s[40:43], s10 offen offset:0 sc1
    v_mfma_f32_16x16x32_bf16 v[252:255], v[220:223], v[48:51], v[252:255]
    ds_read_b128 v[220:223], v11 offset:8192
    s_waitcnt vmcnt(9)
    s_waitcnt lgkmcnt(3)
    v_mfma_f32_16x16x32_bf16 v[172:175], v[204:207], v[52:55], v[172:175]
    v_max3_u32 v226, v52, v56, v226
    v_mfma_f32_16x16x32_bf16 v[176:179], v[204:207], v[56:59], v[176:179]
    ds_read_b128 v[204:207], v1 offset:61440
    v_mfma_f32_16x16x32_bf16 v[180:183], v[208:211], v[52:55], v[180:183]
    buffer_load_dwordx4 v[96:99], v1, s[40:43], s10 offen offset:1024 sc1
    v_mfma_f32_16x16x32_bf16 v[184:187], v[208:211], v[56:59], v[184:187]
    ds_read_b128 v[208:211], v1 offset:62464
    s_waitcnt lgkmcnt(3)
    v_mfma_f32_16x16x32_bf16 v[188:191], v[212:215], v[52:55], v[188:191]
    v_mfma_f32_16x16x32_bf16 v[192:195], v[212:215], v[56:59], v[192:195]
    ds_read_b128 v[212:215], v1 offset:63488
    v_mfma_f32_16x16x32_bf16 v[196:199], v[216:219], v[52:55], v[196:199]
    s_add_u32 s10, s22, 90112
    buffer_load_dwordx4 v[100:103], v1, s[40:43], s10 offen offset:0 sc1
    v_mfma_f32_16x16x32_bf16 v[200:203], v[216:219], v[56:59], v[200:203]
    ds_read_b128 v[216:219], v1 offset:64512
    s_waitcnt lgkmcnt(3)
    v_mfma_f32_16x16x32_bf16 v[248:251], v[220:223], v[52:55], v[248:251]
    v_mfma_f32_16x16x32_bf16 v[252:255], v[220:223], v[56:59], v[252:255]
    ds_read_b128 v[220:223], v11 offset:12288
    s_waitcnt vmcnt(9)
    v_mfma_f32_16x16x32_bf16 v[172:175], v[204:207], v[60:63], v[172:175]
    buffer_load_dwordx4 v[104:107], v1, s[40:43], s10 offen offset:1024 sc1
    v_mfma_f32_16x16x32_bf16 v[176:179], v[204:207], v[64:67], v[176:179]
    ds_read_b128 v[204:207], v10 offset:0
    v_max3_u32 v226, v60, v64, v226
    s_waitcnt lgkmcnt(3)
    v_mfma_f32_16x16x32_bf16 v[180:183], v[208:211], v[60:63], v[180:183]
    v_mfma_f32_16x16x32_bf16 v[184:187], v[208:211], v[64:67], v[184:187]
    ds_read_b128 v[208:211], v10 offset:1024
    v_mfma_f32_16x16x32_bf16 v[188:191], v[212:215], v[60:63], v[188:191]
    s_add_u32 s10, s22, 98304
    buffer_load_dwordx4 v[108:111], v1, s[40:43], s10 offen offset:0 sc1
    v_mfma_f32_16x16x32_bf16 v[192:195], v[212:215], v[64:67], v[192:195]
    ds_read_b128 v[212:215], v10 offset:2048
    s_waitcnt lgkmcnt(3)
    v_mfma_f32_16x16x32_bf16 v[196:199], v[216:219], v[60:63], v[196:199]
    v_mfma_f32_16x16x32_bf16 v[200:203], v[216:219], v[64:67], v[200:203]
    ds_read_b128 v[216:219], v10 offset:3072
    v_mfma_f32_16x16x32_bf16 v[248:251], v[220:223], v[60:63], v[248:251]
    buffer_load_dwordx4 v[112:115], v1, s[40:43], s10 offen offset:1024 sc1
    v_mfma_f32_16x16x32_bf16 v[252:255], v[220:223], v[64:67], v[252:255]
    ds_read_b128 v[220:223], v11 offset:16384
    s_waitcnt vmcnt(10)
    s_waitcnt lgkmcnt(3)
    v_mfma_f32_16x16x32_bf16 v[172:175], v[204:207], v[68:71], v[172:175]
    v_max3_u32 v226, v68, v72, v226
    v_mfma_f32_16x16x32_bf16 v[176:179], v[204:207], v[72:75], v[176:179]
    ds_read_b128 v[204:207], v10 offset:4096
    v_mfma_f32_16x16x32_bf16 v[180:183], v[208:211], v[68:71], v[180:183]
    s_add_u32 s10, s22, 106496
    buffer_load_dwordx4 v[116:119], v1, s[40:43], s10 offen offset:0 sc1
    v_mfma_f32_16x16x32_bf16 v[184:187], v[208:211], v[72:75], v[184:187]
    ds_read_b128 v[208:211], v10 offset:5120
    s_waitcnt lgkmcnt(3)
    v_mfma_f32_16x16x32_bf16 v[188:191], v[212:215], v[68:71], v[188:191]
    v_mfma_f32_16x16x32_bf16 v[192:195], v[212:215], v[72:75], v[192:195]
    ds_read_b128 v[212:215], v10 offset:6144
    v_mfma_f32_16x16x32_bf16 v[196:199], v[216:219], v[68:71], v[196:199]
    buffer_load_dwordx4 v[120:123], v1, s[40:43], s10 offen offset:1024 sc1
    v_mfma_f32_16x16x32_bf16 v[200:203], v[216:219], v[72:75], v[200:203]
    ds_read_b128 v[216:219], v10 offset:7168
    s_waitcnt lgkmcnt(3)
    v_mfma_f32_16x16x32_bf16 v[248:251], v[220:223], v[68:71], v[248:251]
    v_mfma_f32_16x16x32_bf16 v[252:255], v[220:223], v[72:75], v[252:255]
    ds_read_b128 v[220:223], v1 offset:0
    s_waitcnt vmcnt(10)
    v_mfma_f32_16x16x32_bf16 v[172:175], v[204:207], v[76:79], v[172:175]
    s_add_u32 s10, s22, 114688
    buffer_load_dwordx4 v[124:127], v1, s[40:43], s10 offen offset:0 sc1
    v_mfma_f32_16x16x32_bf16 v[176:179], v[204:207], v[80:83], v[176:179]
    ds_read_b128 v[204:207], v10 offset:8192
    v_max3_u32 v226, v76, v80, v226
    s_waitcnt lgkmcnt(3)
    v_mfma_f32_16x16x32_bf16 v[180:183], v[208:211], v[76:79], v[180:183]
    v_mfma_f32_16x16x32_bf16 v[184:187], v[208:211], v[80:83], v[184:187]
    ds_read_b128 v[208:211], v10 offset:9216
    v_mfma_f32_16x16x32_bf16 v[188:191], v[212:215], v[76:79], v[188:191]
    buffer_load_dwordx4 v[128:131], v1, s[40:43], s10 offen offset:1024 sc1
    v_mfma_f32_16x16x32_bf16 v[192:195], v[212:215], v[80:83], v[192:195]
    ds_read_b128 v[212:215], v10 offset:10240
    s_waitcnt lgkmcnt(3)
    v_mfma_f32_16x16x32_bf16 v[196:199], v[216:219], v[76:79], v[196:199]
    v_mfma_f32_16x16x32_bf16 v[200:203], v[216:219], v[80:83], v[200:203]
    ds_read_b128 v[216:219], v10 offset:11264
    v_mfma_f32_16x16x32_bf16 v[248:251], v[220:223], v[76:79], v[248:251]
    s_add_u32 s10, s22, 122880
    buffer_load_dwordx4 v[132:135], v1, s[40:43], s10 offen offset:0 sc1
    v_mfma_f32_16x16x32_bf16 v[252:255], v[220:223], v[80:83], v[252:255]
    ds_read_b128 v[220:223], v1 offset:4096
    s_waitcnt vmcnt(11)
    s_waitcnt lgkmcnt(3)
    v_mfma_f32_16x16x32_bf16 v[172:175], v[204:207], v[84:87], v[172:175]
    v_max3_u32 v226, v84, v88, v226
    v_mfma_f32_16x16x32_bf16 v[176:179], v[204:207], v[88:91], v[176:179]
    ds_read_b128 v[204:207], v10 offset:12288
    v_mfma_f32_16x16x32_bf16 v[180:183], v[208:211], v[84:87], v[180:183]
    buffer_load_dwordx4 v[136:139], v1, s[40:43], s10 offen offset:1024 sc1
    v_mfma_f32_16x16x32_bf16 v[184:187], v[208:211], v[88:91], v[184:187]
    ds_read_b128 v[208:211], v10 offset:13312
    s_waitcnt lgkmcnt(3)
    v_mfma_f32_16x16x32_bf16 v[188:191], v[212:215], v[84:87], v[188:191]
    v_mfma_f32_16x16x32_bf16 v[192:195], v[212:215], v[88:91], v[192:195]
    ds_read_b128 v[212:215], v10 offset:14336
    v_mfma_f32_16x16x32_bf16 v[196:199], v[216:219], v[84:87], v[196:199]
    s_add_u32 s10, s22, 131072
    buffer_load_dwordx4 v[140:143], v1, s[40:43], s10 offen offset:0 sc1
    v_mfma_f32_16x16x32_bf16 v[200:203], v[216:219], v[88:91], v[200:203]
    ds_read_b128 v[216:219], v10 offset:15360
    s_waitcnt lgkmcnt(3)
    v_mfma_f32_16x16x32_bf16 v[248:251], v[220:223], v[84:87], v[248:251]
    v_mfma_f32_16x16x32_bf16 v[252:255], v[220:223], v[88:91], v[252:255]
    ds_read_b128 v[220:223], v1 offset:8192
    s_waitcnt vmcnt(11)
    v_mfma_f32_16x16x32_bf16 v[172:175], v[204:207], v[92:95], v[172:175]
    buffer_load_dwordx4 v[144:147], v1, s[40:43], s10 offen offset:1024 sc1
    v_mfma_f32_16x16x32_bf16 v[176:179], v[204:207], v[96:99], v[176:179]
    ds_read_b128 v[204:207], v10 offset:16384
    v_max3_u32 v226, v92, v96, v226
    s_waitcnt lgkmcnt(3)
    v_mfma_f32_16x16x32_bf16 v[180:183], v[208:211], v[92:95], v[180:183]
    v_mfma_f32_16x16x32_bf16 v[184:187], v[208:211], v[96:99], v[184:187]
    ds_read_b128 v[208:211], v10 offset:17408
    v_mfma_f32_16x16x32_bf16 v[188:191], v[212:215], v[92:95], v[188:191]
    s_add_u32 s10, s22, 139264
    buffer_load_dwordx4 v[148:151], v1, s[40:43], s10 offen offset:0 sc1
    v_mfma_f32_16x16x32_bf16 v[192:195], v[212:215], v[96:99], v[192:195]
    ds_read_b128 v[212:215], v10 offset:18432
    s_waitcnt lgkmcnt(3)
    v_mfma_f32_16x16x32_bf16 v[196:199], v[216:219], v[92:95], v[196:199]
    v_mfma_f32_16x16x32_bf16 v[200:203], v[216:219], v[96:99], v[200:203]
    ds_read_b128 v[216:219], v10 offset:19456
    v_mfma_f32_16x16x32_bf16 v[248:251], v[220:223], v[92:95], v[248:251]
    buffer_load_dwordx4 v[152:155], v1, s[40:43], s10 offen offset:1024 sc1
    v_mfma_f32_16x16x32_bf16 v[252:255], v[220:223], v[96:99], v[252:255]
    ds_read_b128 v[220:223], v1 offset:12288
    s_waitcnt vmcnt(12)
    s_waitcnt lgkmcnt(3)
    v_mfma_f32_16x16x32_bf16 v[172:175], v[204:207], v[100:103], v[172:175]
    v_max3_u32 v226, v100, v104, v226
    v_mfma_f32_16x16x32_bf16 v[176:179], v[204:207], v[104:107], v[176:179]
    ds_read_b128 v[204:207], v10 offset:20480
    v_mfma_f32_16x16x32_bf16 v[180:183], v[208:211], v[100:103], v[180:183]
    s_add_u32 s10, s22, 147456
    buffer_load_dwordx4 v[156:159], v1, s[40:43], s10 offen offset:0 sc1
    v_mfma_f32_16x16x32_bf16 v[184:187], v[208:211], v[104:107], v[184:187]
    ds_read_b128 v[208:211], v10 offset:21504
    s_waitcnt lgkmcnt(3)
    v_mfma_f32_16x16x32_bf16 v[188:191], v[212:215], v[100:103], v[188:191]
    v_mfma_f32_16x16x32_bf16 v[192:195], v[212:215], v[104:107], v[192:195]
    ds_read_b128 v[212:215], v10 offset:22528
    v_mfma_f32_16x16x32_bf16 v[196:199], v[216:219], v[100:103], v[196:199]
    buffer_load_dwordx4 v[160:163], v1, s[40:43], s10 offen offset:1024 sc1
    v_mfma_f32_16x16x32_bf16 v[200:203], v[216:219], v[104:107], v[200:203]
    ds_read_b128 v[216:219], v10 offset:23552
    s_waitcnt lgkmcnt(3)
    v_mfma_f32_16x16x32_bf16 v[248:251], v[220:223], v[100:103], v[248:251]
    v_mfma_f32_16x16x32_bf16 v[252:255], v[220:223], v[104:107], v[252:255]
    ds_read_b128 v[220:223], v1 offset:16384
    s_waitcnt vmcnt(12)
    v_mfma_f32_16x16x32_bf16 v[172:175], v[204:207], v[108:111], v[172:175]
    s_add_u32 s10, s22, 155648
    buffer_load_dwordx4 v[164:167], v1, s[40:43], s10 offen offset:0 sc1
    v_mfma_f32_16x16x32_bf16 v[176:179], v[204:207], v[112:115], v[176:179]
    ds_read_b128 v[204:207], v10 offset:24576
    v_max3_u32 v226, v108, v112, v226
    s_waitcnt lgkmcnt(3)
    v_mfma_f32_16x16x32_bf16 v[180:183], v[208:211], v[108:111], v[180:183]
    v_mfma_f32_16x16x32_bf16 v[184:187], v[208:211], v[112:115], v[184:187]
    ds_read_b128 v[208:211], v10 offset:25600
    v_mfma_f32_16x16x32_bf16 v[188:191], v[212:215], v[108:111], v[188:191]
    buffer_load_dwordx4 v[168:171], v1, s[40:43], s10 offen offset:1024 sc1
    v_mfma_f32_16x16x32_bf16 v[192:195], v[212:215], v[112:115], v[192:195]
    ds_read_b128 v[212:215], v10 offset:26624
    s_waitcnt lgkmcnt(3)
    v_mfma_f32_16x16x32_bf16 v[196:199], v[216:219], v[108:111], v[196:199]
    v_mfma_f32_16x16x32_bf16 v[200:203], v[216:219], v[112:115], v[200:203]
    ds_read_b128 v[216:219], v10 offset:27648
    v_mfma_f32_16x16x32_bf16 v[248:251], v[220:223], v[108:111], v[248:251]
    v_mfma_f32_16x16x32_bf16 v[252:255], v[220:223], v[112:115], v[252:255]
    ds_read_b128 v[220:223], v1 offset:20480
    s_waitcnt vmcnt(12)
    s_waitcnt lgkmcnt(3)
    v_mfma_f32_16x16x32_bf16 v[172:175], v[204:207], v[116:119], v[172:175]
    v_max3_u32 v226, v116, v120, v226
    v_mfma_f32_16x16x32_bf16 v[176:179], v[204:207], v[120:123], v[176:179]
    ds_read_b128 v[204:207], v10 offset:28672
    v_mfma_f32_16x16x32_bf16 v[180:183], v[208:211], v[116:119], v[180:183]
    v_mfma_f32_16x16x32_bf16 v[184:187], v[208:211], v[120:123], v[184:187]
    ds_read_b128 v[208:211], v10 offset:29696
    s_waitcnt lgkmcnt(3)
    v_mfma_f32_16x16x32_bf16 v[188:191], v[212:215], v[116:119], v[188:191]
    v_mfma_f32_16x16x32_bf16 v[192:195], v[212:215], v[120:123], v[192:195]
    ds_read_b128 v[212:215], v10 offset:30720
    v_mfma_f32_16x16x32_bf16 v[196:199], v[216:219], v[116:119], v[196:199]
    v_mfma_f32_16x16x32_bf16 v[200:203], v[216:219], v[120:123], v[200:203]
    ds_read_b128 v[216:219], v10 offset:31744
    s_waitcnt lgkmcnt(4)
    v_mfma_f32_16x16x32_bf16 v[248:251], v[220:223], v[116:119], v[248:251]
    v_mfma_f32_16x16x32_bf16 v[252:255], v[220:223], v[120:123], v[252:255]
    ds_read_b128 v[220:223], v1 offset:24576
    s_waitcnt vmcnt(10)
    s_waitcnt lgkmcnt(3)
    v_mfma_f32_16x16x32_bf16 v[172:175], v[204:207], v[124:127], v[172:175]
    v_max3_u32 v226, v124, v128, v226
    v_mfma_f32_16x16x32_bf16 v[176:179], v[204:207], v[128:131], v[176:179]
    ds_read_b128 v[204:207], v10 offset:32768
    v_mfma_f32_16x16x32_bf16 v[180:183], v[208:211], v[124:127], v[180:183]
    v_mfma_f32_16x16x32_bf16 v[184:187], v[208:211], v[128:131], v[184:187]
    ds_read_b128 v[208:211], v10 offset:33792
    s_waitcnt lgkmcnt(3)
    v_mfma_f32_16x16x32_bf16 v[188:191], v[212:215], v[124:127], v[188:191]
    v_mfma_f32_16x16x32_bf16 v[192:195], v[212:215], v[128:131], v[192:195]
    ds_read_b128 v[212:215], v10 offset:34816
    v_mfma_f32_16x16x32_bf16 v[196:199], v[216:219], v[124:127], v[196:199]
    v_mfma_f32_16x16x32_bf16 v[200:203], v[216:219], v[128:131], v[200:203]
    ds_read_b128 v[216:219], v10 offset:35840
    s_waitcnt lgkmcnt(4)
    v_mfma_f32_16x16x32_bf16 v[248:251], v[220:223], v[124:127], v[248:251]
    v_mfma_f32_16x16x32_bf16 v[252:255], v[220:223], v[128:131], v[252:255]
    ds_read_b128 v[220:223], v1 offset:28672
    s_waitcnt vmcnt(8)
    s_waitcnt lgkmcnt(3)
    v_mfma_f32_16x16x32_bf16 v[172:175], v[204:207], v[132:135], v[172:175]
    v_max3_u32 v226, v132, v136, v226
    v_mfma_f32_16x16x32_bf16 v[176:179], v[204:207], v[136:139], v[176:179]
    ds_read_b128 v[204:207], v10 offset:36864
    v_mfma_f32_16x16x32_bf16 v[180:183], v[208:211], v[132:135], v[180:183]
    v_mfma_f32_16x16x32_bf16 v[184:187], v[208:211], v[136:139], v[184:187]
    ds_read_b128 v[208:211], v10 offset:37888
    s_waitcnt lgkmcnt(3)
    v_mfma_f32_16x16x32_bf16 v[188:191], v[212:215], v[132:135], v[188:191]
    v_mfma_f32_16x16x32_bf16 v[192:195], v[212:215], v[136:139], v[192:195]
    ds_read_b128 v[212:215], v10 offset:38912
    v_mfma_f32_16x16x32_bf16 v[196:199], v[216:219], v[132:135], v[196:199]
    v_mfma_f32_16x16x32_bf16 v[200:203], v[216:219], v[136:139], v[200:203]
    ds_read_b128 v[216:219], v10 offset:39936
    s_waitcnt lgkmcnt(4)
    v_mfma_f32_16x16x32_bf16 v[248:251], v[220:223], v[132:135], v[248:251]
    v_mfma_f32_16x16x32_bf16 v[252:255], v[220:223], v[136:139], v[252:255]
    ds_read_b128 v[220:223], v1 offset:32768
    s_waitcnt vmcnt(6)
    s_waitcnt lgkmcnt(3)
    v_mfma_f32_16x16x32_bf16 v[172:175], v[204:207], v[140:143], v[172:175]
    v_max3_u32 v226, v140, v141, v226
    v_max3_u32 v227, v142, v143, v227
    v_mfma_f32_16x16x32_bf16 v[176:179], v[204:207], v[144:147], v[176:179]
    ds_read_b128 v[204:207], v10 offset:40960
    v_max3_u32 v226, v144, v145, v226
    v_mfma_f32_16x16x32_bf16 v[180:183], v[208:211], v[140:143], v[180:183]
    v_max3_u32 v227, v146, v147, v227
    v_mfma_f32_16x16x32_bf16 v[184:187], v[208:211], v[144:147], v[184:187]
    ds_read_b128 v[208:211], v10 offset:41984
    s_waitcnt lgkmcnt(3)
    v_mfma_f32_16x16x32_bf16 v[188:191], v[212:215], v[140:143], v[188:191]
    v_mfma_f32_16x16x32_bf16 v[192:195], v[212:215], v[144:147], v[192:195]
    ds_read_b128 v[212:215], v10 offset:43008
    v_mfma_f32_16x16x32_bf16 v[196:199], v[216:219], v[140:143], v[196:199]
    v_mfma_f32_16x16x32_bf16 v[200:203], v[216:219], v[144:147], v[200:203]
    ds_read_b128 v[216:219], v10 offset:44032
    s_waitcnt lgkmcnt(4)
    v_mfma_f32_16x16x32_bf16 v[248:251], v[220:223], v[140:143], v[248:251]
    v_mfma_f32_16x16x32_bf16 v[252:255], v[220:223], v[144:147], v[252:255]
    ds_read_b128 v[220:223], v11 offset:20480
    s_waitcnt vmcnt(4)
    s_waitcnt lgkmcnt(3)
    v_mfma_f32_16x16x32_bf16 v[172:175], v[204:207], v[148:151], v[172:175]
    v_max3_u32 v226, v148, v149, v226
    v_max3_u32 v227, v150, v151, v227
    v_mfma_f32_16x16x32_bf16 v[176:179], v[204:207], v[152:155], v[176:179]
    ds_read_b128 v[204:207], v10 offset:45056
    v_max3_u32 v226, v152, v153, v226
    v_mfma_f32_16x16x32_bf16 v[180:183], v[208:211], v[148:151], v[180:183]
    v_max3_u32 v227, v154, v155, v227
    v_mfma_f32_16x16x32_bf16 v[184:187], v[208:211], v[152:155], v[184:187]
    ds_read_b128 v[208:211], v10 offset:46080
    s_waitcnt lgkmcnt(3)
    v_mfma_f32_16x16x32_bf16 v[188:191], v[212:215], v[148:151], v[188:191]
    v_mfma_f32_16x16x32_bf16 v[192:195], v[212:215], v[152:155], v[192:195]
    ds_read_b128 v[212:215], v10 offset:47104
    v_mfma_f32_16x16x32_bf16 v[196:199], v[216:219], v[148:151], v[196:199]
    v_mfma_f32_16x16x32_bf16 v[200:203], v[216:219], v[152:155], v[200:203]
    ds_read_b128 v[216:219], v10 offset:48128
    s_waitcnt lgkmcnt(4)
    v_mfma_f32_16x16x32_bf16 v[248:251], v[220:223], v[148:151], v[248:251]
    v_mfma_f32_16x16x32_bf16 v[252:255], v[220:223], v[152:155], v[252:255]
    ds_read_b128 v[220:223], v11 offset:24576
    s_waitcnt vmcnt(2)
    s_waitcnt lgkmcnt(3)
    v_mfma_f32_16x16x32_bf16 v[172:175], v[204:207], v[156:159], v[172:175]
    v_max3_u32 v226, v156, v157, v226
    v_max3_u32 v227, v158, v159, v227
    v_mfma_f32_16x16x32_bf16 v[176:179], v[204:207], v[160:163], v[176:179]
    ds_read_b128 v[204:207], v10 offset:49152
    v_max3_u32 v226, v160, v161, v226
    v_mfma_f32_16x16x32_bf16 v[180:183], v[208:211], v[156:159], v[180:183]
    v_max3_u32 v227, v162, v163, v227
    v_mfma_f32_16x16x32_bf16 v[184:187], v[208:211], v[160:163], v[184:187]
    ds_read_b128 v[208:211], v10 offset:50176
    s_waitcnt lgkmcnt(3)
    v_mfma_f32_16x16x32_bf16 v[188:191], v[212:215], v[156:159], v[188:191]
    v_mfma_f32_16x16x32_bf16 v[192:195], v[212:215], v[160:163], v[192:195]
    ds_read_b128 v[212:215], v10 offset:51200
    v_mfma_f32_16x16x32_bf16 v[196:199], v[216:219], v[156:159], v[196:199]
    v_mfma_f32_16x16x32_bf16 v[200:203], v[216:219], v[160:163], v[200:203]
    ds_read_b128 v[216:219], v10 offset:52224
    s_waitcnt lgkmcnt(4)
    v_mfma_f32_16x16x32_bf16 v[248:251], v[220:223], v[156:159], v[248:251]
    v_mfma_f32_16x16x32_bf16 v[252:255], v[220:223], v[160:163], v[252:255]
    ds_read_b128 v[220:223], v11 offset:28672
    s_waitcnt vmcnt(0)
    s_waitcnt lgkmcnt(3)
    v_mfma_f32_16x16x32_bf16 v[172:175], v[204:207], v[164:167], v[172:175]
    v_max3_u32 v226, v164, v165, v226
    v_max3_u32 v227, v166, v167, v227
    v_mfma_f32_16x16x32_bf16 v[176:179], v[204:207], v[168:171], v[176:179]
    ds_read_b128 v[204:207], v10 offset:54272
    v_max3_u32 v226, v168, v169, v226
    v_mfma_f32_16x16x32_bf16 v[180:183], v[208:211], v[164:167], v[180:183]
    v_max3_u32 v227, v170, v171, v227
    v_mfma_f32_16x16x32_bf16 v[184:187], v[208:211], v[168:171], v[184:187]
    ds_read_b128 v[208:211], v10 offset:58368
    s_waitcnt lgkmcnt(3)
    v_mfma_f32_16x16x32_bf16 v[188:191], v[212:215], v[164:167], v[188:191]
    v_mfma_f32_16x16x32_bf16 v[192:195], v[212:215], v[168:171], v[192:195]
    ds_read_b128 v[212:215], v10 offset:62464
    v_mfma_f32_16x16x32_bf16 v[196:199], v[216:219], v[164:167], v[196:199]
    v_mfma_f32_16x16x32_bf16 v[200:203], v[216:219], v[168:171], v[200:203]
    ds_read_b128 v[216:219], v11 offset:1024
    s_waitcnt lgkmcnt(4)
    v_mfma_f32_16x16x32_bf16 v[248:251], v[220:223], v[164:167], v[248:251]
    v_mfma_f32_16x16x32_bf16 v[252:255], v[220:223], v[168:171], v[252:255]
    ds_read_b128 v[220:223], v11 offset:5120
    v_max_u32 v226, v226, v227
    v_cmp_lt_u32 vcc, s28, v226
    s_cbranch_vccnz L_g1_redo
    v_cvt_pk_bf16_f32 v172, v172, v173
    v_cvt_pk_bf16_f32 v173, v174, v175
    v_cvt_pk_bf16_f32 v174, v180, v181
    v_cvt_pk_bf16_f32 v175, v182, v183
    v_cvt_pk_bf16_f32 v176, v176, v177
    v_cvt_pk_bf16_f32 v177, v178, v179
    v_cvt_pk_bf16_f32 v178, v184, v185
    v_cvt_pk_bf16_f32 v179, v186, v187
    v_cvt_pk_bf16_f32 v188, v188, v189
    v_cvt_pk_bf16_f32 v189, v190, v191
    v_cvt_pk_bf16_f32 v190, v196, v197
    v_cvt_pk_bf16_f32 v191, v198, v199
    v_cvt_pk_bf16_f32 v192, v192, v193
    v_cvt_pk_bf16_f32 v193, v194, v195
    v_cvt_pk_bf16_f32 v194, v200, v201
    v_cvt_pk_bf16_f32 v195, v202, v203
    s_waitcnt lgkmcnt(1)
    v_mfma_f32_16x16x32_bf16 v[180:183], v[204:207], v[12:15], 0
    buffer_load_dwordx4 a[224:227], v230, s[40:43], s100 offen offset:1024
    v_mfma_f32_16x16x32_bf16 v[184:187], v[204:207], v[16:19], 0
    ds_read_b128 v[204:207], v11 offset:9216
    v_pk_max_i16 v172, v172, 0
    v_mfma_f32_16x16x32_bf16 v[180:183], v[208:211], v[20:23], v[180:183]
    v_pk_max_i16 v173, v173, 0
    v_pk_max_i16 v174, v174, 0
    v_mfma_f32_16x16x32_bf16 v[184:187], v[208:211], v[24:27], v[184:187]
    ds_read_b128 v[208:211], v11 offset:13312
    v_pk_max_i16 v175, v175, 0
    v_mfma_f32_16x16x32_bf16 v[180:183], v[212:215], v[28:31], v[180:183]
    s_add_u32 s12, s24, 0
    buffer_store_dwordx4 v[172:175], v1, s[40:43], s12 offen offset:0 sc1
    v_mfma_f32_16x16x32_bf16 v[184:187], v[212:215], v[32:35], v[184:187]
    ds_read_b128 v[212:215], v11 offset:17408
    v_pk_max_i16 v176, v176, 0
    v_mfma_f32_16x16x32_bf16 v[180:183], v[216:219], v[36:39], v[180:183]
    buffer_load_dwordx4 a[228:231], v230, s[40:43], s100 offen offset:2048
    v_mfma_f32_16x16x32_bf16 v[184:187], v[216:219], v[40:43], v[184:187]
    ds_read_b128 v[216:219], v1 offset:1024
    v_pk_max_i16 v177, v177, 0
    s_waitcnt lgkmcnt(3)
    v_mfma_f32_16x16x32_bf16 v[180:183], v[220:223], v[44:47], v[180:183]
    v_pk_max_i16 v178, v178, 0
    v_pk_max_i16 v179, v179, 0
    v_mfma_f32_16x16x32_bf16 v[184:187], v[220:223], v[48:51], v[184:187]
    ds_read_b128 v[220:223], v1 offset:5120
    v_mfma_f32_16x16x32_bf16 v[180:183], v[204:207], v[52:55], v[180:183]
    s_add_u32 s12, s24, 0
    buffer_store_dwordx4 v[176:179], v1, s[40:43], s12 offen offset:1024 sc1
    v_mfma_f32_16x16x32_bf16 v[184:187], v[204:207], v[56:59], v[184:187]
    ds_read_b128 v[204:207], v1 offset:9216
    v_pk_max_i16 v188, v188, 0
    s_waitcnt lgkmcnt(3)
    v_mfma_f32_16x16x32_bf16 v[180:183], v[208:211], v[60:63], v[180:183]
    buffer_load_dwordx4 a[232:235], v230, s[40:43], s100 offen offset:3072
    v_mfma_f32_16x16x32_bf16 v[184:187], v[208:211], v[64:67], v[184:187]
    ds_read_b128 v[208:211], v1 offset:13312
    v_pk_max_i16 v189, v189, 0
    v_mfma_f32_16x16x32_bf16 v[180:183], v[212:215], v[68:71], v[180:183]
    v_pk_max_i16 v190, v190, 0
    v_pk_max_i16 v191, v191, 0
    v_mfma_f32_16x16x32_bf16 v[184:187], v[212:215], v[72:75], v[184:187]
    ds_read_b128 v[212:215], v1 offset:17408
    s_waitcnt lgkmcnt(3)
    v_mfma_f32_16x16x32_bf16 v[180:183], v[216:219], v[76:79], v[180:183]
    s_add_u32 s12, s24, 4096
    buffer_store_dwordx4 v[188:191], v1, s[40:43], s12 offen offset:0 sc1
    v_mfma_f32_16x16x32_bf16 v[184:187], v[216:219], v[80:83], v[184:187]
    ds_read_b128 v[216:219], v1 offset:21504
    v_pk_max_i16 v192, v192, 0
    v_mfma_f32_16x16x32_bf16 v[180:183], v[220:223], v[84:87], v[180:183]
    buffer_load_dwordx4 a[236:239], v231, s[40:43], s100 offen offset:0
    v_mfma_f32_16x16x32_bf16 v[184:187], v[220:223], v[88:91], v[184:187]
    ds_read_b128 v[220:223], v1 offset:25600
    v_pk_max_i16 v193, v193, 0
    s_waitcnt lgkmcnt(3)
    v_mfma_f32_16x16x32_bf16 v[180:183], v[204:207], v[92:95], v[180:183]
    v_pk_max_i16 v194, v194, 0
    v_pk_max_i16 v195, v195, 0
    v_mfma_f32_16x16x32_bf16 v[184:187], v[204:207], v[96:99], v[184:187]
    ds_read_b128 v[204:207], v1 offset:29696
    v_mfma_f32_16x16x32_bf16 v[180:183], v[208:211], v[100:103], v[180:183]
    s_add_u32 s12, s24, 4096
    buffer_store_dwordx4 v[192:195], v1, s[40:43], s12 offen offset:1024 sc1
    v_mfma_f32_16x16x32_bf16 v[184:187], v[208:211], v[104:107], v[184:187]
    ds_read_b128 v[208:211], v1 offset:33792
    s_waitcnt lgkmcnt(3)
    v_mfma_f32_16x16x32_bf16 v[180:183], v[212:215], v[108:111], v[180:183]
    s_bfe_u32 s100, s71, 0x80000
    s_mul_i32 s100, s100, 40960
    buffer_load_dwordx4 a[240:243], v230, s[40:43], s100 offen offset:0
    v_mfma_f32_16x16x32_bf16 v[184:187], v[212:215], v[112:115], v[184:187]
    ds_read_b128 v[212:215], v11 offset:21504
    v_mfma_f32_16x16x32_bf16 v[180:183], v[216:219], v[116:119], v[180:183]
    v_mfma_f32_16x16x32_bf16 v[184:187], v[216:219], v[120:123], v[184:187]
    ds_read_b128 v[216:219], v11 offset:25600
    s_waitcnt lgkmcnt(3)
    v_mfma_f32_16x16x32_bf16 v[180:183], v[220:223], v[124:127], v[180:183]
    v_mfma_f32_16x16x32_bf16 v[184:187], v[220:223], v[128:131], v[184:187]
    ds_read_b128 v[220:223], v11 offset:29696
    v_mfma_f32_16x16x32_bf16 v[180:183], v[204:207], v[132:135], v[180:183]
    v_mfma_f32_16x16x32_bf16 v[184:187], v[204:207], v[136:139], v[184:187]
    ds_read_b128 v[204:207], v10 offset:55296
    s_waitcnt lgkmcnt(4)
    v_mfma_f32_16x16x32_bf16 v[180:183], v[208:211], v[140:143], v[180:183]
    buffer_load_dwordx4 a[244:247], v230, s[40:43], s100 offen offset:1024
    v_mfma_f32_16x16x32_bf16 v[184:187], v[208:211], v[144:147], v[184:187]
    ds_read_b128 v[208:211], v10 offset:56320
    s_waitcnt lgkmcnt(4)
    v_mfma_f32_16x16x32_bf16 v[180:183], v[212:215], v[148:151], v[180:183]
    v_mfma_f32_16x16x32_bf16 v[184:187], v[212:215], v[152:155], v[184:187]
    ds_read_b128 v[212:215], v10 offset:59392
    s_waitcnt lgkmcnt(4)
    v_mfma_f32_16x16x32_bf16 v[180:183], v[216:219], v[156:159], v[180:183]
    v_mfma_f32_16x16x32_bf16 v[184:187], v[216:219], v[160:163], v[184:187]
    ds_read_b128 v[216:219], v10 offset:60416
    s_waitcnt lgkmcnt(4)
    v_mfma_f32_16x16x32_bf16 v[180:183], v[220:223], v[164:167], v[180:183]
    v_mfma_f32_16x16x32_bf16 v[184:187], v[220:223], v[168:171], v[184:187]
    ds_read_b128 v[220:223], v10 offset:63488
    s_waitcnt lgkmcnt(4)
    v_mfma_f32_16x16x32_bf16 v[172:175], v[204:207], v[12:15], 0
    buffer_load_dwordx4 a[248:251], v230, s[40:43], s100 offen offset:2048
    v_mfma_f32_16x16x32_bf16 v[176:179], v[204:207], v[16:19], 0
    ds_read_b128 v[204:207], v10 offset:64512
    s_waitcnt lgkmcnt(4)
    v_mfma_f32_16x16x32_bf16 v[188:191], v[208:211], v[12:15], 0
    v_mfma_f32_16x16x32_bf16 v[192:195], v[208:211], v[16:19], 0
    ds_read_b128 v[208:211], v11 offset:2048
    v_cvt_pk_bf16_f32 v196, v248, v249
    s_waitcnt lgkmcnt(3)
    v_mfma_f32_16x16x32_bf16 v[172:175], v[212:215], v[20:23], v[172:175]
    v_cvt_pk_bf16_f32 v197, v250, v251
    v_cvt_pk_bf16_f32 v198, v180, v181
    v_mfma_f32_16x16x32_bf16 v[176:179], v[212:215], v[24:27], v[176:179]
    ds_read_b128 v[212:215], v11 offset:3072
    v_cvt_pk_bf16_f32 v199, v182, v183
    v_mfma_f32_16x16x32_bf16 v[188:191], v[216:219], v[20:23], v[188:191]
    buffer_load_dwordx4 a[252:255], v230, s[40:43], s100 offen offset:3072
    v_mfma_f32_16x16x32_bf16 v[192:195], v[216:219], v[24:27], v[192:195]
    ds_read_b128 v[216:219], v11 offset:6144
    v_cvt_pk_bf16_f32 v200, v252, v253
    s_waitcnt lgkmcnt(3)
    v_mfma_f32_16x16x32_bf16 v[172:175], v[220:223], v[28:31], v[172:175]
    v_cvt_pk_bf16_f32 v201, v254, v255
    v_cvt_pk_bf16_f32 v202, v184, v185
    v_mfma_f32_16x16x32_bf16 v[176:179], v[220:223], v[32:35], v[176:179]
    ds_read_b128 v[220:223], v11 offset:7168
    v_cvt_pk_bf16_f32 v203, v186, v187
    v_mfma_f32_16x16x32_bf16 v[188:191], v[204:207], v[28:31], v[188:191]
    v_pk_max_i16 v196, v196, 0
    v_pk_max_i16 v197, v197, 0
    v_mfma_f32_16x16x32_bf16 v[192:195], v[204:207], v[32:35], v[192:195]
    ds_read_b128 v[204:207], v11 offset:10240
    v_pk_max_i16 v198, v198, 0
    s_waitcnt lgkmcnt(3)
    v_mfma_f32_16x16x32_bf16 v[172:175], v[208:211], v[36:39], v[172:175]
    buffer_load_dwordx4 v[232:235], v231, s[40:43], s100 offen offset:0
    v_mfma_f32_16x16x32_bf16 v[176:179], v[208:211], v[40:43], v[176:179]
    ds_read_b128 v[208:211], v11 offset:11264
    v_pk_max_i16 v199, v199, 0
    v_mfma_f32_16x16x32_bf16 v[188:191], v[212:215], v[36:39], v[188:191]
    s_add_u32 s12, s24, 8192
    buffer_store_dwordx4 v[196:199], v3, s[40:43], s12 offen offset:0 sc1
    v_mfma_f32_16x16x32_bf16 v[192:195], v[212:215], v[40:43], v[192:195]
    ds_read_b128 v[212:215], v11 offset:14336
    v_pk_max_i16 v200, v200, 0
    s_waitcnt lgkmcnt(3)
    v_mfma_f32_16x16x32_bf16 v[172:175], v[216:219], v[44:47], v[172:175]
    v_pk_max_i16 v201, v201, 0
    v_pk_max_i16 v202, v202, 0
    v_mfma_f32_16x16x32_bf16 v[176:179], v[216:219], v[48:51], v[176:179]
    ds_read_b128 v[216:219], v11 offset:15360
    v_pk_max_i16 v203, v203, 0
    v_mfma_f32_16x16x32_bf16 v[188:191], v[220:223], v[44:47], v[188:191]
    s_add_u32 s12, s24, 8192
    buffer_store_dwordx4 v[200:203], v3, s[40:43], s12 offen offset:1024 sc1
    v_mfma_f32_16x16x32_bf16 v[192:195], v[220:223], v[48:51], v[192:195]
    ds_read_b128 v[220:223], v11 offset:18432
    s_waitcnt lgkmcnt(3)
    v_mfma_f32_16x16x32_bf16 v[172:175], v[204:207], v[52:55], v[172:175]
    s_bfe_u32 s100, s71, 0x80008
    s_mul_i32 s100, s100, 40960
    buffer_load_dwordx4 v[236:239], v230, s[40:43], s100 offen offset:0
    v_mfma_f32_16x16x32_bf16 v[176:179], v[204:207], v[56:59], v[176:179]
    ds_read_b128 v[204:207], v11 offset:19456
    v_mfma_f32_16x16x32_bf16 v[188:191], v[208:211], v[52:55], v[188:191]
    v_mfma_f32_16x16x32_bf16 v[192:195], v[208:211], v[56:59], v[192:195]
    ds_read_b128 v[208:211], v1 offset:2048
    s_waitcnt lgkmcnt(3)
    v_mfma_f32_16x16x32_bf16 v[172:175], v[212:215], v[60:63], v[172:175]
    v_mfma_f32_16x16x32_bf16 v[176:179], v[212:215], v[64:67], v[176:179]
    ds_read_b128 v[212:215], v1 offset:3072
    v_mfma_f32_16x16x32_bf16 v[188:191], v[216:219], v[60:63], v[188:191]
    v_mfma_f32_16x16x32_bf16 v[192:195], v[216:219], v[64:67], v[192:195]
    ds_read_b128 v[216:219], v1 offset:6144
    s_waitcnt lgkmcnt(4)
    v_mfma_f32_16x16x32_bf16 v[172:175], v[220:223], v[68:71], v[172:175]
    buffer_load_dwordx4 v[240:243], v230, s[40:43], s100 offen offset:1024
    v_mfma_f32_16x16x32_bf16 v[176:179], v[220:223], v[72:75], v[176:179]
    ds_read_b128 v[220:223], v1 offset:7168
    s_waitcnt lgkmcnt(4)
    v_mfma_f32_16x16x32_bf16 v[188:191], v[204:207], v[68:71], v[188:191]
    v_mfma_f32_16x16x32_bf16 v[192:195], v[204:207], v[72:75], v[192:195]
    ds_read_b128 v[204:207], v1 offset:10240
    s_waitcnt lgkmcnt(4)
    v_mfma_f32_16x16x32_bf16 v[172:175], v[208:211], v[76:79], v[172:175]
    v_mfma_f32_16x16x32_bf16 v[176:179], v[208:211], v[80:83], v[176:179]
    ds_read_b128 v[208:211], v1 offset:11264
    s_waitcnt lgkmcnt(4)
    v_mfma_f32_16x16x32_bf16 v[188:191], v[212:215], v[76:79], v[188:191]
    v_mfma_f32_16x16x32_bf16 v[192:195], v[212:215], v[80:83], v[192:195]
    ds_read_b128 v[212:215], v1 offset:14336
    s_waitcnt lgkmcnt(4)
    v_mfma_f32_16x16x32_bf16 v[172:175], v[216:219], v[84:87], v[172:175]
    buffer_load_dwordx4 v[244:247], v230, s[40:43], s100 offen offset:2048
    v_mfma_f32_16x16x32_bf16 v[176:179], v[216:219], v[88:91], v[176:179]
    ds_read_b128 v[216:219], v1 offset:15360
    s_waitcnt lgkmcnt(4)
    v_mfma_f32_16x16x32_bf16 v[188:191], v[220:223], v[84:87], v[188:191]
    s_bfe_u32 s10, s68, 0x80000
    s_lshl_b32 s10, s10, 12
    s_add_u32 s10, s10, s9
    buffer_load_dwordx4 v[12:15], v4, s[40:43], s10 offen sc1
    v_mfma_f32_16x16x32_bf16 v[192:195], v[220:223], v[88:91], v[192:195]
    ds_read_b128 v[220:223], v1 offset:18432
    s_waitcnt lgkmcnt(3)
    v_mfma_f32_16x16x32_bf16 v[172:175], v[204:207], v[92:95], v[172:175]
    v_mfma_f32_16x16x32_bf16 v[176:179], v[204:207], v[96:99], v[176:179]
    ds_read_b128 v[204:207], v1 offset:19456
    v_mfma_f32_16x16x32_bf16 v[188:191], v[208:211], v[92:95], v[188:191]
    buffer_load_dwordx4 v[248:251], v230, s[40:43], s100 offen offset:3072
    v_mfma_f32_16x16x32_bf16 v[192:195], v[208:211], v[96:99], v[192:195]
    ds_read_b128 v[208:211], v1 offset:22528
    s_waitcnt lgkmcnt(3)
    v_mfma_f32_16x16x32_bf16 v[172:175], v[212:215], v[100:103], v[172:175]
    buffer_load_dwordx4 v[16:19], v5, s[40:43], s10 offen sc1
    v_mfma_f32_16x16x32_bf16 v[176:179], v[212:215], v[104:107], v[176:179]
    ds_read_b128 v[212:215], v1 offset:23552
    v_mfma_f32_16x16x32_bf16 v[188:191], v[216:219], v[100:103], v[188:191]
    v_mfma_f32_16x16x32_bf16 v[192:195], v[216:219], v[104:107], v[192:195]
    ds_read_b128 v[216:219], v1 offset:26624
    s_waitcnt lgkmcnt(4)
    v_mfma_f32_16x16x32_bf16 v[172:175], v[220:223], v[108:111], v[172:175]
    buffer_load_dwordx4 v[20:23], v6, s[40:43], s10 offen sc1
    v_mfma_f32_16x16x32_bf16 v[176:179], v[220:223], v[112:115], v[176:179]
    ds_read_b128 v[220:223], v1 offset:27648
    s_waitcnt lgkmcnt(4)
    v_mfma_f32_16x16x32_bf16 v[188:191], v[204:207], v[108:111], v[188:191]
    buffer_load_dwordx4 v[252:255], v231, s[40:43], s100 offen offset:0
    v_mfma_f32_16x16x32_bf16 v[192:195], v[204:207], v[112:115], v[192:195]
    ds_read_b128 v[204:207], v1 offset:30720
    s_waitcnt lgkmcnt(4)
    v_mfma_f32_16x16x32_bf16 v[172:175], v[208:211], v[116:119], v[172:175]
    buffer_load_dwordx4 v[24:27], v7, s[40:43], s10 offen sc1
    v_mfma_f32_16x16x32_bf16 v[176:179], v[208:211], v[120:123], v[176:179]
    ds_read_b128 v[208:211], v1 offset:31744
    s_waitcnt lgkmcnt(4)
    v_mfma_f32_16x16x32_bf16 v[188:191], v[212:215], v[116:119], v[188:191]
    v_mfma_f32_16x16x32_bf16 v[192:195], v[212:215], v[120:123], v[192:195]
    ds_read_b128 v[212:215], v1 offset:34816
    s_waitcnt lgkmcnt(4)
    v_mfma_f32_16x16x32_bf16 v[172:175], v[216:219], v[124:127], v[172:175]
    s_bfe_u32 s10, s68, 0x80008
    s_lshl_b32 s10, s10, 12
    s_add_u32 s10, s10, s9
    buffer_load_dwordx4 v[28:31], v4, s[40:43], s10 offen sc1
    v_mfma_f32_16x16x32_bf16 v[176:179], v[216:219], v[128:131], v[176:179]
    ds_read_b128 v[216:219], v1 offset:35840
    s_waitcnt lgkmcnt(3)
    v_mfma_f32_16x16x32_bf16 v[188:191], v[220:223], v[124:127], v[188:191]
    v_mfma_f32_16x16x32_bf16 v[192:195], v[220:223], v[128:131], v[192:195]
    ds_read_b128 v[220:223], v11 offset:22528
    v_mfma_f32_16x16x32_bf16 v[172:175], v[204:207], v[132:135], v[172:175]
    buffer_load_dwordx4 v[32:35], v5, s[40:43], s10 offen sc1
    v_mfma_f32_16x16x32_bf16 v[176:179], v[204:207], v[136:139], v[176:179]
    ds_read_b128 v[204:207], v11 offset:23552
    s_waitcnt lgkmcnt(3)
    v_mfma_f32_16x16x32_bf16 v[188:191], v[208:211], v[132:135], v[188:191]
    v_mfma_f32_16x16x32_bf16 v[192:195], v[208:211], v[136:139], v[192:195]
    ds_read_b128 v[208:211], v11 offset:26624
    v_mfma_f32_16x16x32_bf16 v[172:175], v[212:215], v[140:143], v[172:175]
    buffer_load_dwordx4 v[36:39], v6, s[40:43], s10 offen sc1
    v_mfma_f32_16x16x32_bf16 v[176:179], v[212:215], v[144:147], v[176:179]
    ds_read_b128 v[212:215], v11 offset:27648
    s_waitcnt lgkmcnt(4)
    v_mfma_f32_16x16x32_bf16 v[188:191], v[216:219], v[140:143], v[188:191]
    v_mfma_f32_16x16x32_bf16 v[192:195], v[216:219], v[144:147], v[192:195]
    ds_read_b128 v[216:219], v11 offset:30720
    s_waitcnt lgkmcnt(4)
    v_mfma_f32_16x16x32_bf16 v[172:175], v[220:223], v[148:151], v[172:175]
    buffer_load_dwordx4 v[40:43], v7, s[40:43], s10 offen sc1
    v_mfma_f32_16x16x32_bf16 v[176:179], v[220:223], v[152:155], v[176:179]
    ds_read_b128 v[220:223], v11 offset:31744
    s_waitcnt lgkmcnt(4)
    v_mfma_f32_16x16x32_bf16 v[188:191], v[204:207], v[148:151], v[188:191]
    v_mfma_f32_16x16x32_bf16 v[192:195], v[204:207], v[152:155], v[192:195]
    s_bfe_u32 s10, s68, 0x80010
    s_lshl_b32 s10, s10, 12
    s_add_u32 s10, s10, s9
    buffer_load_dwordx4 v[44:47], v4, s[40:43], s10 offen sc1
    s_waitcnt lgkmcnt(2)
    v_mfma_f32_16x16x32_bf16 v[172:175], v[208:211], v[156:159], v[172:175]
    v_mfma_f32_16x16x32_bf16 v[176:179], v[208:211], v[160:163], v[176:179]
    v_mfma_f32_16x16x32_bf16 v[188:191], v[212:215], v[156:159], v[188:191]
    buffer_load_dwordx4 v[48:51], v5, s[40:43], s10 offen sc1
    v_mfma_f32_16x16x32_bf16 v[192:195], v[212:215], v[160:163], v[192:195]
    s_waitcnt lgkmcnt(0)
    v_mfma_f32_16x16x32_bf16 v[172:175], v[216:219], v[164:167], v[172:175]
    v_mfma_f32_16x16x32_bf16 v[176:179], v[216:219], v[168:171], v[176:179]
    buffer_load_dwordx4 v[52:55], v6, s[40:43], s10 offen sc1
    v_mfma_f32_16x16x32_bf16 v[188:191], v[220:223], v[164:167], v[188:191]
    v_mfma_f32_16x16x32_bf16 v[192:195], v[220:223], v[168:171], v[192:195]
    s_nop 3
    v_cvt_pk_bf16_f32 v172, v172, v173
    v_cvt_pk_bf16_f32 v173, v174, v175
    s_nop 0
    v_cvt_pk_bf16_f32 v174, v188, v189
    v_cvt_pk_bf16_f32 v175, v190, v191
    v_cvt_pk_bf16_f32 v176, v176, v177
    v_cvt_pk_bf16_f32 v177, v178, v179
    v_cvt_pk_bf16_f32 v178, v192, v193
    v_cvt_pk_bf16_f32 v179, v194, v195
    v_pk_max_i16 v172, v172, 0
    v_pk_max_i16 v173, v173, 0
    v_pk_max_i16 v174, v174, 0
    v_pk_max_i16 v175, v175, 0
    s_add_u32 s12, s24, 12288
    buffer_store_dwordx4 v[172:175], v3, s[40:43], s12 offen offset:0 sc1
    v_pk_max_i16 v176, v176, 0
    v_pk_max_i16 v177, v177, 0
    v_pk_max_i16 v178, v178, 0
    v_pk_max_i16 v179, v179, 0
    s_add_u32 s12, s24, 12288
    buffer_store_dwordx4 v[176:179], v3, s[40:43], s12 offen offset:1024 sc1
    buffer_load_dwordx4 v[56:59], v7, s[40:43], s10 offen sc1
    s_branch L_g2
L_idle:
    buffer_load_dwordx4 a[224:227], v230, s[40:43], s100 offen offset:1024
    buffer_load_dwordx4 a[228:231], v230, s[40:43], s100 offen offset:2048
    buffer_load_dwordx4 a[232:235], v230, s[40:43], s100 offen offset:3072
    buffer_load_dwordx4 a[236:239], v231, s[40:43], s100 offen offset:0
    s_bfe_u32 s100, s71, 0x80000
    s_mul_i32 s100, s100, 40960
    buffer_load_dwordx4 a[240:243], v230, s[40:43], s100 offen offset:0
    buffer_load_dwordx4 a[244:247], v230, s[40:43], s100 offen offset:1024
    buffer_load_dwordx4 a[248:251], v230, s[40:43], s100 offen offset:2048
    buffer_load_dwordx4 a[252:255], v230, s[40:43], s100 offen offset:3072
    buffer_load_dwordx4 v[232:235], v231, s[40:43], s100 offen offset:0
    s_bfe_u32 s100, s71, 0x80008
    s_mul_i32 s100, s100, 40960
    buffer_load_dwordx4 v[236:239], v230, s[40:43], s100 offen offset:0
    buffer_load_dwordx4 v[240:243], v230, s[40:43], s100 offen offset:1024
    buffer_load_dwordx4 v[244:247], v230, s[40:43], s100 offen offset:2048
    buffer_load_dwordx4 v[248:251], v230, s[40:43], s100 offen offset:3072
    buffer_load_dwordx4 v[252:255], v231, s[40:43], s100 offen offset:0
    s_waitcnt vmcnt(0)
    s_barrier
    s_bfe_u32 s10, s69, 0x80010
    s_lshl_b32 s10, s10, 12
    s_add_u32 s10, s10, s9
    v_lshlrev_b32 v204, 6, v2
L_p2_loop:
    buffer_load_dword v205, v204, s[40:43], s10 offen offset:60 sc1
    s_waitcnt vmcnt(0)
    v_cmp_lt_u32 vcc, s28, v205
    s_cbranch_vccz L_p2_done
    s_add_u32 s15, s15, 1
    s_cmp_gt_u32 s15, 65536
    s_cselect_b32 s28, -1, s28
    s_mov_b64 exec, vcc
    s_branch L_p2_loop
L_p2_done:
    s_mov_b64 exec, -1
    s_bfe_u32 s10, s68, 0x80000
    s_lshl_b32 s10, s10, 12
    s_add_u32 s10, s10, s9
    buffer_load_dwordx4 v[12:15], v4, s[40:43], s10 offen sc1
    buffer_load_dwordx4 v[16:19], v5, s[40:43], s10 offen sc1
    buffer_load_dwordx4 v[20:23], v6, s[40:43], s10 offen sc1
    buffer_load_dwordx4 v[24:27], v7, s[40:43], s10 offen sc1
    s_bfe_u32 s10, s68, 0x80008
    s_lshl_b32 s10, s10, 12
    s_add_u32 s10, s10, s9
    buffer_load_dwordx4 v[28:31], v4, s[40:43], s10 offen sc1
    buffer_load_dwordx4 v[32:35], v5, s[40:43], s10 offen sc1
    buffer_load_dwordx4 v[36:39], v6, s[40:43], s10 offen sc1
    buffer_load_dwordx4 v[40:43], v7, s[40:43], s10 offen sc1
    s_bfe_u32 s10, s68, 0x80010
    s_lshl_b32 s10, s10, 12
    s_add_u32 s10, s10, s9
    buffer_load_dwordx4 v[44:47], v4, s[40:43], s10 offen sc1
    buffer_load_dwordx4 v[48:51], v5, s[40:43], s10 offen sc1
    buffer_load_dwordx4 v[52:55], v6, s[40:43], s10 offen sc1
    buffer_load_dwordx4 v[56:59], v7, s[40:43], s10 offen sc1
    s_waitcnt vmcnt(0)
L_g2:
    v_lshrrev_b32 v2, 4, v1
    s_cmp_eq_u32 s3, 3
    s_cselect_b32 s7, 0x70000000, 0
    v_add_u32 v224, s7, v4
    v_add_u32 v225, s7, v5
    v_add_u32 v226, s7, v6
    v_add_u32 v227, s7, v7
    s_waitcnt vmcnt(10)
    v_max3_u32 v208, v12, v16, v20
    v_max_u32 v208, v208, v24
    v_cmp_lt_u32 vcc, s28, v208
    s_cbranch_vccnz L_fx0
L_s0:
    v_mfma_f32_16x16x32_bf16 v[124:127], a[0:3], v[12:15], 0
    s_bfe_u32 s10, s68, 0x80018
    s_lshl_b32 s10, s10, 12
    s_add_u32 s10, s10, s9
    buffer_load_dwordx4 v[60:63], v4, s[40:43], s10 offen sc1
    v_mfma_f32_16x16x32_bf16 v[128:131], a[0:3], v[16:19], 0
    v_mfma_f32_16x16x32_bf16 v[132:135], a[0:3], v[20:23], 0
    v_mfma_f32_16x16x32_bf16 v[136:139], a[0:3], v[24:27], 0
    v_mfma_f32_16x16x32_bf16 v[140:143], a[4:7], v[12:15], 0
    buffer_load_dwordx4 v[64:67], v5, s[40:43], s10 offen sc1
    v_mfma_f32_16x16x32_bf16 v[144:147], a[4:7], v[16:19], 0
    v_mfma_f32_16x16x32_bf16 v[148:151], a[4:7], v[20:23], 0
    v_mfma_f32_16x16x32_bf16 v[152:155], a[4:7], v[24:27], 0
    v_mfma_f32_16x16x32_bf16 v[156:159], a[8:11], v[12:15], 0
    buffer_load_dwordx4 v[68:71], v6, s[40:43], s10 offen sc1
    v_mfma_f32_16x16x32_bf16 v[160:163], a[8:11], v[16:19], 0
    s_waitcnt vmcnt(9)
    v_max3_u32 v208, v28, v32, v36
    v_mfma_f32_16x16x32_bf16 v[164:167], a[8:11], v[20:23], 0
    v_max_u32 v208, v208, v40
    v_mfma_f32_16x16x32_bf16 v[168:171], a[8:11], v[24:27], 0
    v_cmp_lt_u32 vcc, s28, v208
    v_mfma_f32_16x16x32_bf16 v[172:175], a[12:15], v[12:15], 0
    v_mfma_f32_16x16x32_bf16 v[176:179], a[12:15], v[16:19], 0
    buffer_load_dwordx4 v[72:75], v7, s[40:43], s10 offen sc1
    v_mfma_f32_16x16x32_bf16 v[180:183], a[12:15], v[20:23], 0
    v_mfma_f32_16x16x32_bf16 v[184:187], a[12:15], v[24:27], 0
    v_mfma_f32_16x16x32_bf16 v[188:191], a[16:19], v[12:15], 0
    v_mfma_f32_16x16x32_bf16 v[192:195], a[16:19], v[16:19], 0
    v_mfma_f32_16x16x32_bf16 v[196:199], a[16:19], v[20:23], 0
    v_mfma_f32_16x16x32_bf16 v[200:203], a[16:19], v[24:27], 0
    s_cbranch_vccnz L_fx1
L_s1:
    v_mfma_f32_16x16x32_bf16 v[124:127], a[20:23], v[28:31], v[124:127]
    s_bfe_u32 s10, s69, 0x80000
    s_lshl_b32 s10, s10, 12
    s_add_u32 s10, s10, s9
    buffer_load_dwordx4 v[76:79], v4, s[40:43], s10 offen sc1
    s_add_u32 s6, s3, 1
    s_and_b32 s6, s6, 3
    s_mul_i32 s6, s6, 15360
    s_add_u32 s6, s6, 0
    v_add_u32 v9, s6, v1
    v_mfma_f32_16x16x32_bf16 v[128:131], a[20:23], v[32:35], v[128:131]
    s_add_u32 s6, s3, 2
    s_and_b32 s6, s6, 3
    s_mul_i32 s6, s6, 15360
    s_add_u32 s6, s6, 5120
    v_add_u32 v10, s6, v1
    v_mfma_f32_16x16x32_bf16 v[132:135], a[20:23], v[36:39], v[132:135]
    s_add_u32 s6, s3, 3
    s_and_b32 s6, s6, 3
    s_mul_i32 s6, s6, 15360
    s_add_u32 s6, s6, 10240
    v_add_u32 v11, s6, v1
    v_mfma_f32_16x16x32_bf16 v[136:139], a[20:23], v[40:43], v[136:139]
    s_mul_i32 s6, s3, 15360
    v_add_u32 v8, s6, v1
    v_mfma_f32_16x16x32_bf16 v[140:143], a[24:27], v[28:31], v[140:143]
    buffer_load_dwordx4 v[80:83], v5, s[40:43], s10 offen sc1
    v_lshrrev_b32 v210, 4, v2
    v_mfma_f32_16x16x32_bf16 v[144:147], a[24:27], v[32:35], v[144:147]
    v_and_b32 v211, 15, v2
    v_mfma_f32_16x16x32_bf16 v[148:151], a[24:27], v[36:39], v[148:151]
    v_and_b32 v3, 3, v211
    v_mfma_f32_16x16x32_bf16 v[152:155], a[24:27], v[40:43], v[152:155]
    v_lshlrev_b32 v3, 1, v3
    v_mfma_f32_16x16x32_bf16 v[156:159], a[28:31], v[28:31], v[156:159]
    buffer_load_dwordx4 v[84:87], v6, s[40:43], s10 offen sc1
    v_bfe_u32 v212, v211, 2, 1
    v_mfma_f32_16x16x32_bf16 v[160:163], a[28:31], v[32:35], v[160:163]
    s_waitcnt vmcnt(7)
    v_max3_u32 v208, v44, v48, v52
    v_mfma_f32_16x16x32_bf16 v[164:167], a[28:31], v[36:39], v[164:167]
    v_max_u32 v208, v208, v56
    v_mfma_f32_16x16x32_bf16 v[168:171], a[28:31], v[40:43], v[168:171]
    v_cmp_lt_u32 vcc, s28, v208
    v_mfma_f32_16x16x32_bf16 v[172:175], a[32:35], v[28:31], v[172:175]
    v_mfma_f32_16x16x32_bf16 v[176:179], a[32:35], v[32:35], v[176:179]
    buffer_load_dwordx4 v[88:91], v7, s[40:43], s10 offen sc1
    v_mfma_f32_16x16x32_bf16 v[180:183], a[32:35], v[36:39], v[180:183]
    v_mfma_f32_16x16x32_bf16 v[184:187], a[32:35], v[40:43], v[184:187]
    v_mfma_f32_16x16x32_bf16 v[188:191], a[36:39], v[28:31], v[188:191]
    v_mfma_f32_16x16x32_bf16 v[192:195], a[36:39], v[32:35], v[192:195]
    v_mfma_f32_16x16x32_bf16 v[196:199], a[36:39], v[36:39], v[196:199]
    v_mfma_f32_16x16x32_bf16 v[200:203], a[36:39], v[40:43], v[200:203]
    s_cbranch_vccnz L_fx2
L_s2:
    v_mfma_f32_16x16x32_bf16 v[124:127], a[40:43], v[44:47], v[124:127]
    s_bfe_u32 s10, s69, 0x80008
    s_lshl_b32 s10, s10, 12
    s_add_u32 s10, s10, s9
    buffer_load_dwordx4 v[92:95], v4, s[40:43], s10 offen sc1
    v_add_u32 v3, v3, v212
    v_mfma_f32_16x16x32_bf16 v[128:131], a[40:43], v[48:51], v[128:131]
    v_and_b32 v212, 8, v211
    v_mfma_f32_16x16x32_bf16 v[132:135], a[40:43], v[52:55], v[132:135]
    v_add_u32 v3, v3, v212
    v_mfma_f32_16x16x32_bf16 v[136:139], a[40:43], v[56:59], v[136:139]
    v_mul_u32_u24 v3, 1280, v3
    v_mfma_f32_16x16x32_bf16 v[140:143], a[44:47], v[44:47], v[140:143]
    buffer_load_dwordx4 v[96:99], v5, s[40:43], s10 offen sc1
    v_lshl_add_u32 v3, v210, 3, v3
    v_mfma_f32_16x16x32_bf16 v[144:147], a[44:47], v[48:51], v[144:147]
    v_lshlrev_b32 v213, 4, v210
    v_mfma_f32_16x16x32_bf16 v[148:151], a[44:47], v[52:55], v[148:151]
    s_lshl_b32 s11, s27, 6
    s_lshl_b32 s12, s3, 4
    s_add_u32 s11, s11, s12
    s_mul_i32 s11, s11, 1280
    s_mul_i32 s12, s26, 160
    s_add_u32 s11, s11, s12
    s_lshl_b32 s14, s27, 2
    s_add_u32 s14, s14, s3
    s_mul_i32 s14, s14, 20480
    s_mul_i32 s12, s26, 2560
    s_add_u32 s14, s14, s12
    s_add_u32 s14, s14, 29360128
    v_lshlrev_b32 v211, 5, v211
    v_mfma_f32_16x16x32_bf16 v[152:155], a[44:47], v[56:59], v[152:155]
    v_lshl_add_u32 v2, v210, 3, v211
    v_mfma_f32_16x16x32_bf16 v[156:159], a[48:51], v[44:47], v[156:159]
    buffer_load_dwordx4 v[100:103], v6, s[40:43], s10 offen sc1
    s_mov_b32 s13, s18
    s_mov_b64 s[44:45], s[32:33]
    s_mov_b32 s46, 2621440
    s_mov_b32 s47, 0x00020000
    v_mfma_f32_16x16x32_bf16 v[160:163], a[48:51], v[48:51], v[160:163]
    s_waitcnt vmcnt(7)
    v_max3_u32 v208, v60, v64, v68
    v_mfma_f32_16x16x32_bf16 v[164:167], a[48:51], v[52:55], v[164:167]
    v_max_u32 v208, v208, v72
    v_mfma_f32_16x16x32_bf16 v[168:171], a[48:51], v[56:59], v[168:171]
    v_cmp_lt_u32 vcc, s28, v208
    v_mfma_f32_16x16x32_bf16 v[172:175], a[52:55], v[44:47], v[172:175]
    v_mfma_f32_16x16x32_bf16 v[176:179], a[52:55], v[48:51], v[176:179]
    buffer_load_dwordx4 v[104:107], v7, s[40:43], s10 offen sc1
    v_mfma_f32_16x16x32_bf16 v[180:183], a[52:55], v[52:55], v[180:183]
    v_mfma_f32_16x16x32_bf16 v[184:187], a[52:55], v[56:59], v[184:187]
    v_mfma_f32_16x16x32_bf16 v[188:191], a[56:59], v[44:47], v[188:191]
    v_mfma_f32_16x16x32_bf16 v[192:195], a[56:59], v[48:51], v[192:195]
    v_mfma_f32_16x16x32_bf16 v[196:199], a[56:59], v[52:55], v[196:199]
    v_mfma_f32_16x16x32_bf16 v[200:203], a[56:59], v[56:59], v[200:203]
    s_cbranch_vccnz L_fx3
L_s3:
    v_mfma_f32_16x16x32_bf16 v[124:127], a[60:63], v[60:63], v[124:127]
    s_bfe_u32 s10, s69, 0x80010
    s_lshl_b32 s10, s10, 12
    s_add_u32 s10, s10, s9
    buffer_load_dwordx4 v[108:111], v4, s[40:43], s10 offen sc1
    v_mfma_f32_16x16x32_bf16 v[128:131], a[60:63], v[64:67], v[128:131]
    v_mfma_f32_16x16x32_bf16 v[132:135], a[60:63], v[68:71], v[132:135]
    v_mfma_f32_16x16x32_bf16 v[136:139], a[60:63], v[72:75], v[136:139]
    v_mfma_f32_16x16x32_bf16 v[140:143], a[64:67], v[60:63], v[140:143]
    buffer_load_dwordx4 v[112:115], v5, s[40:43], s10 offen sc1
    v_mfma_f32_16x16x32_bf16 v[144:147], a[64:67], v[64:67], v[144:147]
    v_mfma_f32_16x16x32_bf16 v[148:151], a[64:67], v[68:71], v[148:151]
    v_mfma_f32_16x16x32_bf16 v[152:155], a[64:67], v[72:75], v[152:155]
    v_mfma_f32_16x16x32_bf16 v[156:159], a[68:71], v[60:63], v[156:159]
    buffer_load_dwordx4 v[116:119], v6, s[40:43], s10 offen sc1
    v_mfma_f32_16x16x32_bf16 v[160:163], a[68:71], v[64:67], v[160:163]
    s_waitcnt vmcnt(7)
    v_max3_u32 v208, v76, v80, v84
    v_mfma_f32_16x16x32_bf16 v[164:167], a[68:71], v[68:71], v[164:167]
    v_max_u32 v208, v208, v88
    v_mfma_f32_16x16x32_bf16 v[168:171], a[68:71], v[72:75], v[168:171]
    v_cmp_lt_u32 vcc, s28, v208
    v_mfma_f32_16x16x32_bf16 v[172:175], a[72:75], v[60:63], v[172:175]
    v_mfma_f32_16x16x32_bf16 v[176:179], a[72:75], v[64:67], v[176:179]
    buffer_load_dwordx4 v[120:123], v7, s[40:43], s10 offen sc1
    v_mfma_f32_16x16x32_bf16 v[180:183], a[72:75], v[68:71], v[180:183]
    v_mfma_f32_16x16x32_bf16 v[184:187], a[72:75], v[72:75], v[184:187]
    v_mfma_f32_16x16x32_bf16 v[188:191], a[76:79], v[60:63], v[188:191]
    v_mfma_f32_16x16x32_bf16 v[192:195], a[76:79], v[64:67], v[192:195]
    v_mfma_f32_16x16x32_bf16 v[196:199], a[76:79], v[68:71], v[196:199]
    v_mfma_f32_16x16x32_bf16 v[200:203], a[76:79], v[72:75], v[200:203]
    s_cbranch_vccnz L_fx4
L_s4:
    v_mfma_f32_16x16x32_bf16 v[124:127], a[80:83], v[76:79], v[124:127]
    s_bfe_u32 s10, s69, 0x80018
    s_lshl_b32 s10, s10, 12
    s_add_u32 s10, s10, s9
    buffer_load_dwordx4 v[12:15], v224, s[40:43], s10 offen sc1
    v_mfma_f32_16x16x32_bf16 v[128:131], a[80:83], v[80:83], v[128:131]
    v_mfma_f32_16x16x32_bf16 v[132:135], a[80:83], v[84:87], v[132:135]
    v_mfma_f32_16x16x32_bf16 v[136:139], a[80:83], v[88:91], v[136:139]
    v_mfma_f32_16x16x32_bf16 v[140:143], a[84:87], v[76:79], v[140:143]
    buffer_load_dwordx4 v[16:19], v225, s[40:43], s10 offen sc1
    v_mfma_f32_16x16x32_bf16 v[144:147], a[84:87], v[80:83], v[144:147]
    v_mfma_f32_16x16x32_bf16 v[148:151], a[84:87], v[84:87], v[148:151]
    v_mfma_f32_16x16x32_bf16 v[152:155], a[84:87], v[88:91], v[152:155]
    v_mfma_f32_16x16x32_bf16 v[156:159], a[88:91], v[76:79], v[156:159]
    buffer_load_dwordx4 v[20:23], v226, s[40:43], s10 offen sc1
    v_mfma_f32_16x16x32_bf16 v[160:163], a[88:91], v[80:83], v[160:163]
    s_waitcnt vmcnt(7)
    v_max3_u32 v208, v92, v96, v100
    v_mfma_f32_16x16x32_bf16 v[164:167], a[88:91], v[84:87], v[164:167]
    v_max_u32 v208, v208, v104
    v_mfma_f32_16x16x32_bf16 v[168:171], a[88:91], v[88:91], v[168:171]
    v_cmp_lt_u32 vcc, s28, v208
    v_mfma_f32_16x16x32_bf16 v[172:175], a[92:95], v[76:79], v[172:175]
    v_mfma_f32_16x16x32_bf16 v[176:179], a[92:95], v[80:83], v[176:179]
    buffer_load_dwordx4 v[24:27], v227, s[40:43], s10 offen sc1
    v_mfma_f32_16x16x32_bf16 v[180:183], a[92:95], v[84:87], v[180:183]
    v_mfma_f32_16x16x32_bf16 v[184:187], a[92:95], v[88:91], v[184:187]
    v_mfma_f32_16x16x32_bf16 v[188:191], a[96:99], v[76:79], v[188:191]
    v_mfma_f32_16x16x32_bf16 v[192:195], a[96:99], v[80:83], v[192:195]
    v_mfma_f32_16x16x32_bf16 v[196:199], a[96:99], v[84:87], v[196:199]
    v_mfma_f32_16x16x32_bf16 v[200:203], a[96:99], v[88:91], v[200:203]
    s_cbranch_vccnz L_fx5
L_s5:
    s_barrier
    v_mfma_f32_16x16x32_bf16 v[124:127], a[100:103], v[92:95], v[124:127]
    s_bfe_u32 s10, s70, 0x80000
    s_lshl_b32 s10, s10, 12
    s_add_u32 s10, s10, s9
    buffer_load_dwordx4 v[28:31], v224, s[40:43], s10 offen sc1
    v_mfma_f32_16x16x32_bf16 v[128:131], a[100:103], v[96:99], v[128:131]
    v_mfma_f32_16x16x32_bf16 v[132:135], a[100:103], v[100:103], v[132:135]
    v_mfma_f32_16x16x32_bf16 v[136:139], a[100:103], v[104:107], v[136:139]
    v_mfma_f32_16x16x32_bf16 v[140:143], a[104:107], v[92:95], v[140:143]
    buffer_load_dwordx4 v[32:35], v225, s[40:43], s10 offen sc1
    v_mfma_f32_16x16x32_bf16 v[144:147], a[104:107], v[96:99], v[144:147]
    v_mfma_f32_16x16x32_bf16 v[148:151], a[104:107], v[100:103], v[148:151]
    v_mfma_f32_16x16x32_bf16 v[152:155], a[104:107], v[104:107], v[152:155]
    v_mfma_f32_16x16x32_bf16 v[156:159], a[108:111], v[92:95], v[156:159]
    buffer_load_dwordx4 v[36:39], v226, s[40:43], s10 offen sc1
    v_mfma_f32_16x16x32_bf16 v[160:163], a[108:111], v[96:99], v[160:163]
    s_waitcnt vmcnt(7)
    v_max3_u32 v208, v108, v112, v116
    v_mfma_f32_16x16x32_bf16 v[164:167], a[108:111], v[100:103], v[164:167]
    v_max_u32 v208, v208, v120
    v_mfma_f32_16x16x32_bf16 v[168:171], a[108:111], v[104:107], v[168:171]
    v_cmp_lt_u32 vcc, s28, v208
    v_mfma_f32_16x16x32_bf16 v[172:175], a[112:115], v[92:95], v[172:175]
    v_mfma_f32_16x16x32_bf16 v[176:179], a[112:115], v[96:99], v[176:179]
    buffer_load_dwordx4 v[40:43], v227, s[40:43], s10 offen sc1
    v_mfma_f32_16x16x32_bf16 v[180:183], a[112:115], v[100:103], v[180:183]
    v_mfma_f32_16x16x32_bf16 v[184:187], a[112:115], v[104:107], v[184:187]
    v_mfma_f32_16x16x32_bf16 v[188:191], a[116:119], v[92:95], v[188:191]
    v_mfma_f32_16x16x32_bf16 v[192:195], a[116:119], v[96:99], v[192:195]
    v_mfma_f32_16x16x32_bf16 v[196:199], a[116:119], v[100:103], v[196:199]
    v_mfma_f32_16x16x32_bf16 v[200:203], a[116:119], v[104:107], v[200:203]
    s_cbranch_vccnz L_fx6
L_s6:
    v_mfma_f32_16x16x32_bf16 v[124:127], a[120:123], v[108:111], v[124:127]
    s_bfe_u32 s10, s70, 0x80008
    s_lshl_b32 s10, s10, 12
    s_add_u32 s10, s10, s9
    buffer_load_dwordx4 v[44:47], v4, s[40:43], s10 offen sc1
    v_mfma_f32_16x16x32_bf16 v[128:131], a[120:123], v[112:115], v[128:131]
    v_mfma_f32_16x16x32_bf16 v[132:135], a[120:123], v[116:119], v[132:135]
    v_mfma_f32_16x16x32_bf16 v[136:139], a[120:123], v[120:123], v[136:139]
    v_mfma_f32_16x16x32_bf16 v[140:143], a[124:127], v[108:111], v[140:143]
    buffer_load_dwordx4 v[48:51], v5, s[40:43], s10 offen sc1
    v_mfma_f32_16x16x32_bf16 v[144:147], a[124:127], v[112:115], v[144:147]
    v_mfma_f32_16x16x32_bf16 v[148:151], a[124:127], v[116:119], v[148:151]
    v_mfma_f32_16x16x32_bf16 v[152:155], a[124:127], v[120:123], v[152:155]
    v_mfma_f32_16x16x32_bf16 v[156:159], a[128:131], v[108:111], v[156:159]
    buffer_load_dwordx4 v[52:55], v6, s[40:43], s10 offen sc1
    v_mfma_f32_16x16x32_bf16 v[160:163], a[128:131], v[112:115], v[160:163]
    s_waitcnt vmcnt(7)
    v_max3_u32 v208, v12, v16, v20
    v_mfma_f32_16x16x32_bf16 v[164:167], a[128:131], v[116:119], v[164:167]
    v_max_u32 v208, v208, v24
    v_mfma_f32_16x16x32_bf16 v[168:171], a[128:131], v[120:123], v[168:171]
    v_cmp_lt_u32 vcc, s28, v208
    v_mfma_f32_16x16x32_bf16 v[172:175], a[132:135], v[108:111], v[172:175]
    v_mfma_f32_16x16x32_bf16 v[176:179], a[132:135], v[112:115], v[176:179]
    buffer_load_dwordx4 v[56:59], v7, s[40:43], s10 offen sc1
    v_mfma_f32_16x16x32_bf16 v[180:183], a[132:135], v[116:119], v[180:183]
    v_mfma_f32_16x16x32_bf16 v[184:187], a[132:135], v[120:123], v[184:187]
    v_mfma_f32_16x16x32_bf16 v[188:191], a[136:139], v[108:111], v[188:191]
    v_mfma_f32_16x16x32_bf16 v[192:195], a[136:139], v[112:115], v[192:195]
    v_mfma_f32_16x16x32_bf16 v[196:199], a[136:139], v[116:119], v[196:199]
    v_mfma_f32_16x16x32_bf16 v[200:203], a[136:139], v[120:123], v[200:203]
    s_cbranch_vccnz L_fx7
L_s7:
    v_mfma_f32_16x16x32_bf16 v[124:127], a[140:143], v[12:15], v[124:127]
    s_bfe_u32 s10, s70, 0x80010
    s_lshl_b32 s10, s10, 12
    s_add_u32 s10, s10, s9
    buffer_load_dwordx4 v[60:63], v4, s[40:43], s10 offen sc1
    v_mfma_f32_16x16x32_bf16 v[128:131], a[140:143], v[16:19], v[128:131]
    v_mfma_f32_16x16x32_bf16 v[132:135], a[140:143], v[20:23], v[132:135]
    v_mfma_f32_16x16x32_bf16 v[136:139], a[140:143], v[24:27], v[136:139]
    v_mfma_f32_16x16x32_bf16 v[140:143], a[144:147], v[12:15], v[140:143]
    buffer_load_dwordx4 v[64:67], v5, s[40:43], s10 offen sc1
    v_mfma_f32_16x16x32_bf16 v[144:147], a[144:147], v[16:19], v[144:147]
    v_mfma_f32_16x16x32_bf16 v[148:151], a[144:147], v[20:23], v[148:151]
    v_mfma_f32_16x16x32_bf16 v[152:155], a[144:147], v[24:27], v[152:155]
    v_mfma_f32_16x16x32_bf16 v[156:159], a[148:151], v[12:15], v[156:159]
    buffer_load_dwordx4 v[68:71], v6, s[40:43], s10 offen sc1
    v_mfma_f32_16x16x32_bf16 v[160:163], a[148:151], v[16:19], v[160:163]
    s_waitcnt vmcnt(7)
    v_max3_u32 v208, v28, v32, v36
    v_mfma_f32_16x16x32_bf16 v[164:167], a[148:151], v[20:23], v[164:167]
    v_max_u32 v208, v208, v40
    v_mfma_f32_16x16x32_bf16 v[168:171], a[148:151], v[24:27], v[168:171]
    v_cmp_lt_u32 vcc, s28, v208
    v_mfma_f32_16x16x32_bf16 v[172:175], a[152:155], v[12:15], v[172:175]
    v_mfma_f32_16x16x32_bf16 v[176:179], a[152:155], v[16:19], v[176:179]
    buffer_load_dwordx4 v[72:75], v7, s[40:43], s10 offen sc1
    v_mfma_f32_16x16x32_bf16 v[180:183], a[152:155], v[20:23], v[180:183]
    v_mfma_f32_16x16x32_bf16 v[184:187], a[152:155], v[24:27], v[184:187]
    v_mfma_f32_16x16x32_bf16 v[188:191], a[156:159], v[12:15], v[188:191]
    v_mfma_f32_16x16x32_bf16 v[192:195], a[156:159], v[16:19], v[192:195]
    v_mfma_f32_16x16x32_bf16 v[196:199], a[156:159], v[20:23], v[196:199]
    v_mfma_f32_16x16x32_bf16 v[200:203], a[156:159], v[24:27], v[200:203]
    s_cbranch_vccnz L_fx8
L_s8:
    v_mfma_f32_16x16x32_bf16 v[124:127], a[160:163], v[28:31], v[124:127]
    s_bfe_u32 s10, s70, 0x80018
    s_lshl_b32 s10, s10, 12
    s_add_u32 s10, s10, s9
    buffer_load_dwordx4 v[76:79], v4, s[40:43], s10 offen sc1
    v_mfma_f32_16x16x32_bf16 v[128:131], a[160:163], v[32:35], v[128:131]
    v_mfma_f32_16x16x32_bf16 v[132:135], a[160:163], v[36:39], v[132:135]
    v_mfma_f32_16x16x32_bf16 v[136:139], a[160:163], v[40:43], v[136:139]
    v_mfma_f32_16x16x32_bf16 v[140:143], a[164:167], v[28:31], v[140:143]
    buffer_load_dwordx4 v[80:83], v5, s[40:43], s10 offen sc1
    v_mfma_f32_16x16x32_bf16 v[144:147], a[164:167], v[32:35], v[144:147]
    v_mfma_f32_16x16x32_bf16 v[148:151], a[164:167], v[36:39], v[148:151]
    v_mfma_f32_16x16x32_bf16 v[152:155], a[164:167], v[40:43], v[152:155]
    v_mfma_f32_16x16x32_bf16 v[156:159], a[168:171], v[28:31], v[156:159]
    buffer_load_dwordx4 v[84:87], v6, s[40:43], s10 offen sc1
    v_mfma_f32_16x16x32_bf16 v[160:163], a[168:171], v[32:35], v[160:163]
    s_waitcnt vmcnt(7)
    v_max3_u32 v208, v44, v48, v52
    v_mfma_f32_16x16x32_bf16 v[164:167], a[168:171], v[36:39], v[164:167]
    v_max_u32 v208, v208, v56
    v_mfma_f32_16x16x32_bf16 v[168:171], a[168:171], v[40:43], v[168:171]
    v_cmp_lt_u32 vcc, s28, v208
    v_mfma_f32_16x16x32_bf16 v[172:175], a[172:175], v[28:31], v[172:175]
    v_mfma_f32_16x16x32_bf16 v[176:179], a[172:175], v[32:35], v[176:179]
    buffer_load_dwordx4 v[88:91], v7, s[40:43], s10 offen sc1
    v_mfma_f32_16x16x32_bf16 v[180:183], a[172:175], v[36:39], v[180:183]
    v_mfma_f32_16x16x32_bf16 v[184:187], a[172:175], v[40:43], v[184:187]
    v_mfma_f32_16x16x32_bf16 v[188:191], a[176:179], v[28:31], v[188:191]
    v_mfma_f32_16x16x32_bf16 v[192:195], a[176:179], v[32:35], v[192:195]
    v_mfma_f32_16x16x32_bf16 v[196:199], a[176:179], v[36:39], v[196:199]
    v_mfma_f32_16x16x32_bf16 v[200:203], a[176:179], v[40:43], v[200:203]
    s_cbranch_vccnz L_fx9
L_s9:
    v_mfma_f32_16x16x32_bf16 v[124:127], a[180:183], v[44:47], v[124:127]
    s_bfe_u32 s10, s71, 0x80000
    s_lshl_b32 s10, s10, 12
    s_add_u32 s10, s10, s9
    buffer_load_dwordx4 v[92:95], v4, s[40:43], s10 offen sc1
    v_mfma_f32_16x16x32_bf16 v[128:131], a[180:183], v[48:51], v[128:131]
    buffer_load_dwordx4 v[96:99], v5, s[40:43], s10 offen sc1
    v_mfma_f32_16x16x32_bf16 v[132:135], a[180:183], v[52:55], v[132:135]
    buffer_load_dwordx4 v[100:103], v6, s[40:43], s10 offen sc1
    v_mfma_f32_16x16x32_bf16 v[136:139], a[180:183], v[56:59], v[136:139]
    buffer_load_dwordx4 v[104:107], v7, s[40:43], s10 offen sc1
    v_mfma_f32_16x16x32_bf16 v[140:143], a[184:187], v[44:47], v[140:143]
    s_bfe_u32 s10, s71, 0x80008
    s_lshl_b32 s10, s10, 12
    s_add_u32 s10, s10, s9
    buffer_load_dwordx4 v[108:111], v4, s[40:43], s10 offen sc1
    v_mfma_f32_16x16x32_bf16 v[144:147], a[184:187], v[48:51], v[144:147]
    buffer_load_dwordx4 v[112:115], v5, s[40:43], s10 offen sc1
    v_mfma_f32_16x16x32_bf16 v[148:151], a[184:187], v[52:55], v[148:151]
    buffer_load_dwordx4 v[116:119], v6, s[40:43], s10 offen sc1
    v_mfma_f32_16x16x32_bf16 v[152:155], a[184:187], v[56:59], v[152:155]
    buffer_load_dwordx4 v[120:123], v7, s[40:43], s10 offen sc1
    v_mfma_f32_16x16x32_bf16 v[156:159], a[188:191], v[44:47], v[156:159]
    buffer_load_dwordx2 v[214:215], v2, s[40:43], s14 offen offset:0 sc1
    v_mfma_f32_16x16x32_bf16 v[160:163], a[188:191], v[48:51], v[160:163]
    s_waitcnt vmcnt(13)
    v_max3_u32 v208, v60, v64, v68
    v_mfma_f32_16x16x32_bf16 v[164:167], a[188:191], v[52:55], v[164:167]
    buffer_load_dwordx2 v[216:217], v2, s[40:43], s14 offen offset:512 sc1
    v_max_u32 v208, v208, v72
    v_mfma_f32_16x16x32_bf16 v[168:171], a[188:191], v[56:59], v[168:171]
    buffer_load_dwordx2 v[218:219], v2, s[40:43], s14 offen offset:1024 sc1
    v_cmp_lt_u32 vcc, s28, v208
    v_mfma_f32_16x16x32_bf16 v[172:175], a[192:195], v[44:47], v[172:175]
    buffer_load_dwordx2 v[220:221], v2, s[40:43], s14 offen offset:1536 sc1
    v_mfma_f32_16x16x32_bf16 v[176:179], a[192:195], v[48:51], v[176:179]
    buffer_load_dwordx2 v[222:223], v2, s[40:43], s14 offen offset:2048 sc1
    v_mfma_f32_16x16x32_bf16 v[180:183], a[192:195], v[52:55], v[180:183]
    v_mfma_f32_16x16x32_bf16 v[184:187], a[192:195], v[56:59], v[184:187]
    v_mfma_f32_16x16x32_bf16 v[188:191], a[196:199], v[44:47], v[188:191]
    v_mfma_f32_16x16x32_bf16 v[192:195], a[196:199], v[48:51], v[192:195]
    v_mfma_f32_16x16x32_bf16 v[196:199], a[196:199], v[52:55], v[196:199]
    v_mfma_f32_16x16x32_bf16 v[200:203], a[196:199], v[56:59], v[200:203]
    s_cbranch_vccnz L_fx10
L_s10:
    v_mfma_f32_16x16x32_bf16 v[124:127], a[200:203], v[60:63], v[124:127]
    buffer_load_dwordx4 v[28:31], v213, s[40:43], s13 offen offset:0
    v_mfma_f32_16x16x32_bf16 v[128:131], a[200:203], v[64:67], v[128:131]
    v_mfma_f32_16x16x32_bf16 v[132:135], a[200:203], v[68:71], v[132:135]
    v_mfma_f32_16x16x32_bf16 v[136:139], a[200:203], v[72:75], v[136:139]
    buffer_load_dwordx4 v[32:35], v213, s[40:43], s13 offen offset:64
    v_mfma_f32_16x16x32_bf16 v[140:143], a[204:207], v[60:63], v[140:143]
    v_mfma_f32_16x16x32_bf16 v[144:147], a[204:207], v[64:67], v[144:147]
    v_mfma_f32_16x16x32_bf16 v[148:151], a[204:207], v[68:71], v[148:151]
    buffer_load_dwordx4 v[36:39], v213, s[40:43], s13 offen offset:128
    v_mfma_f32_16x16x32_bf16 v[152:155], a[204:207], v[72:75], v[152:155]
    v_mfma_f32_16x16x32_bf16 v[156:159], a[208:211], v[60:63], v[156:159]
    v_mfma_f32_16x16x32_bf16 v[160:163], a[208:211], v[64:67], v[160:163]
    s_waitcnt vmcnt(16)
    v_max3_u32 v208, v76, v80, v84
    v_mfma_f32_16x16x32_bf16 v[164:167], a[208:211], v[68:71], v[164:167]
    buffer_load_dwordx4 v[40:43], v213, s[40:43], s13 offen offset:192
    v_max_u32 v208, v208, v88
    v_mfma_f32_16x16x32_bf16 v[168:171], a[208:211], v[72:75], v[168:171]
    v_cmp_lt_u32 vcc, s28, v208
    v_mfma_f32_16x16x32_bf16 v[172:175], a[212:215], v[60:63], v[172:175]
    v_mfma_f32_16x16x32_bf16 v[176:179], a[212:215], v[64:67], v[176:179]
    buffer_load_dwordx4 v[44:47], v213, s[40:43], s13 offen offset:256
    v_mfma_f32_16x16x32_bf16 v[180:183], a[212:215], v[68:71], v[180:183]
    v_mfma_f32_16x16x32_bf16 v[184:187], a[212:215], v[72:75], v[184:187]
    v_mfma_f32_16x16x32_bf16 v[188:191], a[216:219], v[60:63], v[188:191]
    v_mfma_f32_16x16x32_bf16 v[192:195], a[216:219], v[64:67], v[192:195]
    v_mfma_f32_16x16x32_bf16 v[196:199], a[216:219], v[68:71], v[196:199]
    v_mfma_f32_16x16x32_bf16 v[200:203], a[216:219], v[72:75], v[200:203]
    s_cbranch_vccnz L_fx11
L_s11:
    v_mfma_f32_16x16x32_bf16 v[124:127], a[220:223], v[76:79], v[124:127]
    v_mfma_f32_16x16x32_bf16 v[128:131], a[220:223], v[80:83], v[128:131]
    v_mfma_f32_16x16x32_bf16 v[132:135], a[220:223], v[84:87], v[132:135]
    v_mfma_f32_16x16x32_bf16 v[136:139], a[220:223], v[88:91], v[136:139]
    v_mfma_f32_16x16x32_bf16 v[140:143], a[224:227], v[76:79], v[140:143]
    v_mfma_f32_16x16x32_bf16 v[144:147], a[224:227], v[80:83], v[144:147]
    v_mfma_f32_16x16x32_bf16 v[148:151], a[224:227], v[84:87], v[148:151]
    v_mfma_f32_16x16x32_bf16 v[152:155], a[224:227], v[88:91], v[152:155]
    v_mfma_f32_16x16x32_bf16 v[156:159], a[228:231], v[76:79], v[156:159]
    v_mfma_f32_16x16x32_bf16 v[160:163], a[228:231], v[80:83], v[160:163]
    s_waitcnt vmcnt(10)
    v_max3_u32 v208, v92, v96, v100
    v_mfma_f32_16x16x32_bf16 v[164:167], a[228:231], v[84:87], v[164:167]
    v_max_u32 v208, v208, v104
    v_mfma_f32_16x16x32_bf16 v[168:171], a[228:231], v[88:91], v[168:171]
    v_max3_u32 v208, v108, v112, v208
    v_mfma_f32_16x16x32_bf16 v[172:175], a[232:235], v[76:79], v[172:175]
    v_max3_u32 v208, v116, v120, v208
    v_mfma_f32_16x16x32_bf16 v[176:179], a[232:235], v[80:83], v[176:179]
    v_cmp_lt_u32 vcc, s28, v208
    v_mfma_f32_16x16x32_bf16 v[180:183], a[232:235], v[84:87], v[180:183]
    v_mfma_f32_16x16x32_bf16 v[184:187], a[232:235], v[88:91], v[184:187]
    v_mfma_f32_16x16x32_bf16 v[188:191], a[236:239], v[76:79], v[188:191]
    v_mfma_f32_16x16x32_bf16 v[192:195], a[236:239], v[80:83], v[192:195]
    v_mfma_f32_16x16x32_bf16 v[196:199], a[236:239], v[84:87], v[196:199]
    v_mfma_f32_16x16x32_bf16 v[200:203], a[236:239], v[88:91], v[200:203]
    s_cbranch_vccnz L_fx12
L_s12:
    s_waitcnt vmcnt(5)
    v_mfma_f32_16x16x32_bf16 v[128:131], a[240:243], v[96:99], v[128:131]
    v_and_b32 v4, 1, v210
    v_mad_u32_u24 v4, v4, 24, v3
    v_mfma_f32_16x16x32_bf16 v[144:147], a[244:247], v[96:99], v[144:147]
    v_lshlrev_b32 v52, 16, v214
    v_and_b32 v53, 0xffff0000, v214
    v_mfma_f32_16x16x32_bf16 v[160:163], a[248:251], v[96:99], v[160:163]
    v_lshlrev_b32 v54, 16, v215
    v_and_b32 v55, 0xffff0000, v215
    v_mfma_f32_16x16x32_bf16 v[176:179], a[252:255], v[96:99], v[176:179]
    v_lshlrev_b32 v56, 16, v216
    v_and_b32 v57, 0xffff0000, v216
    v_mfma_f32_16x16x32_bf16 v[192:195], v[232:235], v[96:99], v[192:195]
    v_lshlrev_b32 v58, 16, v217
    v_and_b32 v59, 0xffff0000, v217
    v_mfma_f32_16x16x32_bf16 v[128:131], v[236:239], v[112:115], v[128:131]
    v_lshlrev_b32 v60, 16, v218
    v_and_b32 v61, 0xffff0000, v218
    v_mfma_f32_16x16x32_bf16 v[144:147], v[240:243], v[112:115], v[144:147]
    v_lshlrev_b32 v62, 16, v219
    v_and_b32 v63, 0xffff0000, v219
    v_mfma_f32_16x16x32_bf16 v[160:163], v[244:247], v[112:115], v[160:163]
    v_lshlrev_b32 v64, 16, v220
    v_and_b32 v65, 0xffff0000, v220
    v_mfma_f32_16x16x32_bf16 v[176:179], v[248:251], v[112:115], v[176:179]
    ds_write_b128 v9, v[128:131] offset:0
    v_mfma_f32_16x16x32_bf16 v[192:195], v[252:255], v[112:115], v[192:195]
    v_lshlrev_b32 v66, 16, v221
    v_and_b32 v67, 0xffff0000, v221
    v_mfma_f32_16x16x32_bf16 v[132:135], a[240:243], v[100:103], v[132:135]
    v_lshlrev_b32 v68, 16, v222
    v_and_b32 v69, 0xffff0000, v222
    v_mfma_f32_16x16x32_bf16 v[148:151], a[244:247], v[100:103], v[148:151]
    ds_write_b128 v9, v[144:147] offset:1024
    v_mfma_f32_16x16x32_bf16 v[164:167], a[248:251], v[100:103], v[164:167]
    v_lshlrev_b32 v70, 16, v223
    v_and_b32 v71, 0xffff0000, v223
    v_mfma_f32_16x16x32_bf16 v[180:183], a[252:255], v[100:103], v[180:183]
    s_waitcnt vmcnt(0)
    s_mov_b32 s4, 0x3f80
    v_mfma_f32_16x16x32_bf16 v[196:199], v[232:235], v[100:103], v[196:199]
    ds_write_b128 v9, v[160:163] offset:2048
    v_mfma_f32_16x16x32_bf16 v[132:135], v[236:239], v[116:119], v[132:135]
    s_mov_b32 s5, 0x3f800000
    v_lshrrev_b32 v28, 16, v28
    v_mfma_f32_16x16x32_bf16 v[148:151], v[240:243], v[116:119], v[148:151]
    v_lshrrev_b32 v30, 16, v30
    v_lshrrev_b32 v32, 16, v32
    v_mfma_f32_16x16x32_bf16 v[164:167], v[244:247], v[116:119], v[164:167]
    ds_write_b128 v9, v[176:179] offset:3072
    v_mfma_f32_16x16x32_bf16 v[180:183], v[248:251], v[116:119], v[180:183]
    v_lshrrev_b32 v34, 16, v34
    v_lshrrev_b32 v36, 16, v36
    v_mfma_f32_16x16x32_bf16 v[196:199], v[252:255], v[116:119], v[196:199]
    v_lshrrev_b32 v38, 16, v38
    v_lshrrev_b32 v40, 16, v40
    v_mfma_f32_16x16x32_bf16 v[136:139], a[240:243], v[104:107], v[136:139]
    ds_write_b128 v9, v[192:195] offset:4096
    v_mfma_f32_16x16x32_bf16 v[152:155], a[244:247], v[104:107], v[152:155]
    v_lshrrev_b32 v42, 16, v42
    v_lshrrev_b32 v44, 16, v44
    v_mfma_f32_16x16x32_bf16 v[168:171], a[248:251], v[104:107], v[168:171]
    v_lshrrev_b32 v46, 16, v46
    v_mfma_f32_16x16x32_bf16 v[184:187], a[252:255], v[104:107], v[184:187]
    ds_write_b128 v10, v[132:135] offset:0
    v_mfma_f32_16x16x32_bf16 v[200:203], v[232:235], v[104:107], v[200:203]
    v_mfma_f32_16x16x32_bf16 v[136:139], v[236:239], v[120:123], v[136:139]
    v_mfma_f32_16x16x32_bf16 v[152:155], v[240:243], v[120:123], v[152:155]
    ds_write_b128 v10, v[148:151] offset:1024
    v_mfma_f32_16x16x32_bf16 v[168:171], v[244:247], v[120:123], v[168:171]
    v_mfma_f32_16x16x32_bf16 v[184:187], v[248:251], v[120:123], v[184:187]
    v_mfma_f32_16x16x32_bf16 v[200:203], v[252:255], v[120:123], v[200:203]
    ds_write_b128 v10, v[164:167] offset:2048
    v_mfma_f32_16x16x32_bf16 v[124:127], a[240:243], v[92:95], v[124:127]
    v_mfma_f32_16x16x32_bf16 v[140:143], a[244:247], v[92:95], v[140:143]
    v_mfma_f32_16x16x32_bf16 v[156:159], a[248:251], v[92:95], v[156:159]
    ds_write_b128 v10, v[180:183] offset:3072
    v_mfma_f32_16x16x32_bf16 v[172:175], a[252:255], v[92:95], v[172:175]
    v_mfma_f32_16x16x32_bf16 v[188:191], v[232:235], v[92:95], v[188:191]
    v_mfma_f32_16x16x32_bf16 v[124:127], v[236:239], v[108:111], v[124:127]
    ds_write_b128 v10, v[196:199] offset:4096
    v_mfma_f32_16x16x32_bf16 v[140:143], v[240:243], v[108:111], v[140:143]
    v_mfma_f32_16x16x32_bf16 v[156:159], v[244:247], v[108:111], v[156:159]
    v_mfma_f32_16x16x32_bf16 v[172:175], v[248:251], v[108:111], v[172:175]
    ds_write_b128 v11, v[136:139] offset:0
    v_mfma_f32_16x16x32_bf16 v[188:191], v[252:255], v[108:111], v[188:191]
    ds_write_b128 v11, v[152:155] offset:1024
    ds_write_b128 v11, v[168:171] offset:2048
    ds_write_b128 v11, v[184:187] offset:3072
    ds_write_b128 v11, v[200:203] offset:4096
    s_waitcnt vmcnt(0) lgkmcnt(0)
    s_barrier
    ds_read_b128 v[76:79], v8 offset:0
    ds_read_b128 v[96:99], v8 offset:5120
    ds_read_b128 v[204:207], v8 offset:10240
    ds_read_b128 v[80:83], v8 offset:1024
    ds_read_b128 v[100:103], v8 offset:6144
    ds_read_b128 v[208:211], v8 offset:11264
    ds_read_b128 v[84:87], v8 offset:2048
    ds_read_b128 v[104:107], v8 offset:7168
    ds_read_b128 v[212:215], v8 offset:12288
    ds_read_b128 v[88:91], v8 offset:3072
    ds_read_b128 v[108:111], v8 offset:8192
    ds_read_b128 v[216:219], v8 offset:13312
    ds_read_b128 v[92:95], v8 offset:4096
    ds_read_b128 v[112:115], v8 offset:9216
    ds_read_b128 v[220:223], v8 offset:14336
    s_bitcmp1_b32 s26, 0
    s_cbranch_scc1 L_ep_odd
    s_waitcnt lgkmcnt(9)
    v_pk_add_f32 v[76:77], v[76:77], v[96:97]
    v_pk_add_f32 v[204:205], v[204:205], v[124:125]
    v_pk_add_f32 v[78:79], v[78:79], v[98:99]
    v_pk_add_f32 v[206:207], v[206:207], v[126:127]
    v_pk_add_f32 v[80:81], v[80:81], v[100:101]
    v_pk_add_f32 v[208:209], v[208:209], v[140:141]
    v_pk_add_f32 v[82:83], v[82:83], v[102:103]
    v_pk_add_f32 v[210:211], v[210:211], v[142:143]
    v_pk_add_f32 v[76:77], v[76:77], v[204:205]
    v_pk_add_f32 v[78:79], v[78:79], v[206:207]
    v_pk_add_f32 v[80:81], v[80:81], v[208:209]
    v_pk_add_f32 v[82:83], v[82:83], v[210:211]
    v_cvt_pk_bf16_f32 v96, v76, v77
    v_cvt_pk_bf16_f32 v97, v78, v79
    v_cvt_pk_bf16_f32 v98, v80, v81
    v_cvt_pk_bf16_f32 v99, v82, v83
    v_dot2_f32_bf16 v76, v96, v28, 0
    v_dot2_f32_bf16 v77, v96, v29, 0
    v_dot2_f32_bf16 v78, v97, v30, 0
    v_dot2_f32_bf16 v79, v97, v31, 0
    v_dot2_f32_bf16 v80, v98, v32, 0
    v_dot2_f32_bf16 v81, v98, v33, 0
    v_dot2_f32_bf16 v82, v99, v34, 0
    v_dot2_f32_bf16 v83, v99, v35, 0
    v_cvt_pk_bf16_f32 v96, v76, v77
    v_cvt_pk_bf16_f32 v97, v78, v79
    v_cvt_pk_bf16_f32 v98, v80, v81
    v_cvt_pk_bf16_f32 v99, v82, v83
    v_dot2_f32_bf16 v76, v96, s4, v52
    v_dot2_f32_bf16 v77, v96, s5, v53
    v_dot2_f32_bf16 v78, v97, s4, v54
    v_dot2_f32_bf16 v79, v97, s5, v55
    v_dot2_f32_bf16 v80, v98, s4, v56
    v_dot2_f32_bf16 v81, v98, s5, v57
    v_dot2_f32_bf16 v82, v99, s4, v58
    v_dot2_f32_bf16 v83, v99, s5, v59
    v_cvt_pk_bf16_f32 v96, v76, v77
    v_cvt_pk_bf16_f32 v97, v78, v79
    v_cvt_pk_bf16_f32 v98, v80, v81
    v_cvt_pk_bf16_f32 v99, v82, v83
    s_nop 0
    v_permlane16_swap_b32 v96, v98
    v_permlane16_swap_b32 v97, v99
    buffer_store_dwordx4 v[96:99], v4, s[44:47], s11 offen offset:0 sc1
    s_waitcnt lgkmcnt(3)
    v_pk_add_f32 v[84:85], v[84:85], v[104:105]
    v_pk_add_f32 v[212:213], v[212:213], v[156:157]
    v_pk_add_f32 v[86:87], v[86:87], v[106:107]
    v_pk_add_f32 v[214:215], v[214:215], v[158:159]
    v_pk_add_f32 v[88:89], v[88:89], v[108:109]
    v_pk_add_f32 v[216:217], v[216:217], v[172:173]
    v_pk_add_f32 v[90:91], v[90:91], v[110:111]
    v_pk_add_f32 v[218:219], v[218:219], v[174:175]
    v_pk_add_f32 v[84:85], v[84:85], v[212:213]
    v_pk_add_f32 v[86:87], v[86:87], v[214:215]
    v_pk_add_f32 v[88:89], v[88:89], v[216:217]
    v_pk_add_f32 v[90:91], v[90:91], v[218:219]
    v_cvt_pk_bf16_f32 v104, v84, v85
    v_cvt_pk_bf16_f32 v105, v86, v87
    v_cvt_pk_bf16_f32 v106, v88, v89
    v_cvt_pk_bf16_f32 v107, v90, v91
    v_dot2_f32_bf16 v84, v104, v36, 0
    v_dot2_f32_bf16 v85, v104, v37, 0
    v_dot2_f32_bf16 v86, v105, v38, 0
    v_dot2_f32_bf16 v87, v105, v39, 0
    v_dot2_f32_bf16 v88, v106, v40, 0
    v_dot2_f32_bf16 v89, v106, v41, 0
    v_dot2_f32_bf16 v90, v107, v42, 0
    v_dot2_f32_bf16 v91, v107, v43, 0
    v_cvt_pk_bf16_f32 v104, v84, v85
    v_cvt_pk_bf16_f32 v105, v86, v87
    v_cvt_pk_bf16_f32 v106, v88, v89
    v_cvt_pk_bf16_f32 v107, v90, v91
    v_dot2_f32_bf16 v84, v104, s4, v60
    v_dot2_f32_bf16 v85, v104, s5, v61
    v_dot2_f32_bf16 v86, v105, s4, v62
    v_dot2_f32_bf16 v87, v105, s5, v63
    v_dot2_f32_bf16 v88, v106, s4, v64
    v_dot2_f32_bf16 v89, v106, s5, v65
    v_dot2_f32_bf16 v90, v107, s4, v66
    v_dot2_f32_bf16 v91, v107, s5, v67
    v_cvt_pk_bf16_f32 v104, v84, v85
    v_cvt_pk_bf16_f32 v105, v86, v87
    v_cvt_pk_bf16_f32 v106, v88, v89
    v_cvt_pk_bf16_f32 v107, v90, v91
    s_nop 0
    v_permlane16_swap_b32 v104, v106
    v_permlane16_swap_b32 v105, v107
    buffer_store_dwordx4 v[104:107], v4, s[44:47], s11 offen offset:64 sc1
    s_waitcnt lgkmcnt(0)
    v_pk_add_f32 v[92:93], v[92:93], v[112:113]
    v_pk_add_f32 v[220:221], v[220:221], v[188:189]
    v_pk_add_f32 v[94:95], v[94:95], v[114:115]
    v_pk_add_f32 v[222:223], v[222:223], v[190:191]
    v_pk_add_f32 v[92:93], v[92:93], v[220:221]
    v_pk_add_f32 v[94:95], v[94:95], v[222:223]
    v_cvt_pk_bf16_f32 v112, v92, v93
    v_cvt_pk_bf16_f32 v113, v94, v95
    v_dot2_f32_bf16 v92, v112, v44, 0
    v_dot2_f32_bf16 v93, v112, v45, 0
    v_dot2_f32_bf16 v94, v113, v46, 0
    v_dot2_f32_bf16 v95, v113, v47, 0
    s_nop 0
    v_cvt_pk_bf16_f32 v112, v92, v93
    s_nop 0
    v_cvt_pk_bf16_f32 v113, v94, v95
    v_dot2_f32_bf16 v92, v112, s4, v68
    v_dot2_f32_bf16 v93, v112, s5, v69
    v_dot2_f32_bf16 v94, v113, s4, v70
    v_dot2_f32_bf16 v95, v113, s5, v71
    s_nop 0
    v_cvt_pk_bf16_f32 v112, v92, v93
    s_nop 0
    v_cvt_pk_bf16_f32 v113, v94, v95
    buffer_store_dwordx2 v[112:113], v3, s[44:47], s11 offen offset:128 sc1
    s_endpgm
L_ep_odd:
    s_waitcnt lgkmcnt(12)
    v_pk_add_f32 v[76:77], v[76:77], v[96:97]
    v_pk_add_f32 v[204:205], v[204:205], v[124:125]
    v_pk_add_f32 v[78:79], v[78:79], v[98:99]
    v_pk_add_f32 v[206:207], v[206:207], v[126:127]
    v_pk_add_f32 v[76:77], v[76:77], v[204:205]
    v_pk_add_f32 v[78:79], v[78:79], v[206:207]
    v_cvt_pk_bf16_f32 v96, v76, v77
    v_cvt_pk_bf16_f32 v97, v78, v79
    v_dot2_f32_bf16 v76, v96, v28, 0
    v_dot2_f32_bf16 v77, v96, v29, 0
    v_dot2_f32_bf16 v78, v97, v30, 0
    v_dot2_f32_bf16 v79, v97, v31, 0
    s_nop 0
    v_cvt_pk_bf16_f32 v96, v76, v77
    s_nop 0
    v_cvt_pk_bf16_f32 v97, v78, v79
    v_dot2_f32_bf16 v76, v96, s4, v52
    v_dot2_f32_bf16 v77, v96, s5, v53
    v_dot2_f32_bf16 v78, v97, s4, v54
    v_dot2_f32_bf16 v79, v97, s5, v55
    s_nop 0
    v_cvt_pk_bf16_f32 v96, v76, v77
    s_nop 0
    v_cvt_pk_bf16_f32 v97, v78, v79
    buffer_store_dwordx2 v[96:97], v3, s[44:47], s11 offen offset:0 sc1
    s_waitcnt lgkmcnt(6)
    v_pk_add_f32 v[80:81], v[80:81], v[100:101]
    v_pk_add_f32 v[208:209], v[208:209], v[140:141]
    v_pk_add_f32 v[82:83], v[82:83], v[102:103]
    v_pk_add_f32 v[210:211], v[210:211], v[142:143]
    v_pk_add_f32 v[84:85], v[84:85], v[104:105]
    v_pk_add_f32 v[212:213], v[212:213], v[156:157]
    v_pk_add_f32 v[86:87], v[86:87], v[106:107]
    v_pk_add_f32 v[214:215], v[214:215], v[158:159]
    v_pk_add_f32 v[80:81], v[80:81], v[208:209]
    v_pk_add_f32 v[82:83], v[82:83], v[210:211]
    v_pk_add_f32 v[84:85], v[84:85], v[212:213]
    v_pk_add_f32 v[86:87], v[86:87], v[214:215]
    v_cvt_pk_bf16_f32 v100, v80, v81
    v_cvt_pk_bf16_f32 v101, v82, v83
    v_cvt_pk_bf16_f32 v102, v84, v85
    v_cvt_pk_bf16_f32 v103, v86, v87
    v_dot2_f32_bf16 v80, v100, v32, 0
    v_dot2_f32_bf16 v81, v100, v33, 0
    v_dot2_f32_bf16 v82, v101, v34, 0
    v_dot2_f32_bf16 v83, v101, v35, 0
    v_dot2_f32_bf16 v84, v102, v36, 0
    v_dot2_f32_bf16 v85, v102, v37, 0
    v_dot2_f32_bf16 v86, v103, v38, 0
    v_dot2_f32_bf16 v87, v103, v39, 0
    v_cvt_pk_bf16_f32 v100, v80, v81
    v_cvt_pk_bf16_f32 v101, v82, v83
    v_cvt_pk_bf16_f32 v102, v84, v85
    v_cvt_pk_bf16_f32 v103, v86, v87
    v_dot2_f32_bf16 v80, v100, s4, v56
    v_dot2_f32_bf16 v81, v100, s5, v57
    v_dot2_f32_bf16 v82, v101, s4, v58
    v_dot2_f32_bf16 v83, v101, s5, v59
    v_dot2_f32_bf16 v84, v102, s4, v60
    v_dot2_f32_bf16 v85, v102, s5, v61
    v_dot2_f32_bf16 v86, v103, s4, v62
    v_dot2_f32_bf16 v87, v103, s5, v63
    v_cvt_pk_bf16_f32 v100, v80, v81
    v_cvt_pk_bf16_f32 v101, v82, v83
    v_cvt_pk_bf16_f32 v102, v84, v85
    v_cvt_pk_bf16_f32 v103, v86, v87
    s_nop 0
    v_permlane16_swap_b32 v100, v102
    v_permlane16_swap_b32 v101, v103
    buffer_store_dwordx4 v[100:103], v4, s[44:47], s11 offen offset:32 sc1
    s_waitcnt lgkmcnt(0)
    v_pk_add_f32 v[88:89], v[88:89], v[108:109]
    v_pk_add_f32 v[216:217], v[216:217], v[172:173]
    v_pk_add_f32 v[90:91], v[90:91], v[110:111]
    v_pk_add_f32 v[218:219], v[218:219], v[174:175]
    v_pk_add_f32 v[92:93], v[92:93], v[112:113]
    v_pk_add_f32 v[220:221], v[220:221], v[188:189]
    v_pk_add_f32 v[94:95], v[94:95], v[114:115]
    v_pk_add_f32 v[222:223], v[222:223], v[190:191]
    v_pk_add_f32 v[88:89], v[88:89], v[216:217]
    v_pk_add_f32 v[90:91], v[90:91], v[218:219]
    v_pk_add_f32 v[92:93], v[92:93], v[220:221]
    v_pk_add_f32 v[94:95], v[94:95], v[222:223]
    v_cvt_pk_bf16_f32 v108, v88, v89
    v_cvt_pk_bf16_f32 v109, v90, v91
    v_cvt_pk_bf16_f32 v110, v92, v93
    v_cvt_pk_bf16_f32 v111, v94, v95
    v_dot2_f32_bf16 v88, v108, v40, 0
    v_dot2_f32_bf16 v89, v108, v41, 0
    v_dot2_f32_bf16 v90, v109, v42, 0
    v_dot2_f32_bf16 v91, v109, v43, 0
    v_dot2_f32_bf16 v92, v110, v44, 0
    v_dot2_f32_bf16 v93, v110, v45, 0
    v_dot2_f32_bf16 v94, v111, v46, 0
    v_dot2_f32_bf16 v95, v111, v47, 0
    v_cvt_pk_bf16_f32 v108, v88, v89
    v_cvt_pk_bf16_f32 v109, v90, v91
    v_cvt_pk_bf16_f32 v110, v92, v93
    v_cvt_pk_bf16_f32 v111, v94, v95
    v_dot2_f32_bf16 v88, v108, s4, v64
    v_dot2_f32_bf16 v89, v108, s5, v65
    v_dot2_f32_bf16 v90, v109, s4, v66
    v_dot2_f32_bf16 v91, v109, s5, v67
    v_dot2_f32_bf16 v92, v110, s4, v68
    v_dot2_f32_bf16 v93, v110, s5, v69
    v_dot2_f32_bf16 v94, v111, s4, v70
    v_dot2_f32_bf16 v95, v111, s5, v71
    v_cvt_pk_bf16_f32 v108, v88, v89
    v_cvt_pk_bf16_f32 v109, v90, v91
    v_cvt_pk_bf16_f32 v110, v92, v93
    v_cvt_pk_bf16_f32 v111, v94, v95
    s_nop 0
    v_permlane16_swap_b32 v108, v110
    v_permlane16_swap_b32 v109, v111
    buffer_store_dwordx4 v[108:111], v4, s[44:47], s11 offen offset:96 sc1
L_ep_end:
L_end:
    s_endpgm
L_an_slow0:
    s_mov_b32 s31, 0
L_an_loop0:
    s_sleep 4
    buffer_load_dword v189, v5, s[48:51], 0 offen sc1
    s_waitcnt vmcnt(0)
    v_cmp_eq_u32 vcc, 0, v189
    s_cbranch_vccz L_an_done0
    s_add_u32 s31, s31, 1
    s_cmp_gt_u32 s31, 65536
    s_cbranch_scc1 L_an_done0
    s_branch L_an_loop0
L_an_slow2:
    s_mov_b32 s31, 0
L_an_loop2:
    s_sleep 4
    buffer_load_dword v189, v5, s[48:51], 0 offen sc1
    s_waitcnt vmcnt(0)
    v_cmp_eq_u32 vcc, 0, v189
    s_cbranch_vccz L_an_done2
    s_add_u32 s31, s31, 1
    s_cmp_gt_u32 s31, 65536
    s_cbranch_scc1 L_an_done2
    s_branch L_an_loop2
L_an_slow1:
    s_mov_b32 s31, 0
L_an_loop1:
    s_sleep 4
    buffer_load_dword v189, v5, s[48:51], 0 offen sc1
    s_waitcnt vmcnt(0)
    v_cmp_eq_u32 vcc, 0, v189
    s_cbranch_vccz L_an_done1
    s_add_u32 s31, s31, 1
    s_cmp_gt_u32 s31, 65536
    s_cbranch_scc1 L_an_done1
    s_branch L_an_loop1
L_fc_slow0:
    s_mov_b32 s31, 0
L_fc_loop0:
    s_sleep 4
    s_mov_b32 s15, 1048576
    buffer_load_dwordx4 v[190:193], v3, s[40:43], s15 offen offset:0 sc1
    s_waitcnt vmcnt(0)
    s_cmp_ge_u32 s2, 192
    s_cselect_b64 vcc, -1, 0
    v_cndmask_b32 v192, v192, v193, vcc
    v_cmp_eq_u32 vcc, s1, v2
    s_nop 1
    v_cndmask_b32 v192, 0, v192, vcc
    v_max3_u32 v190, v190, v191, v192
    v_cmp_eq_u32 vcc, -1, v190
    s_cbranch_vccz L_fc_done0
    s_add_u32 s31, s31, 1
    s_cmp_gt_u32 s31, 65536
    s_cbranch_scc1 L_fc_done0
    s_branch L_fc_loop0
L_fc_slow1:
    s_mov_b32 s31, 0
L_fc_loop1:
    s_sleep 4
    s_mov_b32 s15, 1048576
    buffer_load_dwordx4 v[190:193], v3, s[40:43], s15 offen offset:0 sc1
    s_waitcnt vmcnt(0)
    v_max_u32 v190, v192, v193
    v_cmp_eq_u32 vcc, -1, v190
    s_cbranch_vccz L_fc_done1
    s_add_u32 s31, s31, 1
    s_cmp_gt_u32 s31, 65536
    s_cbranch_scc1 L_fc_done1
    s_branch L_fc_loop1
L_fb_slow:
    s_mov_b32 s31, 0
L_fb_loop:
    s_sleep 4
    s_mov_b32 s15, 1048576
    buffer_load_dwordx4 v[236:239], v3, s[40:43], s15 offen offset:16 sc1
    s_waitcnt vmcnt(0)
    v_max3_u32 v236, v236, v237, v238
    v_max_u32 v236, v236, v239
    v_cmp_eq_u32 vcc, -1, v236
    s_cbranch_vccz L_fb_done
    s_add_u32 s31, s31, 1
    s_cmp_gt_u32 s31, 65536
    s_cbranch_scc1 L_fb_done
    s_branch L_fb_loop
L_mv_slow:
    s_mov_b32 s31, 0
L_mv_loop:
    s_sleep 1
    s_mov_b32 s15, 1056768
    buffer_load_dwordx2 v[10:11], v215, s[40:43], s15 offen sc1
    s_waitcnt vmcnt(0)
    v_cmp_eq_u32 vcc, -1, v11
    s_cbranch_vccz L_mv_done
    s_add_u32 s31, s31, 1
    s_cmp_gt_u32 s31, 65536
    s_cbranch_scc1 L_mv_done
    s_branch L_mv_loop
L_rt_slow2:
    s_mov_b64 exec, vcc
    buffer_load_dwordx4 v[100:103], v196, s[40:43], s75 offen sc1
    buffer_load_dwordx4 v[92:95], v241, s[40:43], s61 offen sc1
    buffer_load_dwordx4 v[96:99], v240, s[40:43], s77 offen sc1
    s_mov_b64 exec, -1
    s_add_u32 m0, s19, 0
    s_add_u32 s30, s22, 888832
    buffer_load_dwordx4 v1, s[44:47], s30 offen offset:0 lds
    buffer_load_dwordx4 v1, s[44:47], s30 offen offset:1024 lds
    buffer_load_dwordx4 v1, s[44:47], s30 offen offset:2048 lds
    buffer_load_dwordx4 v1, s[44:47], s30 offen offset:3072 lds
    s_add_u32 m0, s19, 16384
    s_add_u32 s30, s22, 1331200
    buffer_load_dwordx4 v1, s[44:47], s30 offen offset:0 lds
    buffer_load_dwordx4 v1, s[44:47], s30 offen offset:1024 lds
    buffer_load_dwordx4 v1, s[44:47], s30 offen offset:2048 lds
    buffer_load_dwordx4 v1, s[44:47], s30 offen offset:3072 lds
    s_mov_b32 s29, 3
    s_waitcnt vmcnt(8)
    v_max3_u32 v60, v92, v93, v94
    v_max3_u32 v61, v95, v96, v97
    v_max3_u32 v62, v98, v99, v100
    v_max3_u32 v63, v101, v102, v103
    v_max3_u32 v60, v60, v61, v62
    v_max_u32 v60, v60, v63
    v_cmp_lt_u32 vcc, s28, v60
    s_cbranch_vccz L_rt_ok
L_rt_slow3:
    s_add_u32 s15, s15, 1
    s_cmp_gt_u32 s15, 65536
    s_cselect_b32 s28, -1, s28
    s_mov_b64 exec, vcc
    buffer_load_dwordx4 v[100:103], v196, s[40:43], s75 offen sc1
    buffer_load_dwordx4 v[92:95], v241, s[40:43], s61 offen sc1
    buffer_load_dwordx4 v[96:99], v240, s[40:43], s77 offen sc1
    s_mov_b64 exec, -1
    s_waitcnt vmcnt(0)
    v_max3_u32 v60, v92, v93, v94
    v_max3_u32 v61, v95, v96, v97
    v_max3_u32 v62, v98, v99, v100
    v_max3_u32 v63, v101, v102, v103
    v_max3_u32 v60, v60, v61, v62
    v_max_u32 v60, v60, v63
    v_cmp_lt_u32 vcc, s28, v60
    s_cbranch_vccnz L_rt_slow3
    s_branch L_rt_ok
L_g1_redo:
    s_add_u32 s15, s15, 65
    s_cmp_gt_u32 s15, 65536
    s_cselect_b32 s28, -1, s28
    s_waitcnt vmcnt(0) lgkmcnt(0)
    s_branch L_g1
L_fx0:
    s_nop 15
    s_waitcnt vmcnt(0)
    s_add_u32 s15, s15, 16
    s_cmp_gt_u32 s15, 65536
    s_cselect_b32 s28, -1, s28
    s_mov_b64 exec, vcc
    s_bfe_u32 s10, s68, 0x80000
    s_lshl_b32 s10, s10, 12
    s_add_u32 s10, s10, s9
    buffer_load_dwordx4 v[12:15], v4, s[40:43], s10 offen sc1
    buffer_load_dwordx4 v[16:19], v5, s[40:43], s10 offen sc1
    buffer_load_dwordx4 v[20:23], v6, s[40:43], s10 offen sc1
    buffer_load_dwordx4 v[24:27], v7, s[40:43], s10 offen sc1
    s_mov_b64 exec, -1
    v_max3_u32 v208, v28, v32, v36
    v_max_u32 v208, v208, v40
    v_cmp_lt_u32 vcc, s28, v208
    s_nop 0
    s_mov_b64 exec, vcc
    s_bfe_u32 s10, s68, 0x80008
    s_lshl_b32 s10, s10, 12
    s_add_u32 s10, s10, s9
    buffer_load_dwordx4 v[28:31], v4, s[40:43], s10 offen sc1
    buffer_load_dwordx4 v[32:35], v5, s[40:43], s10 offen sc1
    buffer_load_dwordx4 v[36:39], v6, s[40:43], s10 offen sc1
    buffer_load_dwordx4 v[40:43], v7, s[40:43], s10 offen sc1
    s_mov_b64 exec, -1
    v_max3_u32 v208, v44, v48, v52
    v_max_u32 v208, v208, v56
    v_cmp_lt_u32 vcc, s28, v208
    s_nop 0
    s_mov_b64 exec, vcc
    s_bfe_u32 s10, s68, 0x80010
    s_lshl_b32 s10, s10, 12
    s_add_u32 s10, s10, s9
    buffer_load_dwordx4 v[44:47], v4, s[40:43], s10 offen sc1
    buffer_load_dwordx4 v[48:51], v5, s[40:43], s10 offen sc1
    buffer_load_dwordx4 v[52:55], v6, s[40:43], s10 offen sc1
    buffer_load_dwordx4 v[56:59], v7, s[40:43], s10 offen sc1
    s_mov_b64 exec, -1
    s_waitcnt vmcnt(8)
    v_max3_u32 v208, v12, v16, v20
    v_max_u32 v208, v208, v24
    v_cmp_lt_u32 vcc, s28, v208
    s_cbranch_vccnz L_fx0
    s_branch L_s0
L_fx1:
    s_nop 15
    s_waitcnt vmcnt(0)
    s_add_u32 s15, s15, 16
    s_cmp_gt_u32 s15, 65536
    s_cselect_b32 s28, -1, s28
    s_mov_b64 exec, vcc
    s_bfe_u32 s10, s68, 0x80008
    s_lshl_b32 s10, s10, 12
    s_add_u32 s10, s10, s9
    buffer_load_dwordx4 v[28:31], v4, s[40:43], s10 offen sc1
    buffer_load_dwordx4 v[32:35], v5, s[40:43], s10 offen sc1
    buffer_load_dwordx4 v[36:39], v6, s[40:43], s10 offen sc1
    buffer_load_dwordx4 v[40:43], v7, s[40:43], s10 offen sc1
    s_mov_b64 exec, -1
    v_max3_u32 v208, v44, v48, v52
    v_max_u32 v208, v208, v56
    v_cmp_lt_u32 vcc, s28, v208
    s_nop 0
    s_mov_b64 exec, vcc
    s_bfe_u32 s10, s68, 0x80010
    s_lshl_b32 s10, s10, 12
    s_add_u32 s10, s10, s9
    buffer_load_dwordx4 v[44:47], v4, s[40:43], s10 offen sc1
    buffer_load_dwordx4 v[48:51], v5, s[40:43], s10 offen sc1
    buffer_load_dwordx4 v[52:55], v6, s[40:43], s10 offen sc1
    buffer_load_dwordx4 v[56:59], v7, s[40:43], s10 offen sc1
    s_mov_b64 exec, -1
    v_max3_u32 v208, v60, v64, v68
    v_max_u32 v208, v208, v72
    v_cmp_lt_u32 vcc, s28, v208
    s_nop 0
    s_mov_b64 exec, vcc
    s_bfe_u32 s10, s68, 0x80018
    s_lshl_b32 s10, s10, 12
    s_add_u32 s10, s10, s9
    buffer_load_dwordx4 v[60:63], v4, s[40:43], s10 offen sc1
    buffer_load_dwordx4 v[64:67], v5, s[40:43], s10 offen sc1
    buffer_load_dwordx4 v[68:71], v6, s[40:43], s10 offen sc1
    buffer_load_dwordx4 v[72:75], v7, s[40:43], s10 offen sc1
    s_mov_b64 exec, -1
    s_waitcnt vmcnt(8)
    v_max3_u32 v208, v28, v32, v36
    v_max_u32 v208, v208, v40
    v_cmp_lt_u32 vcc, s28, v208
    s_cbranch_vccnz L_fx1
    s_branch L_s1
L_fx2:
    s_nop 15
    s_waitcnt vmcnt(0)
    s_add_u32 s15, s15, 16
    s_cmp_gt_u32 s15, 65536
    s_cselect_b32 s28, -1, s28
    s_mov_b64 exec, vcc
    s_bfe_u32 s10, s68, 0x80010
    s_lshl_b32 s10, s10, 12
    s_add_u32 s10, s10, s9
    buffer_load_dwordx4 v[44:47], v4, s[40:43], s10 offen sc1
    buffer_load_dwordx4 v[48:51], v5, s[40:43], s10 offen sc1
    buffer_load_dwordx4 v[52:55], v6, s[40:43], s10 offen sc1
    buffer_load_dwordx4 v[56:59], v7, s[40:43], s10 offen sc1
    s_mov_b64 exec, -1
    v_max3_u32 v208, v60, v64, v68
    v_max_u32 v208, v208, v72
    v_cmp_lt_u32 vcc, s28, v208
    s_nop 0
    s_mov_b64 exec, vcc
    s_bfe_u32 s10, s68, 0x80018
    s_lshl_b32 s10, s10, 12
    s_add_u32 s10, s10, s9
    buffer_load_dwordx4 v[60:63], v4, s[40:43], s10 offen sc1
    buffer_load_dwordx4 v[64:67], v5, s[40:43], s10 offen sc1
    buffer_load_dwordx4 v[68:71], v6, s[40:43], s10 offen sc1
    buffer_load_dwordx4 v[72:75], v7, s[40:43], s10 offen sc1
    s_mov_b64 exec, -1
    v_max3_u32 v208, v76, v80, v84
    v_max_u32 v208, v208, v88
    v_cmp_lt_u32 vcc, s28, v208
    s_nop 0
    s_mov_b64 exec, vcc
    s_bfe_u32 s10, s69, 0x80000
    s_lshl_b32 s10, s10, 12
    s_add_u32 s10, s10, s9
    buffer_load_dwordx4 v[76:79], v4, s[40:43], s10 offen sc1
    buffer_load_dwordx4 v[80:83], v5, s[40:43], s10 offen sc1
    buffer_load_dwordx4 v[84:87], v6, s[40:43], s10 offen sc1
    buffer_load_dwordx4 v[88:91], v7, s[40:43], s10 offen sc1
    s_mov_b64 exec, -1
    s_waitcnt vmcnt(8)
    v_max3_u32 v208, v44, v48, v52
    v_max_u32 v208, v208, v56
    v_cmp_lt_u32 vcc, s28, v208
    s_cbranch_vccnz L_fx2
    s_branch L_s2
L_fx3:
    s_nop 15
    s_waitcnt vmcnt(0)
    s_add_u32 s15, s15, 16
    s_cmp_gt_u32 s15, 65536
    s_cselect_b32 s28, -1, s28
    s_mov_b64 exec, vcc
    s_bfe_u32 s10, s68, 0x80018
    s_lshl_b32 s10, s10, 12
    s_add_u32 s10, s10, s9
    buffer_load_dwordx4 v[60:63], v4, s[40:43], s10 offen sc1
    buffer_load_dwordx4 v[64:67], v5, s[40:43], s10 offen sc1
    buffer_load_dwordx4 v[68:71], v6, s[40:43], s10 offen sc1
    buffer_load_dwordx4 v[72:75], v7, s[40:43], s10 offen sc1
    s_mov_b64 exec, -1
    v_max3_u32 v208, v76, v80, v84
    v_max_u32 v208, v208, v88
    v_cmp_lt_u32 vcc, s28, v208
    s_nop 0
    s_mov_b64 exec, vcc
    s_bfe_u32 s10, s69, 0x80000
    s_lshl_b32 s10, s10, 12
    s_add_u32 s10, s10, s9
    buffer_load_dwordx4 v[76:79], v4, s[40:43], s10 offen sc1
    buffer_load_dwordx4 v[80:83], v5, s[40:43], s10 offen sc1
    buffer_load_dwordx4 v[84:87], v6, s[40:43], s10 offen sc1
    buffer_load_dwordx4 v[88:91], v7, s[40:43], s10 offen sc1
    s_mov_b64 exec, -1
    v_max3_u32 v208, v92, v96, v100
    v_max_u32 v208, v208, v104
    v_cmp_lt_u32 vcc, s28, v208
    s_nop 0
    s_mov_b64 exec, vcc
    s_bfe_u32 s10, s69, 0x80008
    s_lshl_b32 s10, s10, 12
    s_add_u32 s10, s10, s9
    buffer_load_dwordx4 v[92:95], v4, s[40:43], s10 offen sc1
    buffer_load_dwordx4 v[96:99], v5, s[40:43], s10 offen sc1
    buffer_load_dwordx4 v[100:103], v6, s[40:43], s10 offen sc1
    buffer_load_dwordx4 v[104:107], v7, s[40:43], s10 offen sc1
    s_mov_b64 exec, -1
    s_waitcnt vmcnt(8)
    v_max3_u32 v208, v60, v64, v68
    v_max_u32 v208, v208, v72
    v_cmp_lt_u32 vcc, s28, v208
    s_cbranch_vccnz L_fx3
    s_branch L_s3
L_fx4:
    s_nop 15
    s_waitcnt vmcnt(0)
    s_add_u32 s15, s15, 16
    s_cmp_gt_u32 s15, 65536
    s_cselect_b32 s28, -1, s28
    s_mov_b64 exec, vcc
    s_bfe_u32 s10, s69, 0x80000
    s_lshl_b32 s10, s10, 12
    s_add_u32 s10, s10, s9
    buffer_load_dwordx4 v[76:79], v4, s[40:43], s10 offen sc1
    buffer_load_dwordx4 v[80:83], v5, s[40:43], s10 offen sc1
    buffer_load_dwordx4 v[84:87], v6, s[40:43], s10 offen sc1
    buffer_load_dwordx4 v[88:91], v7, s[40:43], s10 offen sc1
    s_mov_b64 exec, -1
    v_max3_u32 v208, v92, v96, v100
    v_max_u32 v208, v208, v104
    v_cmp_lt_u32 vcc, s28, v208
    s_nop 0
    s_mov_b64 exec, vcc
    s_bfe_u32 s10, s69, 0x80008
    s_lshl_b32 s10, s10, 12
    s_add_u32 s10, s10, s9
    buffer_load_dwordx4 v[92:95], v4, s[40:43], s10 offen sc1
    buffer_load_dwordx4 v[96:99], v5, s[40:43], s10 offen sc1
    buffer_load_dwordx4 v[100:103], v6, s[40:43], s10 offen sc1
    buffer_load_dwordx4 v[104:107], v7, s[40:43], s10 offen sc1
    s_mov_b64 exec, -1
    v_max3_u32 v208, v108, v112, v116
    v_max_u32 v208, v208, v120
    v_cmp_lt_u32 vcc, s28, v208
    s_nop 0
    s_mov_b64 exec, vcc
    s_bfe_u32 s10, s69, 0x80010
    s_lshl_b32 s10, s10, 12
    s_add_u32 s10, s10, s9
    buffer_load_dwordx4 v[108:111], v4, s[40:43], s10 offen sc1
    buffer_load_dwordx4 v[112:115], v5, s[40:43], s10 offen sc1
    buffer_load_dwordx4 v[116:119], v6, s[40:43], s10 offen sc1
    buffer_load_dwordx4 v[120:123], v7, s[40:43], s10 offen sc1
    s_mov_b64 exec, -1
    s_waitcnt vmcnt(8)
    v_max3_u32 v208, v76, v80, v84
    v_max_u32 v208, v208, v88
    v_cmp_lt_u32 vcc, s28, v208
    s_cbranch_vccnz L_fx4
    s_branch L_s4
L_fx5:
    s_nop 15
    s_waitcnt vmcnt(0)
    s_add_u32 s15, s15, 16
    s_cmp_gt_u32 s15, 65536
    s_cselect_b32 s28, -1, s28
    s_mov_b64 exec, vcc
    s_bfe_u32 s10, s69, 0x80008
    s_lshl_b32 s10, s10, 12
    s_add_u32 s10, s10, s9
    buffer_load_dwordx4 v[92:95], v4, s[40:43], s10 offen sc1
    buffer_load_dwordx4 v[96:99], v5, s[40:43], s10 offen sc1
    buffer_load_dwordx4 v[100:103], v6, s[40:43], s10 offen sc1
    buffer_load_dwordx4 v[104:107], v7, s[40:43], s10 offen sc1
    s_mov_b64 exec, -1
    v_max3_u32 v208, v108, v112, v116
    v_max_u32 v208, v208, v120
    v_cmp_lt_u32 vcc, s28, v208
    s_nop 0
    s_mov_b64 exec, vcc
    s_bfe_u32 s10, s69, 0x80010
    s_lshl_b32 s10, s10, 12
    s_add_u32 s10, s10, s9
    buffer_load_dwordx4 v[108:111], v4, s[40:43], s10 offen sc1
    buffer_load_dwordx4 v[112:115], v5, s[40:43], s10 offen sc1
    buffer_load_dwordx4 v[116:119], v6, s[40:43], s10 offen sc1
    buffer_load_dwordx4 v[120:123], v7, s[40:43], s10 offen sc1
    s_mov_b64 exec, -1
    v_max3_u32 v208, v12, v16, v20
    v_max_u32 v208, v208, v24
    v_cmp_lt_u32 vcc, s28, v208
    s_nop 0
    s_mov_b64 exec, vcc
    s_bfe_u32 s10, s69, 0x80018
    s_lshl_b32 s10, s10, 12
    s_add_u32 s10, s10, s9
    buffer_load_dwordx4 v[12:15], v224, s[40:43], s10 offen sc1
    buffer_load_dwordx4 v[16:19], v225, s[40:43], s10 offen sc1
    buffer_load_dwordx4 v[20:23], v226, s[40:43], s10 offen sc1
    buffer_load_dwordx4 v[24:27], v227, s[40:43], s10 offen sc1
    s_mov_b64 exec, -1
    s_waitcnt vmcnt(8)
    v_max3_u32 v208, v92, v96, v100
    v_max_u32 v208, v208, v104
    v_cmp_lt_u32 vcc, s28, v208
    s_cbranch_vccnz L_fx5
    s_branch L_s5
L_fx6:
    s_nop 15
    s_waitcnt vmcnt(0)
    s_add_u32 s15, s15, 16
    s_cmp_gt_u32 s15, 65536
    s_cselect_b32 s28, -1, s28
    s_mov_b64 exec, vcc
    s_bfe_u32 s10, s69, 0x80010
    s_lshl_b32 s10, s10, 12
    s_add_u32 s10, s10, s9
    buffer_load_dwordx4 v[108:111], v4, s[40:43], s10 offen sc1
    buffer_load_dwordx4 v[112:115], v5, s[40:43], s10 offen sc1
    buffer_load_dwordx4 v[116:119], v6, s[40:43], s10 offen sc1
    buffer_load_dwordx4 v[120:123], v7, s[40:43], s10 offen sc1
    s_mov_b64 exec, -1
    v_max3_u32 v208, v12, v16, v20
    v_max_u32 v208, v208, v24
    v_cmp_lt_u32 vcc, s28, v208
    s_nop 0
    s_mov_b64 exec, vcc
    s_bfe_u32 s10, s69, 0x80018
    s_lshl_b32 s10, s10, 12
    s_add_u32 s10, s10, s9
    buffer_load_dwordx4 v[12:15], v224, s[40:43], s10 offen sc1
    buffer_load_dwordx4 v[16:19], v225, s[40:43], s10 offen sc1
    buffer_load_dwordx4 v[20:23], v226, s[40:43], s10 offen sc1
    buffer_load_dwordx4 v[24:27], v227, s[40:43], s10 offen sc1
    s_mov_b64 exec, -1
    v_max3_u32 v208, v28, v32, v36
    v_max_u32 v208, v208, v40
    v_cmp_lt_u32 vcc, s28, v208
    s_nop 0
    s_mov_b64 exec, vcc
    s_bfe_u32 s10, s70, 0x80000
    s_lshl_b32 s10, s10, 12
    s_add_u32 s10, s10, s9
    buffer_load_dwordx4 v[28:31], v224, s[40:43], s10 offen sc1
    buffer_load_dwordx4 v[32:35], v225, s[40:43], s10 offen sc1
    buffer_load_dwordx4 v[36:39], v226, s[40:43], s10 offen sc1
    buffer_load_dwordx4 v[40:43], v227, s[40:43], s10 offen sc1
    s_mov_b64 exec, -1
    s_waitcnt vmcnt(8)
    v_max3_u32 v208, v108, v112, v116
    v_max_u32 v208, v208, v120
    v_cmp_lt_u32 vcc, s28, v208
    s_cbranch_vccnz L_fx6
    s_branch L_s6
L_fx7:
    s_nop 15
    s_waitcnt vmcnt(0)
    s_add_u32 s15, s15, 16
    s_cmp_gt_u32 s15, 65536
    s_cselect_b32 s28, -1, s28
    s_mov_b64 exec, vcc
    s_bfe_u32 s10, s69, 0x80018
    s_lshl_b32 s10, s10, 12
    s_add_u32 s10, s10, s9
    buffer_load_dwordx4 v[12:15], v224, s[40:43], s10 offen sc1
    buffer_load_dwordx4 v[16:19], v225, s[40:43], s10 offen sc1
    buffer_load_dwordx4 v[20:23], v226, s[40:43], s10 offen sc1
    buffer_load_dwordx4 v[24:27], v227, s[40:43], s10 offen sc1
    s_mov_b64 exec, -1
    v_max3_u32 v208, v28, v32, v36
    v_max_u32 v208, v208, v40
    v_cmp_lt_u32 vcc, s28, v208
    s_nop 0
    s_mov_b64 exec, vcc
    s_bfe_u32 s10, s70, 0x80000
    s_lshl_b32 s10, s10, 12
    s_add_u32 s10, s10, s9
    buffer_load_dwordx4 v[28:31], v224, s[40:43], s10 offen sc1
    buffer_load_dwordx4 v[32:35], v225, s[40:43], s10 offen sc1
    buffer_load_dwordx4 v[36:39], v226, s[40:43], s10 offen sc1
    buffer_load_dwordx4 v[40:43], v227, s[40:43], s10 offen sc1
    s_mov_b64 exec, -1
    v_max3_u32 v208, v44, v48, v52
    v_max_u32 v208, v208, v56
    v_cmp_lt_u32 vcc, s28, v208
    s_nop 0
    s_mov_b64 exec, vcc
    s_bfe_u32 s10, s70, 0x80008
    s_lshl_b32 s10, s10, 12
    s_add_u32 s10, s10, s9
    buffer_load_dwordx4 v[44:47], v4, s[40:43], s10 offen sc1
    buffer_load_dwordx4 v[48:51], v5, s[40:43], s10 offen sc1
    buffer_load_dwordx4 v[52:55], v6, s[40:43], s10 offen sc1
    buffer_load_dwordx4 v[56:59], v7, s[40:43], s10 offen sc1
    s_mov_b64 exec, -1
    s_waitcnt vmcnt(8)
    v_max3_u32 v208, v12, v16, v20
    v_max_u32 v208, v208, v24
    v_cmp_lt_u32 vcc, s28, v208
    s_cbranch_vccnz L_fx7
    s_branch L_s7
L_fx8:
    s_nop 15
    s_waitcnt vmcnt(0)
    s_add_u32 s15, s15, 16
    s_cmp_gt_u32 s15, 65536
    s_cselect_b32 s28, -1, s28
    s_mov_b64 exec, vcc
    s_bfe_u32 s10, s70, 0x80000
    s_lshl_b32 s10, s10, 12
    s_add_u32 s10, s10, s9
    buffer_load_dwordx4 v[28:31], v224, s[40:43], s10 offen sc1
    buffer_load_dwordx4 v[32:35], v225, s[40:43], s10 offen sc1
    buffer_load_dwordx4 v[36:39], v226, s[40:43], s10 offen sc1
    buffer_load_dwordx4 v[40:43], v227, s[40:43], s10 offen sc1
    s_mov_b64 exec, -1
    v_max3_u32 v208, v44, v48, v52
    v_max_u32 v208, v208, v56
    v_cmp_lt_u32 vcc, s28, v208
    s_nop 0
    s_mov_b64 exec, vcc
    s_bfe_u32 s10, s70, 0x80008
    s_lshl_b32 s10, s10, 12
    s_add_u32 s10, s10, s9
    buffer_load_dwordx4 v[44:47], v4, s[40:43], s10 offen sc1
    buffer_load_dwordx4 v[48:51], v5, s[40:43], s10 offen sc1
    buffer_load_dwordx4 v[52:55], v6, s[40:43], s10 offen sc1
    buffer_load_dwordx4 v[56:59], v7, s[40:43], s10 offen sc1
    s_mov_b64 exec, -1
    v_max3_u32 v208, v60, v64, v68
    v_max_u32 v208, v208, v72
    v_cmp_lt_u32 vcc, s28, v208
    s_nop 0
    s_mov_b64 exec, vcc
    s_bfe_u32 s10, s70, 0x80010
    s_lshl_b32 s10, s10, 12
    s_add_u32 s10, s10, s9
    buffer_load_dwordx4 v[60:63], v4, s[40:43], s10 offen sc1
    buffer_load_dwordx4 v[64:67], v5, s[40:43], s10 offen sc1
    buffer_load_dwordx4 v[68:71], v6, s[40:43], s10 offen sc1
    buffer_load_dwordx4 v[72:75], v7, s[40:43], s10 offen sc1
    s_mov_b64 exec, -1
    s_waitcnt vmcnt(8)
    v_max3_u32 v208, v28, v32, v36
    v_max_u32 v208, v208, v40
    v_cmp_lt_u32 vcc, s28, v208
    s_cbranch_vccnz L_fx8
    s_branch L_s8
L_fx9:
    s_nop 15
    s_waitcnt vmcnt(0)
    s_add_u32 s15, s15, 16
    s_cmp_gt_u32 s15, 65536
    s_cselect_b32 s28, -1, s28
    s_mov_b64 exec, vcc
    s_bfe_u32 s10, s70, 0x80008
    s_lshl_b32 s10, s10, 12
    s_add_u32 s10, s10, s9
    buffer_load_dwordx4 v[44:47], v4, s[40:43], s10 offen sc1
    buffer_load_dwordx4 v[48:51], v5, s[40:43], s10 offen sc1
    buffer_load_dwordx4 v[52:55], v6, s[40:43], s10 offen sc1
    buffer_load_dwordx4 v[56:59], v7, s[40:43], s10 offen sc1
    s_mov_b64 exec, -1
    v_max3_u32 v208, v60, v64, v68
    v_max_u32 v208, v208, v72
    v_cmp_lt_u32 vcc, s28, v208
    s_nop 0
    s_mov_b64 exec, vcc
    s_bfe_u32 s10, s70, 0x80010
    s_lshl_b32 s10, s10, 12
    s_add_u32 s10, s10, s9
    buffer_load_dwordx4 v[60:63], v4, s[40:43], s10 offen sc1
    buffer_load_dwordx4 v[64:67], v5, s[40:43], s10 offen sc1
    buffer_load_dwordx4 v[68:71], v6, s[40:43], s10 offen sc1
    buffer_load_dwordx4 v[72:75], v7, s[40:43], s10 offen sc1
    s_mov_b64 exec, -1
    v_max3_u32 v208, v76, v80, v84
    v_max_u32 v208, v208, v88
    v_cmp_lt_u32 vcc, s28, v208
    s_nop 0
    s_mov_b64 exec, vcc
    s_bfe_u32 s10, s70, 0x80018
    s_lshl_b32 s10, s10, 12
    s_add_u32 s10, s10, s9
    buffer_load_dwordx4 v[76:79], v4, s[40:43], s10 offen sc1
    buffer_load_dwordx4 v[80:83], v5, s[40:43], s10 offen sc1
    buffer_load_dwordx4 v[84:87], v6, s[40:43], s10 offen sc1
    buffer_load_dwordx4 v[88:91], v7, s[40:43], s10 offen sc1
    s_mov_b64 exec, -1
    s_waitcnt vmcnt(8)
    v_max3_u32 v208, v44, v48, v52
    v_max_u32 v208, v208, v56
    v_cmp_lt_u32 vcc, s28, v208
    s_cbranch_vccnz L_fx9
    s_branch L_s9
L_fx10:
    s_nop 15
    s_waitcnt vmcnt(0)
    s_add_u32 s15, s15, 16
    s_cmp_gt_u32 s15, 65536
    s_cselect_b32 s28, -1, s28
    s_mov_b64 exec, vcc
    s_bfe_u32 s10, s70, 0x80010
    s_lshl_b32 s10, s10, 12
    s_add_u32 s10, s10, s9
    buffer_load_dwordx4 v[60:63], v4, s[40:43], s10 offen sc1
    buffer_load_dwordx4 v[64:67], v5, s[40:43], s10 offen sc1
    buffer_load_dwordx4 v[68:71], v6, s[40:43], s10 offen sc1
    buffer_load_dwordx4 v[72:75], v7, s[40:43], s10 offen sc1
    s_mov_b64 exec, -1
    v_max3_u32 v208, v76, v80, v84
    v_max_u32 v208, v208, v88
    v_cmp_lt_u32 vcc, s28, v208
    s_nop 0
    s_mov_b64 exec, vcc
    s_bfe_u32 s10, s70, 0x80018
    s_lshl_b32 s10, s10, 12
    s_add_u32 s10, s10, s9
    buffer_load_dwordx4 v[76:79], v4, s[40:43], s10 offen sc1
    buffer_load_dwordx4 v[80:83], v5, s[40:43], s10 offen sc1
    buffer_load_dwordx4 v[84:87], v6, s[40:43], s10 offen sc1
    buffer_load_dwordx4 v[88:91], v7, s[40:43], s10 offen sc1
    s_mov_b64 exec, -1
    v_max3_u32 v208, v92, v96, v100
    v_max_u32 v208, v208, v104
    v_cmp_lt_u32 vcc, s28, v208
    s_nop 0
    s_mov_b64 exec, vcc
    s_bfe_u32 s10, s71, 0x80000
    s_lshl_b32 s10, s10, 12
    s_add_u32 s10, s10, s9
    buffer_load_dwordx4 v[92:95], v4, s[40:43], s10 offen sc1
    buffer_load_dwordx4 v[96:99], v5, s[40:43], s10 offen sc1
    buffer_load_dwordx4 v[100:103], v6, s[40:43], s10 offen sc1
    buffer_load_dwordx4 v[104:107], v7, s[40:43], s10 offen sc1
    s_mov_b64 exec, -1
    v_max3_u32 v208, v108, v112, v116
    v_max_u32 v208, v208, v120
    v_cmp_lt_u32 vcc, s28, v208
    s_nop 0
    s_mov_b64 exec, vcc
    s_bfe_u32 s10, s71, 0x80008
    s_lshl_b32 s10, s10, 12
    s_add_u32 s10, s10, s9
    buffer_load_dwordx4 v[108:111], v4, s[40:43], s10 offen sc1
    buffer_load_dwordx4 v[112:115], v5, s[40:43], s10 offen sc1
    buffer_load_dwordx4 v[116:119], v6, s[40:43], s10 offen sc1
    buffer_load_dwordx4 v[120:123], v7, s[40:43], s10 offen sc1
    s_mov_b64 exec, -1
    s_waitcnt vmcnt(12)
    v_max3_u32 v208, v60, v64, v68
    v_max_u32 v208, v208, v72
    v_cmp_lt_u32 vcc, s28, v208
    s_cbranch_vccnz L_fx10
    s_branch L_s10
L_fx11:
    s_nop 15
    s_waitcnt vmcnt(0)
    s_add_u32 s15, s15, 16
    s_cmp_gt_u32 s15, 65536
    s_cselect_b32 s28, -1, s28
    s_mov_b64 exec, vcc
    s_bfe_u32 s10, s70, 0x80018
    s_lshl_b32 s10, s10, 12
    s_add_u32 s10, s10, s9
    buffer_load_dwordx4 v[76:79], v4, s[40:43], s10 offen sc1
    buffer_load_dwordx4 v[80:83], v5, s[40:43], s10 offen sc1
    buffer_load_dwordx4 v[84:87], v6, s[40:43], s10 offen sc1
    buffer_load_dwordx4 v[88:91], v7, s[40:43], s10 offen sc1
    s_mov_b64 exec, -1
    v_max3_u32 v208, v92, v96, v100
    v_max_u32 v208, v208, v104
    v_cmp_lt_u32 vcc, s28, v208
    s_nop 0
    s_mov_b64 exec, vcc
    s_bfe_u32 s10, s71, 0x80000
    s_lshl_b32 s10, s10, 12
    s_add_u32 s10, s10, s9
    buffer_load_dwordx4 v[92:95], v4, s[40:43], s10 offen sc1
    buffer_load_dwordx4 v[96:99], v5, s[40:43], s10 offen sc1
    buffer_load_dwordx4 v[100:103], v6, s[40:43], s10 offen sc1
    buffer_load_dwordx4 v[104:107], v7, s[40:43], s10 offen sc1
    s_mov_b64 exec, -1
    v_max3_u32 v208, v108, v112, v116
    v_max_u32 v208, v208, v120
    v_cmp_lt_u32 vcc, s28, v208
    s_nop 0
    s_mov_b64 exec, vcc
    s_bfe_u32 s10, s71, 0x80008
    s_lshl_b32 s10, s10, 12
    s_add_u32 s10, s10, s9
    buffer_load_dwordx4 v[108:111], v4, s[40:43], s10 offen sc1
    buffer_load_dwordx4 v[112:115], v5, s[40:43], s10 offen sc1
    buffer_load_dwordx4 v[116:119], v6, s[40:43], s10 offen sc1
    buffer_load_dwordx4 v[120:123], v7, s[40:43], s10 offen sc1
    s_mov_b64 exec, -1
    s_waitcnt vmcnt(8)
    v_max3_u32 v208, v76, v80, v84
    v_max_u32 v208, v208, v88
    v_cmp_lt_u32 vcc, s28, v208
    s_cbranch_vccnz L_fx11
    s_branch L_s11
L_fx12:
    s_nop 15
    s_waitcnt vmcnt(0)
    s_add_u32 s15, s15, 16
    s_cmp_gt_u32 s15, 65536
    s_cselect_b32 s28, -1, s28
    s_mov_b64 exec, vcc
    s_bfe_u32 s10, s71, 0x80000
    s_lshl_b32 s10, s10, 12
    s_add_u32 s10, s10, s9
    buffer_load_dwordx4 v[92:95], v4, s[40:43], s10 offen sc1
    buffer_load_dwordx4 v[96:99], v5, s[40:43], s10 offen sc1
    buffer_load_dwordx4 v[100:103], v6, s[40:43], s10 offen sc1
    buffer_load_dwordx4 v[104:107], v7, s[40:43], s10 offen sc1
    s_mov_b64 exec, -1
    v_max3_u32 v208, v108, v112, v116
    v_max_u32 v208, v208, v120
    v_cmp_lt_u32 vcc, s28, v208
    s_nop 0
    s_mov_b64 exec, vcc
    s_bfe_u32 s10, s71, 0x80008
    s_lshl_b32 s10, s10, 12
    s_add_u32 s10, s10, s9
    buffer_load_dwordx4 v[108:111], v4, s[40:43], s10 offen sc1
    buffer_load_dwordx4 v[112:115], v5, s[40:43], s10 offen sc1
    buffer_load_dwordx4 v[116:119], v6, s[40:43], s10 offen sc1
    buffer_load_dwordx4 v[120:123], v7, s[40:43], s10 offen sc1
    s_mov_b64 exec, -1
    s_waitcnt vmcnt(0)
    v_max3_u32 v208, v92, v96, v100
    v_max_u32 v208, v208, v104
    v_max3_u32 v208, v108, v112, v208
    v_max3_u32 v208, v116, v120, v208
    v_cmp_lt_u32 vcc, s28, v208
    s_cbranch_vccnz L_fx12
    s_branch L_s12
L_code_end:
.section .rodata,"a"
.p2align 6
.p2align 6
.amdhsa_kernel fused_kernel
  .amdhsa_next_free_vgpr 512
  .amdhsa_next_free_sgpr 102
  .amdhsa_accum_offset 256
  .amdhsa_group_segment_fixed_size 0
  .amdhsa_kernarg_size 136
  .amdhsa_user_sgpr_count 2
  .amdhsa_user_sgpr_kernarg_segment_ptr 1
  .amdhsa_system_sgpr_workgroup_id_x 1
  .amdhsa_float_denorm_mode_32 3
  .amdhsa_float_denorm_mode_16_64 3
.end_amdhsa_kernel
```
